```python
import torch

def _softmax(x, axis=-1):
    return torch.softmax(x, dim=axis)
def _gelu(x):
    return torch.nn.functional.gelu(x, approximate="tanh")
def _silu(x):
    return torch.nn.functional.silu(x)
def _sigmoid(x):
    return torch.sigmoid(x)
def _layernorm(x, axis=-1, eps=1e-5):
    m = x.mean(dim=axis, keepdim=True)
    v = x.var(dim=axis, keepdim=True, unbiased=False)
    return (x - m) / torch.sqrt(v + eps)
def _scatter_add(tgt, idx, src, axis=0):
    return tgt.clone().index_add_(axis, idx, src)
def _segment_sum(src, seg, n):
    out = torch.zeros((n,) + src.shape[1:], dtype=src.dtype)
    return out.index_add_(0, seg, src)
def _pad(x, pw):
    flat = tuple(v for pair in reversed(pw) for v in pair)
    return torch.nn.functional.pad(x, flat)

kernel_name = 'parallel_sum__ssm_conv_s4d__glu_gated_bilinear__prompt'

def setup_inputs():

    _w = (lambda a: (lambda t: t.to(torch.bfloat16) if t.is_floating_point() else t)(torch.as_tensor(a)))
    def _A_setup():
        Bsz, L, D, N = 1, 2048, 576, 128
        return {
            "u": _w((lambda *s: torch.randn(*s, dtype=torch.bfloat16) * 0.05)(Bsz, L, D)),
            "log_A_real": _w((lambda *s: torch.randn(*s, dtype=torch.bfloat16) * 3.2)(D, N) * 0.5),
            "A_imag": _w((lambda *s: torch.randn(*s, dtype=torch.bfloat16) * 0.05)(D, N) * 3.14),
            "C_real": _w((lambda *s: torch.randn(*s, dtype=torch.bfloat16) * 0.2)(D, N) / N ** 0.5),
            "C_imag": _w((lambda *s: torch.randn(*s, dtype=torch.bfloat16) * 0.2)(D, N) / N ** 0.5),
            "log_dt": _w((lambda *s: torch.randn(*s, dtype=torch.bfloat16) * 0.05)(D) * 0.5 - 4.0),
            "D_skip": _w((lambda *s: torch.randn(*s, dtype=torch.bfloat16) * 0.05)(D)),
        }
    _A_in = _A_setup()

    def _B_setup():
        B, S, D, F = 1, 2048, 576, 4608
        return {
            "x": _w((lambda *s: torch.randn(*s, dtype=torch.bfloat16) * 0.05)(B, S, D)),
            "w_gate": _w((lambda *s: torch.randn(*s, dtype=torch.bfloat16) * 0.4)(D, F) * (D ** -0.5)),
            "w_up": _w((lambda *s: torch.randn(*s, dtype=torch.bfloat16) * 0.4)(D, F) * (D ** -0.5)),
            "w_down": _w((lambda *s: torch.randn(*s, dtype=torch.bfloat16) * 0.4)(F, D) * (F ** -0.5)),
        }
    _B_in = _B_setup()

    return {
        "A_u": _A_in["u"],
        "A_log_A_real": _A_in["log_A_real"],
        "A_A_imag": _A_in["A_imag"],
        "A_C_real": _A_in["C_real"],
        "A_C_imag": _A_in["C_imag"],
        "A_log_dt": _A_in["log_dt"],
        "A_D_skip": _A_in["D_skip"],
        "B_x": _B_in["x"],
        "B_w_gate": _B_in["w_gate"],
        "B_w_up": _B_in["w_up"],
        "B_w_down": _B_in["w_down"],
    }

def reference(A_u, A_log_A_real, A_A_imag, A_C_real, A_C_imag, A_log_dt, A_D_skip, B_x, B_w_gate, B_w_up, B_w_down):
    def _A_ref(u, log_A_real, A_imag, C_real, C_imag, log_dt, D_skip):
        L = u.shape[1]
        dt = torch.exp(log_dt)
        A = -torch.exp(log_A_real) + 1j * A_imag
        C = (C_real + 1j * C_imag) * dt[:, None]
        pos = (lambda x, dt: x.to(dt))(torch.arange(L), log_dt.dtype)
        P = torch.exp((A * dt[:, None])[:, :, None] * pos[None, None, :])
        K = 2.0 * torch.einsum("dn,dnl->dl", C, P).real
        L2 = 2 * L
        u_t = (lambda x, *d: x.permute(*d))(u, 0, 2, 1)
        Kf = (lambda x, *a, **k: torch.fft.rfft(x.float(), *a, **k))(K, L2)
        Uf = (lambda x, *a, **k: torch.fft.rfft(x.float(), *a, **k))(u_t, L2)
        y = (lambda x, *a, **k: torch.fft.irfft(x, *a, **k).to(torch.bfloat16))(Uf * Kf[None, :, :], L2)[:, :, :L]
        y = (lambda x, *d: x.permute(*d))(y, 0, 2, 1)
        return y + u * D_skip[None, None, :]

    def _B_ref(x, w_gate, w_up, w_down):
        g = torch.einsum("bsd,df->bsf", x, w_gate)
        u = torch.einsum("bsd,df->bsf", x, w_up)
        h = g * u
        return torch.einsum("bsf,fd->bsd", h, w_down)

    x = A_u
    xn = _layernorm(x, axis=-1)
    return x + _A_ref(xn, A_log_A_real, A_A_imag, A_C_real, A_C_imag, A_log_dt, A_D_skip) + _B_ref(xn, B_w_gate, B_w_up, B_w_down)
```

```asm
; @launch grid=(256,1,1) block=(256,1,1) lds=163840
.amdgcn_target "amdgcn-amd-amdhsa--gfx950"
.text
.globl parallel_sum__ssm_conv_s4d__glu_gated_bilinear__prompt_kernel
.p2align 12
.p2align 8
.type parallel_sum__ssm_conv_s4d__glu_gated_bilinear__prompt_kernel,@function
parallel_sum__ssm_conv_s4d__glu_gated_bilinear__prompt_kernel:
    s_cmp_ge_u32 s2, 256
    s_cbranch_scc1 END
    s_load_dwordx2 s[24:25], s[0:1], 0
    s_load_dwordx8 s[72:79], s[0:1], 8
    s_load_dwordx4 s[80:83], s[0:1], 40
    s_load_dwordx4 s[4:7], s[0:1], 64
    s_load_dwordx4 s[60:63], s[0:1], 80
    s_load_dwordx2 s[20:21], s[0:1], 104
    s_getpc_b64 s[84:85]
    s_lshr_b32 s86, s2, 3
    s_mul_i32 s86, s86, 1792
    v_and_b32 v2, 15, v0
    v_lshl_add_u32 v2, v2, 7, s86
    v_min_u32 v2, 52992, v2
    global_load_dword v57, v2, s[84:85]
    v_lshrrev_b32 v2, 6, v0
    v_and_b32 v1, 63, v0
    v_readfirstlane_b32 s3, v2
    v_lshrrev_b32 v3, 5, v0
    v_and_b32 v4, 31, v0
    v_mul_u32_u24 v5, 1152, v3
    v_lshl_add_u32 v6, v4, 4, v5
    v_lshl_add_u32 v7, v4, 2, v5
    v_mul_u32_u24 v5, 1216, v3
    v_add_u32 v5, 81920, v5
    v_lshl_add_u32 v46, v4, 4, v5
    v_lshl_add_u32 v47, v4, 2, v5
    s_mul_i32 s64, s2, 9216
    s_mov_b32 s26, 2359296
    s_mov_b32 s27, 0x20000
    s_and_b32 s32, s2, 7
    s_lshr_b32 s33, s2, 3
    s_lshr_b32 s37, s33, 2
    s_and_b32 s36, s33, 3
    s_lshl_b32 s65, s33, 1
    s_add_u32 s65, s65, s3
    s_add_u32 s66, s37, 64
    s_cmp_lt_u32 s3, 2
    s_cselect_b32 s65, s65, s66
    s_mul_i32 s66, s32, 72
    s_add_u32 s65, s65, s66
    s_lshl_b32 s66, s65, 8
    v_lshl_add_u32 v8, v1, 2, s66
    s_lshl_b32 s66, s65, 1
    v_mov_b32 v9, s66
    s_waitcnt lgkmcnt(0)
    buffer_load_dwordx4 v[48:51], v6, s[24:27], s64 offen
    buffer_load_dwordx4 v[52:55], v6, s[24:27], s64 offen offset:512
    buffer_load_dword v56, v7, s[24:27], s64 offen offset:1024
    global_load_dword v40, v8, s[72:73]
    global_load_dword v41, v8, s[74:75]
    global_load_dword v42, v8, s[76:77]
    global_load_dword v43, v8, s[78:79]
    global_load_ushort v44, v9, s[80:81]
    global_load_ushort v45, v9, s[82:83]
    s_add_u32 s66, s20, 35127296
    s_addc_u32 s67, s21, 0
    s_load_dword s59, s[66:67], 0
    s_mov_b32 s84, s4
    s_mov_b32 s85, s5
    s_mov_b32 s86, 5308416
    s_mov_b32 s87, 0x20000
    s_cmp_ge_u32 s3, 2
    s_cselect_b32 s8, s6, s4
    s_cselect_b32 s9, s7, s5
    s_mov_b32 s10, 5308416
    s_mov_b32 s11, 0x20000
    s_mov_b32 s16, s60
    s_mov_b32 s17, s61
    s_mov_b32 s18, 5308416
    s_mov_b32 s19, 0x20000
    s_mov_b32 s22, 44040192
    s_mov_b32 s23, 0x20000
    s_mov_b32 s28, s62
    s_mov_b32 s29, s63
    s_mov_b32 s30, 2359296
    s_mov_b32 s31, 0x20000
    s_cmp_eq_u32 s36, 0
    s_cselect_b32 s0, 3, 2
    s_cmp_lt_u32 s3, s0
    s_cselect_b32 s0, 1, 0
    s_cselect_b32 s66, 0, 134217728
    s_lshl_b32 s5, s65, 12
    s_add_u32 s5, s5, 4718592
    s_add_u32 s5, s5, s66
    s_lshl_b32 s6, s65, 2
    s_add_u32 s6, s6, 34668544
    s_add_u32 s6, s6, s66
    s_lshl_b32 s7, s65, 4
    s_add_u32 s7, s7, 2359296
    s_add_u32 s7, s7, s66
    s_mul_i32 s4, s3, 21248
    s_add_u32 s4, s4, 98304
    s_and_b32 s34, s32, 1
    s_lshr_b32 s35, s32, 1
    s_lshl_b32 s38, s34, 2
    s_add_u32 s36, s36, s38
    s_lshl_b32 s1, s36, 2
    s_add_u32 s1, s1, s3
    s_lshl_b32 s1, s1, 5
    s_add_u32 s1, s1, 34672640
    s_and_b32 s60, s37, 1
    s_lshl_b32 s92, s36, 1
    s_add_u32 s92, s92, s60
    s_lshr_b32 s93, s37, 1
    v_and_b32 v37, 7, v1
    v_lshlrev_b32 v37, 2, v37
    s_lshl_b32 s60, s35, 1
    s_sub_u32 s60, 3, s60
    s_and_b32 s60, s60, 7
    s_lshl_b32 s60, s60, 7
    s_mul_i32 s61, s35, 2304
    s_add_u32 s60, s60, s61
    s_and_b32 s61, s3, 1
    s_lshl1_add_u32 s61, s33, s61
    s_mul_i32 s61, s61, 82944
    s_add_u32 s60, s60, s61
    v_lshrrev_b32 v33, 1, v1
    v_mul_u32_u24 v33, 9216, v33
    v_and_b32 v32, 1, v1
    v_lshl_add_u32 v33, v32, 10, v33
    s_mov_b64 exec, 0x3ffff
    buffer_load_dword v33, v33, s[8:11], s60 offen
    s_mov_b64 exec, -1
    s_and_b32 s60, s33, 3
    s_lshl_b32 s60, s60, 1
    s_add_u32 s60, s60, s37
    s_sub_u32 s61, s60, 9
    s_cmp_ge_u32 s60, 9
    s_cselect_b32 s60, s61, s60
    s_lshl_b32 s62, s36, 2
    s_add_u32 s62, s62, s3
    s_mul_i32 s63, s62, 73728
    s_mul_i32 s58, s62, 589824
    s_mul_i32 s64, s35, 36864
    s_add_u32 s58, s58, s64
    s_add_u32 s58, s58, 8388608
    s_mul_i32 s40, s60, 589824
    s_lshl_b32 s49, s60, 11
    s_add_u32 s49, s49, s63
    s_add_u32 s60, s60, 1
    s_cmp_eq_u32 s60, 9
    s_cselect_b32 s60, 0, s60
    s_mul_i32 s41, s60, 589824
    s_lshl_b32 s50, s60, 11
    s_add_u32 s50, s50, s63
    s_add_u32 s60, s60, 1
    s_cmp_eq_u32 s60, 9
    s_cselect_b32 s60, 0, s60
    s_mul_i32 s42, s60, 589824
    s_lshl_b32 s51, s60, 11
    s_add_u32 s51, s51, s63
    s_add_u32 s60, s60, 1
    s_cmp_eq_u32 s60, 9
    s_cselect_b32 s60, 0, s60
    s_mul_i32 s43, s60, 589824
    s_lshl_b32 s52, s60, 11
    s_add_u32 s52, s52, s63
    s_add_u32 s60, s60, 1
    s_cmp_eq_u32 s60, 9
    s_cselect_b32 s60, 0, s60
    s_mul_i32 s44, s60, 589824
    s_lshl_b32 s53, s60, 11
    s_add_u32 s53, s53, s63
    s_add_u32 s60, s60, 1
    s_cmp_eq_u32 s60, 9
    s_cselect_b32 s60, 0, s60
    s_mul_i32 s45, s60, 589824
    s_lshl_b32 s54, s60, 11
    s_add_u32 s54, s54, s63
    s_add_u32 s60, s60, 1
    s_cmp_eq_u32 s60, 9
    s_cselect_b32 s60, 0, s60
    s_mul_i32 s46, s60, 589824
    s_lshl_b32 s55, s60, 11
    s_add_u32 s55, s55, s63
    s_add_u32 s60, s60, 1
    s_cmp_eq_u32 s60, 9
    s_cselect_b32 s60, 0, s60
    s_mul_i32 s47, s60, 589824
    s_lshl_b32 s56, s60, 11
    s_add_u32 s56, s56, s63
    s_add_u32 s60, s60, 1
    s_cmp_eq_u32 s60, 9
    s_cselect_b32 s60, 0, s60
    s_mul_i32 s48, s60, 589824
    s_lshl_b32 s57, s60, 11
    s_add_u32 s57, s57, s63
    s_and_b32 s60, s3, 1
    s_lshr_b32 s61, s3, 1
    s_lshl_b32 s38, s61, 13
    s_lshl_b32 s62, s60, 10
    s_add_u32 s38, s38, s62
    s_lshl_b32 s39, s60, 11
    s_lshl_b32 s62, s61, 10
    s_add_u32 s39, s39, s62
    s_mul_i32 s62, s35, 2304
    s_lshl_b32 s63, s37, 7
    s_add_u32 s63, s63, s62
    s_mul_i32 s64, s60, 73728
    s_add_u32 s63, s63, s64
    s_lshl_b32 s64, s37, 5
    s_add_u32 s64, s64, s62
    s_add_u32 s64, s64, 2048
    s_mul_i32 s65, s60, 294912
    s_add_u32 s64, s64, s65
    s_lshl_b32 s65, s60, 1
    v_lshrrev_b32 v128, 3, v1
    v_bfe_u32 v129, v1, 4, 1
    v_or_b32 v129, s65, v129
    v_bfe_u32 v130, v1, 1, 2
    v_xor_b32 v129, v129, v130
    v_lshlrev_b32 v129, 5, v129
    v_and_b32 v130, 1, v1
    v_lshl_add_u32 v129, v130, 4, v129
    v_mul_u32_u24 v128, 9216, v128
    v_add3_u32 v14, v128, v129, s63
    v_add_u32 v15, 147456, v14
    v_add_u32 v16, 294912, v14
    v_add_u32 v17, 442368, v14
    v_lshrrev_b32 v128, 1, v1
    v_bfe_u32 v129, v1, 4, 1
    v_lshlrev_b32 v129, 2, v129
    v_xor_b32 v128, v128, v129
    v_mul_u32_u24 v128, 9216, v128
    v_lshlrev_b32 v130, 4, v130
    v_add3_u32 v18, v128, v130, s64
    v_lshrrev_b32 v128, 4, v1
    v_bfe_u32 v129, v1, 2, 2
    v_lshl_add_u32 v130, v128, 3, v129
    v_and_b32 v131, 3, v1
    v_lshlrev_b32 v131, 3, v131
    v_lshl_add_u32 v132, v130, 7, v131
    v_bfe_u32 v133, v1, 3, 2
    v_xor_b32 v134, 0, v133
    v_lshl_add_u32 v2, v134, 5, v132
    v_add_u32 v6, 0x10000, v2
    v_xor_b32 v134, 1, v133
    v_lshl_add_u32 v3, v134, 5, v132
    v_add_u32 v7, 0x10000, v3
    v_xor_b32 v134, 2, v133
    v_lshl_add_u32 v4, v134, 5, v132
    v_add_u32 v8, 0x10000, v4
    v_xor_b32 v134, 3, v133
    v_lshl_add_u32 v5, v134, 5, v132
    v_add_u32 v9, 0x10000, v5
    v_bfe_u32 v133, v1, 4, 1
    v_lshlrev_b32 v133, 2, v133
    v_xor_b32 v134, v130, v133
    v_lshl_add_u32 v10, v134, 5, v131
    v_xor_b32 v11, 128, v10
    v_add_u32 v12, 0x10000, v10
    v_add_u32 v13, 0x10000, v11
    v_lshlrev_b32 v19, 4, v1
    v_mov_b32 v23, v19
    v_add_u32 v20, 18432, v19
    v_add_u32 v24, 147456, v19
    v_add_u32 v21, 36864, v19
    v_add_u32 v25, 294912, v19
    v_add_u32 v22, 55296, v19
    v_add_u32 v26, 442368, v19
    s_add_u32 m0, s38, 0
    s_nop 0
    buffer_load_dwordx4 v14, s[8:11], s40 offen lds
    s_add_u32 m0, s38, 2048
    s_nop 0
    buffer_load_dwordx4 v15, s[8:11], s40 offen lds
    s_add_u32 m0, s38, 4096
    s_nop 0
    buffer_load_dwordx4 v16, s[8:11], s40 offen lds
    s_add_u32 m0, s38, 6144
    s_nop 0
    buffer_load_dwordx4 v17, s[8:11], s40 offen lds
    s_mov_b64 exec, 0
    s_cmp_eq_u32 s3, 0
    s_cbranch_scc1 CH_A0
    s_cmp_eq_u32 s3, 1
    s_cbranch_scc1 CH_A1
    s_cmp_eq_u32 s3, 2
    s_cbranch_scc1 CH_A2
    s_branch CH_A3
RT_A:
    s_mov_b64 exec, -1
    s_waitcnt lgkmcnt(0)
    s_mul_i32 s59, s59, 0x9E3779B1
    s_add_u32 s59, s59, 0x7F4A7C15
    v_mov_b32 v38, s59
    s_waitcnt vmcnt(11)
    v_lshlrev_b32 v60, 16, v48
    v_and_b32 v61, 0xffff0000, v48
    v_lshlrev_b32 v62, 16, v49
    v_and_b32 v63, 0xffff0000, v49
    v_lshlrev_b32 v64, 16, v50
    v_and_b32 v65, 0xffff0000, v50
    v_lshlrev_b32 v66, 16, v51
    v_and_b32 v67, 0xffff0000, v51
    v_lshlrev_b32 v68, 16, v52
    v_and_b32 v69, 0xffff0000, v52
    v_lshlrev_b32 v70, 16, v53
    v_and_b32 v71, 0xffff0000, v53
    v_lshlrev_b32 v72, 16, v54
    v_and_b32 v73, 0xffff0000, v54
    v_lshlrev_b32 v74, 16, v55
    v_and_b32 v75, 0xffff0000, v55
    v_lshlrev_b32 v76, 16, v56
    v_and_b32 v77, 0xffff0000, v56
    v_pk_add_f32 v[80:81], v[60:61], v[62:63]
    v_pk_add_f32 v[82:83], v[64:65], v[66:67]
    v_pk_add_f32 v[80:81], v[80:81], v[68:69]
    v_pk_add_f32 v[82:83], v[82:83], v[70:71]
    v_pk_add_f32 v[80:81], v[80:81], v[72:73]
    v_pk_add_f32 v[82:83], v[82:83], v[74:75]
    v_pk_add_f32 v[80:81], v[80:81], v[76:77]
    v_pk_add_f32 v[80:81], v[80:81], v[82:83]
    v_add_f32 v80, v80, v81
    s_nop 1
    v_add_f32_dpp v80, v80, v80 quad_perm:[1,0,3,2] row_mask:0xf bank_mask:0xf
    s_nop 1
    v_add_f32_dpp v80, v80, v80 quad_perm:[2,3,0,1] row_mask:0xf bank_mask:0xf
    s_nop 1
    v_add_f32_dpp v80, v80, v80 row_half_mirror row_mask:0xf bank_mask:0xf
    s_nop 1
    v_add_f32_dpp v80, v80, v80 row_mirror row_mask:0xf bank_mask:0xf
    v_mov_b32 v81, v80
    s_nop 1
    v_permlane16_swap_b32 v80, v81
    v_add_f32 v80, v80, v81
    v_mul_f32 v80, 0xbae38e39, v80
    v_pk_add_f32 v[60:61], v[60:61], v[80:81] op_sel_hi:[1,0]
    v_pk_add_f32 v[62:63], v[62:63], v[80:81] op_sel_hi:[1,0]
    v_pk_add_f32 v[64:65], v[64:65], v[80:81] op_sel_hi:[1,0]
    v_pk_add_f32 v[66:67], v[66:67], v[80:81] op_sel_hi:[1,0]
    v_pk_add_f32 v[68:69], v[68:69], v[80:81] op_sel_hi:[1,0]
    v_pk_add_f32 v[70:71], v[70:71], v[80:81] op_sel_hi:[1,0]
    v_pk_add_f32 v[72:73], v[72:73], v[80:81] op_sel_hi:[1,0]
    v_pk_add_f32 v[74:75], v[74:75], v[80:81] op_sel_hi:[1,0]
    v_pk_add_f32 v[76:77], v[76:77], v[80:81] op_sel_hi:[1,0]
    v_pk_mul_f32 v[82:83], v[60:61], v[60:61]
    v_pk_mul_f32 v[84:85], v[62:63], v[62:63]
    v_pk_fma_f32 v[82:83], v[64:65], v[64:65], v[82:83]
    v_pk_fma_f32 v[84:85], v[66:67], v[66:67], v[84:85]
    v_pk_fma_f32 v[82:83], v[68:69], v[68:69], v[82:83]
    v_pk_fma_f32 v[84:85], v[70:71], v[70:71], v[84:85]
    v_pk_fma_f32 v[82:83], v[72:73], v[72:73], v[82:83]
    v_pk_fma_f32 v[84:85], v[74:75], v[74:75], v[84:85]
    v_pk_fma_f32 v[82:83], v[76:77], v[76:77], v[82:83]
    v_pk_add_f32 v[80:81], v[82:83], v[84:85]
    v_add_f32 v80, v80, v81
    s_nop 1
    v_add_f32_dpp v80, v80, v80 quad_perm:[1,0,3,2] row_mask:0xf bank_mask:0xf
    s_nop 1
    v_add_f32_dpp v80, v80, v80 quad_perm:[2,3,0,1] row_mask:0xf bank_mask:0xf
    s_nop 1
    v_add_f32_dpp v80, v80, v80 row_half_mirror row_mask:0xf bank_mask:0xf
    s_nop 1
    v_add_f32_dpp v80, v80, v80 row_mirror row_mask:0xf bank_mask:0xf
    v_mov_b32 v81, v80
    s_nop 1
    v_permlane16_swap_b32 v80, v81
    v_add_f32 v80, v80, v81
    v_mov_b32 v81, 0x3727c5ac
    v_fmac_f32 v81, 0x3ae38e39, v80
    v_rsq_f32 v80, v81
    s_nop 0
    v_pk_mul_f32 v[60:61], v[60:61], v[80:81] op_sel_hi:[1,0]
    v_pk_mul_f32 v[62:63], v[62:63], v[80:81] op_sel_hi:[1,0]
    v_pk_mul_f32 v[64:65], v[64:65], v[80:81] op_sel_hi:[1,0]
    v_pk_mul_f32 v[66:67], v[66:67], v[80:81] op_sel_hi:[1,0]
    v_pk_mul_f32 v[68:69], v[68:69], v[80:81] op_sel_hi:[1,0]
    v_pk_mul_f32 v[70:71], v[70:71], v[80:81] op_sel_hi:[1,0]
    v_pk_mul_f32 v[72:73], v[72:73], v[80:81] op_sel_hi:[1,0]
    v_pk_mul_f32 v[74:75], v[74:75], v[80:81] op_sel_hi:[1,0]
    v_pk_mul_f32 v[76:77], v[76:77], v[80:81] op_sel_hi:[1,0]
    v_cvt_pk_bf16_f32 v48, v60, v61
    v_cvt_pk_bf16_f32 v49, v62, v63
    v_cvt_pk_bf16_f32 v50, v64, v65
    v_cvt_pk_bf16_f32 v51, v66, v67
    ds_write_b128 v46, v[48:51]
    v_cvt_pk_bf16_f32 v52, v68, v69
    v_cvt_pk_bf16_f32 v53, v70, v71
    v_cvt_pk_bf16_f32 v54, v72, v73
    v_cvt_pk_bf16_f32 v55, v74, v75
    ds_write_b128 v46, v[52:55] offset:512
    v_cvt_pk_bf16_f32 v56, v76, v77
    ds_write_b32 v47, v56 offset:1024
    s_waitcnt lgkmcnt(0)
    s_barrier
    s_cmp_eq_u32 s0, 1
    s_cbranch_scc1 KGEN
    s_cmp_eq_u32 s3, 2
    s_cbranch_scc1 PACK
    v_and_b32 v104, 7, v1
    v_lshrrev_b32 v105, 3, v1
    v_mul_u32_u24 v106, 1216, v104
    v_lshl_add_u32 v106, v105, 4, v106
    v_add_u32 v106, 81920, v106
    ds_read_b128 v[64:67], v106 offset:0
    ds_read_b128 v[68:71], v106 offset:128
    ds_read_b128 v[72:75], v106 offset:256
    ds_read_b128 v[76:79], v106 offset:384
    ds_read_b128 v[80:83], v106 offset:512
    ds_read_b128 v[84:87], v106 offset:640
    ds_read_b128 v[88:91], v106 offset:768
    ds_read_b128 v[92:95], v106 offset:896
    ds_read_b128 v[96:99], v106 offset:1024
    v_lshlrev_b32 v104, 4, v104
    v_lshl_add_u32 v104, v105, 8, v104
    s_lshr_b32 s60, s2, 1
    s_mul_i32 s60, s60, 18432
    s_and_b32 s61, s2, 1
    s_lshl_b32 s61, s61, 7
    s_add_u32 s60, s60, s61
    v_bfe_u32 v107, v1, 2, 2
    v_mul_u32_u24 v107, 1216, v107
    v_lshrrev_b32 v108, 4, v1
    v_lshl_add_u32 v107, v108, 5, v107
    v_and_b32 v108, 3, v1
    v_lshl_add_u32 v107, v108, 3, v107
    v_add_u32 v107, 81920, v107
    s_waitcnt lgkmcnt(8)
    buffer_store_dwordx4 v[64:67], v104, s[20:23], s60 offen offset:0 sc1
    s_waitcnt lgkmcnt(7)
    buffer_store_dwordx4 v[68:71], v104, s[20:23], s60 offen offset:2048 sc1
    s_add_u32 s60, s60, 4096
    s_waitcnt lgkmcnt(6)
    buffer_store_dwordx4 v[72:75], v104, s[20:23], s60 offen offset:0 sc1
    s_waitcnt lgkmcnt(5)
    buffer_store_dwordx4 v[76:79], v104, s[20:23], s60 offen offset:2048 sc1
    s_add_u32 s60, s60, 4096
    s_waitcnt lgkmcnt(4)
    buffer_store_dwordx4 v[80:83], v104, s[20:23], s60 offen offset:0 sc1
    s_waitcnt lgkmcnt(3)
    buffer_store_dwordx4 v[84:87], v104, s[20:23], s60 offen offset:2048 sc1
    s_add_u32 s60, s60, 4096
    s_waitcnt lgkmcnt(2)
    buffer_store_dwordx4 v[88:91], v104, s[20:23], s60 offen offset:0 sc1
    s_waitcnt lgkmcnt(1)
    buffer_store_dwordx4 v[92:95], v104, s[20:23], s60 offen offset:2048 sc1
    s_add_u32 s60, s60, 4096
    s_waitcnt lgkmcnt(0)
    buffer_store_dwordx4 v[96:99], v104, s[20:23], s60 offen offset:0 sc1
    ds_read_b64_tr_b16 v[128:129], v107 offset:0
    ds_read_b64_tr_b16 v[130:131], v107 offset:4864
    ds_read_b64_tr_b16 v[132:133], v107 offset:128
    ds_read_b64_tr_b16 v[134:135], v107 offset:4992
    ds_read_b64_tr_b16 v[136:137], v107 offset:256
    ds_read_b64_tr_b16 v[138:139], v107 offset:5120
    ds_read_b64_tr_b16 v[140:141], v107 offset:384
    ds_read_b64_tr_b16 v[142:143], v107 offset:5248
    ds_read_b64_tr_b16 v[144:145], v107 offset:512
    ds_read_b64_tr_b16 v[146:147], v107 offset:5376
    ds_read_b64_tr_b16 v[148:149], v107 offset:640
    ds_read_b64_tr_b16 v[150:151], v107 offset:5504
    ds_read_b64_tr_b16 v[152:153], v107 offset:768
    ds_read_b64_tr_b16 v[154:155], v107 offset:5632
    ds_read_b64_tr_b16 v[156:157], v107 offset:896
    ds_read_b64_tr_b16 v[158:159], v107 offset:5760
    ds_read_b64_tr_b16 v[160:161], v107 offset:1024
    ds_read_b64_tr_b16 v[162:163], v107 offset:5888
    s_mul_i32 s60, s2, 9216
    s_add_u32 s60, s60, 2359296
    s_lshl_b32 s61, s2, 2
    s_add_u32 s61, s61, 34672640
    s_add_u32 s62, s61, 4096
    s_waitcnt lgkmcnt(15)
    buffer_store_dwordx4 v[128:131], v23, s[20:23], s60 offen offset:0 sc1
    s_waitcnt lgkmcnt(14)
    buffer_store_dwordx4 v[132:135], v23, s[20:23], s60 offen offset:1024 sc1
    s_waitcnt lgkmcnt(12)
    buffer_store_dwordx4 v[136:139], v23, s[20:23], s60 offen offset:2048 sc1
    s_waitcnt lgkmcnt(10)
    buffer_store_dwordx4 v[140:143], v23, s[20:23], s60 offen offset:3072 sc1
    s_add_u32 s60, s60, 4096
    s_waitcnt lgkmcnt(8)
    buffer_store_dwordx4 v[144:147], v23, s[20:23], s60 offen offset:0 sc1
    s_waitcnt lgkmcnt(6)
    buffer_store_dwordx4 v[148:151], v23, s[20:23], s60 offen offset:1024 sc1
    s_waitcnt lgkmcnt(4)
    buffer_store_dwordx4 v[152:155], v23, s[20:23], s60 offen offset:2048 sc1
    s_waitcnt lgkmcnt(2)
    buffer_store_dwordx4 v[156:159], v23, s[20:23], s60 offen offset:3072 sc1
    s_add_u32 s60, s60, 4096
    s_waitcnt lgkmcnt(0)
    buffer_store_dwordx4 v[160:163], v23, s[20:23], s60 offen offset:0 sc1
    s_mov_b64 exec, 1
    s_waitcnt vmcnt(9)
    buffer_store_dword v38, off, s[20:23], s61 sc1
    s_waitcnt vmcnt(1)
    buffer_store_dword v38, off, s[20:23], s62 sc1
    s_mov_b64 exec, -1
    s_and_b32 s68, s3, 1
    s_lshl_b32 s69, s68, 6
    s_mul_i32 s68, s68, 73728
    v_xor_b32 v152, s69, v14
    v_subrev_u32 v152, s68, v152
    v_xor_b32 v156, 64, v152
    v_add_u32 v156, 73728, v156
    v_xor_b32 v153, s69, v15
    v_subrev_u32 v153, s68, v153
    v_xor_b32 v157, 64, v153
    v_add_u32 v157, 73728, v157
    v_xor_b32 v154, s69, v16
    v_subrev_u32 v154, s68, v154
    v_xor_b32 v158, 64, v154
    v_add_u32 v158, 73728, v158
    v_xor_b32 v155, s69, v17
    v_subrev_u32 v155, s68, v155
    v_xor_b32 v159, 64, v155
    v_add_u32 v159, 73728, v159
    s_and_b32 s68, s33, 3
    s_cbranch_scc1 NODL
    s_mov_b32 m0, 16384
    s_nop 0
    buffer_load_dwordx4 v152, s[84:87], s41 offen lds
    s_mov_b32 m0, 17408
    s_nop 0
    buffer_load_dwordx4 v156, s[84:87], s41 offen lds
    s_mov_b32 m0, 18432
    s_nop 0
    buffer_load_dwordx4 v153, s[84:87], s41 offen lds
    s_mov_b32 m0, 19456
    s_nop 0
    buffer_load_dwordx4 v157, s[84:87], s41 offen lds
    s_mov_b32 m0, 20480
    s_nop 0
    buffer_load_dwordx4 v154, s[84:87], s41 offen lds
    s_mov_b32 m0, 21504
    s_nop 0
    buffer_load_dwordx4 v158, s[84:87], s41 offen lds
    s_mov_b32 m0, 22528
    s_nop 0
    buffer_load_dwordx4 v155, s[84:87], s41 offen lds
    s_mov_b32 m0, 23552
    s_nop 0
    buffer_load_dwordx4 v159, s[84:87], s41 offen lds
    s_mov_b32 m0, 24576
    s_nop 0
    buffer_load_dwordx4 v152, s[8:11], s41 offen lds
    s_mov_b32 m0, 25600
    s_nop 0
    buffer_load_dwordx4 v156, s[8:11], s41 offen lds
    s_mov_b32 m0, 26624
    s_nop 0
    buffer_load_dwordx4 v153, s[8:11], s41 offen lds
    s_mov_b32 m0, 27648
    s_nop 0
    buffer_load_dwordx4 v157, s[8:11], s41 offen lds
    s_mov_b32 m0, 28672
    s_nop 0
    buffer_load_dwordx4 v154, s[8:11], s41 offen lds
    s_mov_b32 m0, 29696
    s_nop 0
    buffer_load_dwordx4 v158, s[8:11], s41 offen lds
    s_mov_b32 m0, 30720
    s_nop 0
    buffer_load_dwordx4 v155, s[8:11], s41 offen lds
    s_mov_b32 m0, 31744
    s_nop 0
    buffer_load_dwordx4 v159, s[8:11], s41 offen lds
    s_mov_b32 m0, 32768
    s_nop 0
    buffer_load_dwordx4 v152, s[84:87], s42 offen lds
    s_mov_b32 m0, 33792
    s_nop 0
    buffer_load_dwordx4 v156, s[84:87], s42 offen lds
    s_mov_b32 m0, 34816
    s_nop 0
    buffer_load_dwordx4 v153, s[84:87], s42 offen lds
    s_mov_b32 m0, 35840
    s_nop 0
    buffer_load_dwordx4 v157, s[84:87], s42 offen lds
    s_mov_b32 m0, 36864
    s_nop 0
    buffer_load_dwordx4 v154, s[84:87], s42 offen lds
    s_mov_b32 m0, 37888
    s_nop 0
    buffer_load_dwordx4 v158, s[84:87], s42 offen lds
    s_mov_b32 m0, 38912
    s_nop 0
    buffer_load_dwordx4 v155, s[84:87], s42 offen lds
    s_mov_b32 m0, 39936
    s_nop 0
    buffer_load_dwordx4 v159, s[84:87], s42 offen lds
    s_mov_b32 m0, 40960
    s_nop 0
    buffer_load_dwordx4 v152, s[8:11], s42 offen lds
    s_mov_b32 m0, 41984
    s_nop 0
    buffer_load_dwordx4 v156, s[8:11], s42 offen lds
    s_mov_b32 m0, 43008
    s_nop 0
    buffer_load_dwordx4 v153, s[8:11], s42 offen lds
    s_mov_b32 m0, 44032
    s_nop 0
    buffer_load_dwordx4 v157, s[8:11], s42 offen lds
    s_mov_b32 m0, 45056
    s_nop 0
    buffer_load_dwordx4 v154, s[8:11], s42 offen lds
    s_mov_b32 m0, 46080
    s_nop 0
    buffer_load_dwordx4 v158, s[8:11], s42 offen lds
    s_mov_b32 m0, 47104
    s_nop 0
    buffer_load_dwordx4 v155, s[8:11], s42 offen lds
    s_mov_b32 m0, 48128
    s_nop 0
    buffer_load_dwordx4 v159, s[8:11], s42 offen lds
    s_mov_b32 m0, 49152
    s_nop 0
    buffer_load_dwordx4 v152, s[84:87], s43 offen lds
    s_mov_b32 m0, 50176
    s_nop 0
    buffer_load_dwordx4 v156, s[84:87], s43 offen lds
    s_mov_b32 m0, 51200
    s_nop 0
    buffer_load_dwordx4 v153, s[84:87], s43 offen lds
    s_mov_b32 m0, 52224
    s_nop 0
    buffer_load_dwordx4 v157, s[84:87], s43 offen lds
    s_mov_b32 m0, 53248
    s_nop 0
    buffer_load_dwordx4 v154, s[84:87], s43 offen lds
    s_mov_b32 m0, 54272
    s_nop 0
    buffer_load_dwordx4 v158, s[84:87], s43 offen lds
    s_mov_b32 m0, 55296
    s_nop 0
    buffer_load_dwordx4 v155, s[84:87], s43 offen lds
    s_mov_b32 m0, 56320
    s_nop 0
    buffer_load_dwordx4 v159, s[84:87], s43 offen lds
    s_mov_b32 m0, 57344
    s_nop 0
    buffer_load_dwordx4 v152, s[8:11], s43 offen lds
    s_mov_b32 m0, 58368
    s_nop 0
    buffer_load_dwordx4 v156, s[8:11], s43 offen lds
    s_mov_b32 m0, 59392
    s_nop 0
    buffer_load_dwordx4 v153, s[8:11], s43 offen lds
    s_mov_b32 m0, 60416
    s_nop 0
    buffer_load_dwordx4 v157, s[8:11], s43 offen lds
    s_mov_b32 m0, 61440
    s_nop 0
    buffer_load_dwordx4 v154, s[8:11], s43 offen lds
    s_mov_b32 m0, 62464
    s_nop 0
    buffer_load_dwordx4 v158, s[8:11], s43 offen lds
    s_mov_b32 m0, 63488
    s_nop 0
    buffer_load_dwordx4 v155, s[8:11], s43 offen lds
    s_mov_b32 m0, 64512
    s_nop 0
    buffer_load_dwordx4 v159, s[8:11], s43 offen lds
    s_waitcnt vmcnt(44)
    s_mov_b32 m0, 65536
    s_nop 0
    buffer_load_dwordx4 v152, s[84:87], s44 offen lds
    s_mov_b32 m0, 66560
    s_nop 0
    buffer_load_dwordx4 v156, s[84:87], s44 offen lds
    s_mov_b32 m0, 67584
    s_nop 0
    buffer_load_dwordx4 v153, s[84:87], s44 offen lds
    s_mov_b32 m0, 68608
CH_A0:
PG1:
    s_cbranch_execz RT_A
    s_nop 0
    buffer_load_dwordx4 v157, s[84:87], s44 offen lds
    s_mov_b32 m0, 69632
    s_nop 0
    buffer_load_dwordx4 v154, s[84:87], s44 offen lds
    s_mov_b32 m0, 70656
    s_nop 0
    buffer_load_dwordx4 v158, s[84:87], s44 offen lds
    s_mov_b32 m0, 71680
    s_nop 0
    buffer_load_dwordx4 v155, s[84:87], s44 offen lds
    s_mov_b32 m0, 72704
    s_nop 0
    buffer_load_dwordx4 v159, s[84:87], s44 offen lds
    s_mov_b32 m0, 73728
    s_nop 0
    buffer_load_dwordx4 v152, s[8:11], s44 offen lds
    s_mov_b32 m0, 74752
    s_nop 0
    buffer_load_dwordx4 v156, s[8:11], s44 offen lds
    s_mov_b32 m0, 75776
    s_nop 0
    buffer_load_dwordx4 v153, s[8:11], s44 offen lds
    s_mov_b32 m0, 76800
    s_nop 0
    buffer_load_dwordx4 v157, s[8:11], s44 offen lds
    s_mov_b32 m0, 77824
    s_nop 0
    buffer_load_dwordx4 v154, s[8:11], s44 offen lds
    s_mov_b32 m0, 78848
    s_nop 0
    buffer_load_dwordx4 v158, s[8:11], s44 offen lds
    s_mov_b32 m0, 79872
    s_nop 0
    buffer_load_dwordx4 v155, s[8:11], s44 offen lds
    s_mov_b32 m0, 80896
    s_nop 0
    buffer_load_dwordx4 v159, s[8:11], s44 offen lds
NODL:
    s_mov_b64 exec, 0
    s_branch CH_B
RT_B:
    s_mov_b64 exec, -1
    s_branch JOIN
PACK:
    s_and_b32 s68, s3, 1
    s_lshl_b32 s69, s68, 6
    s_mul_i32 s68, s68, 73728
    v_xor_b32 v152, s69, v14
    v_subrev_u32 v152, s68, v152
    v_xor_b32 v156, 64, v152
    v_add_u32 v156, 73728, v156
    v_xor_b32 v153, s69, v15
    v_subrev_u32 v153, s68, v153
    v_xor_b32 v157, 64, v153
    v_add_u32 v157, 73728, v157
    v_xor_b32 v154, s69, v16
    v_subrev_u32 v154, s68, v154
    v_xor_b32 v158, 64, v154
    v_add_u32 v158, 73728, v158
    v_xor_b32 v155, s69, v17
    v_subrev_u32 v155, s68, v155
    v_xor_b32 v159, 64, v155
    v_add_u32 v159, 73728, v159
    v_lshrrev_b32 v128, 2, v1
    v_mul_u32_u24 v128, 1152, v128
    v_bfe_u32 v129, v1, 1, 1
    v_bfe_u32 v130, v1, 4, 1
    v_xor_b32 v129, v129, v130
    v_lshl_add_u32 v128, v129, 5, v128
    v_and_b32 v129, 1, v1
    v_lshl_add_u32 v128, v129, 4, v128
    s_lshl_b32 s62, s93, 8
    v_lshrrev_b32 v130, 1, v1
    v_mul_u32_u24 v130, 1152, v130
    v_lshl_add_u32 v130, v129, 4, v130
    s_lshl_b32 s63, s93, 5
    s_add_u32 s63, s63, 1024
    v_add_u32 v148, s63, v130
    s_xor_b32 s63, s35, 0
    s_lshl_b32 s63, s63, 6
    s_add_u32 s63, s63, s62
    v_add_u32 v140, s63, v128
    v_add_u32 v141, 18432, v140
    s_xor_b32 s63, s35, 1
    s_lshl_b32 s63, s63, 6
    s_add_u32 s63, s63, s62
    v_add_u32 v142, s63, v128
    v_add_u32 v143, 18432, v142
    s_xor_b32 s63, s35, 2
    s_lshl_b32 s63, s63, 6
    s_add_u32 s63, s63, s62
    v_add_u32 v144, s63, v128
    v_add_u32 v145, 18432, v144
    s_xor_b32 s63, s35, 3
    s_lshl_b32 s63, s63, 6
    s_add_u32 s63, s63, s62
    v_add_u32 v146, s63, v128
    v_add_u32 v147, 18432, v146
    s_lshl_b32 s66, s34, 1
    s_sub_u32 s66, s92, s66
    s_sub_u32 s66, s66, 2
    s_mul_i32 s60, s35, 36
    s_add_u32 s60, s60, s66
    s_mul_i32 s60, s60, 36864
    s_add_u32 s61, s60, 442368
    s_add_u32 s62, s60, 884736
    s_lshl_b32 s63, s35, 2
    s_add_u32 s63, s63, s93
    s_mul_i32 s63, s63, 36
    s_add_u32 s63, s63, s66
    s_mul_i32 s63, s63, 9216
    s_add_u32 s63, s63, 37748736
    s_add_u32 s64, s63, 110592
    s_add_u32 s65, s63, 221184
    v_add_u32 v128, 8192, v23
    v_add_u32 v34, 4096, v23
    s_mov_b32 m0, 16384
    s_nop 0
    buffer_load_dwordx4 v152, s[84:87], s41 offen lds
    s_mov_b32 m0, 17408
    s_nop 0
    buffer_load_dwordx4 v156, s[84:87], s41 offen lds
    s_mov_b32 m0, 18432
    s_nop 0
    buffer_load_dwordx4 v153, s[84:87], s41 offen lds
    s_mov_b32 m0, 19456
    s_nop 0
    buffer_load_dwordx4 v157, s[84:87], s41 offen lds
    s_mov_b32 m0, 20480
    s_nop 0
    buffer_load_dwordx4 v154, s[84:87], s41 offen lds
    s_mov_b32 m0, 21504
    s_nop 0
    buffer_load_dwordx4 v158, s[84:87], s41 offen lds
    s_mov_b32 m0, 22528
    s_nop 0
    buffer_load_dwordx4 v155, s[84:87], s41 offen lds
    s_mov_b32 m0, 23552
    s_nop 0
    buffer_load_dwordx4 v159, s[84:87], s41 offen lds
    s_mov_b32 m0, 24576
    s_nop 0
    buffer_load_dwordx4 v152, s[8:11], s41 offen lds
    s_mov_b32 m0, 25600
    s_nop 0
    buffer_load_dwordx4 v156, s[8:11], s41 offen lds
    s_mov_b32 m0, 26624
    s_nop 0
    buffer_load_dwordx4 v153, s[8:11], s41 offen lds
    s_mov_b32 m0, 27648
    s_nop 0
    buffer_load_dwordx4 v157, s[8:11], s41 offen lds
    s_mov_b32 m0, 28672
    s_nop 0
    buffer_load_dwordx4 v154, s[8:11], s41 offen lds
    s_mov_b32 m0, 29696
    s_nop 0
    buffer_load_dwordx4 v158, s[8:11], s41 offen lds
    s_mov_b32 m0, 30720
    s_nop 0
    buffer_load_dwordx4 v155, s[8:11], s41 offen lds
    s_mov_b32 m0, 31744
    s_nop 0
    buffer_load_dwordx4 v159, s[8:11], s41 offen lds
    s_mov_b32 m0, 32768
    s_nop 0
    buffer_load_dwordx4 v152, s[84:87], s42 offen lds
    s_mov_b32 m0, 33792
    s_nop 0
    buffer_load_dwordx4 v156, s[84:87], s42 offen lds
    s_mov_b32 m0, 34816
    s_nop 0
    buffer_load_dwordx4 v153, s[84:87], s42 offen lds
    s_mov_b32 m0, 35840
    s_nop 0
    buffer_load_dwordx4 v157, s[84:87], s42 offen lds
    s_mov_b32 m0, 36864
    s_nop 0
    buffer_load_dwordx4 v154, s[84:87], s42 offen lds
    s_mov_b32 m0, 37888
    s_nop 0
    buffer_load_dwordx4 v158, s[84:87], s42 offen lds
    s_mov_b32 m0, 38912
    s_nop 0
    buffer_load_dwordx4 v155, s[84:87], s42 offen lds
    s_mov_b32 m0, 39936
    s_nop 0
    buffer_load_dwordx4 v159, s[84:87], s42 offen lds
    s_mov_b32 m0, 40960
    s_nop 0
    buffer_load_dwordx4 v152, s[8:11], s42 offen lds
    s_mov_b32 m0, 41984
    s_nop 0
    buffer_load_dwordx4 v156, s[8:11], s42 offen lds
    s_mov_b32 m0, 43008
    s_nop 0
    buffer_load_dwordx4 v153, s[8:11], s42 offen lds
    s_mov_b32 m0, 44032
    s_nop 0
    buffer_load_dwordx4 v157, s[8:11], s42 offen lds
    s_mov_b32 m0, 45056
    s_nop 0
    buffer_load_dwordx4 v154, s[8:11], s42 offen lds
    s_mov_b32 m0, 46080
    s_nop 0
    buffer_load_dwordx4 v158, s[8:11], s42 offen lds
    s_mov_b32 m0, 47104
    s_nop 0
    buffer_load_dwordx4 v155, s[8:11], s42 offen lds
    s_mov_b32 m0, 48128
    s_nop 0
    buffer_load_dwordx4 v159, s[8:11], s42 offen lds
    s_mov_b32 m0, 49152
    s_nop 0
    buffer_load_dwordx4 v152, s[84:87], s43 offen lds
    s_mov_b32 m0, 50176
    s_nop 0
    buffer_load_dwordx4 v156, s[84:87], s43 offen lds
    s_mov_b32 m0, 51200
    s_nop 0
    buffer_load_dwordx4 v153, s[84:87], s43 offen lds
    s_mov_b32 m0, 52224
    s_nop 0
    buffer_load_dwordx4 v157, s[84:87], s43 offen lds
    s_mov_b32 m0, 53248
    s_nop 0
    buffer_load_dwordx4 v154, s[84:87], s43 offen lds
    s_mov_b32 m0, 54272
    s_nop 0
    buffer_load_dwordx4 v158, s[84:87], s43 offen lds
    s_mov_b32 m0, 55296
    s_nop 0
    buffer_load_dwordx4 v155, s[84:87], s43 offen lds
    s_mov_b32 m0, 56320
    s_nop 0
    buffer_load_dwordx4 v159, s[84:87], s43 offen lds
    s_mov_b32 m0, 57344
    s_nop 0
    buffer_load_dwordx4 v152, s[8:11], s43 offen lds
    s_mov_b32 m0, 58368
    s_nop 0
    buffer_load_dwordx4 v156, s[8:11], s43 offen lds
    s_mov_b32 m0, 59392
    s_nop 0
    buffer_load_dwordx4 v153, s[8:11], s43 offen lds
    s_mov_b32 m0, 60416
    s_nop 0
    buffer_load_dwordx4 v157, s[8:11], s43 offen lds
    s_mov_b32 m0, 61440
    s_nop 0
    buffer_load_dwordx4 v154, s[8:11], s43 offen lds
    s_mov_b32 m0, 62464
    s_nop 0
    buffer_load_dwordx4 v158, s[8:11], s43 offen lds
    s_mov_b32 m0, 63488
    s_nop 0
    buffer_load_dwordx4 v155, s[8:11], s43 offen lds
    s_mov_b32 m0, 64512
    s_nop 0
    buffer_load_dwordx4 v159, s[8:11], s43 offen lds
    s_waitcnt vmcnt(52)
    s_waitcnt vmcnt(44)
    s_mov_b32 m0, 65536
    s_nop 0
    buffer_load_dwordx4 v152, s[84:87], s44 offen lds
    s_mov_b32 m0, 66560
    s_nop 0
    buffer_load_dwordx4 v156, s[84:87], s44 offen lds
    s_mov_b32 m0, 67584
    s_nop 0
    buffer_load_dwordx4 v153, s[84:87], s44 offen lds
    s_mov_b32 m0, 68608
    s_nop 0
    buffer_load_dwordx4 v157, s[84:87], s44 offen lds
    s_mov_b32 m0, 69632
    s_nop 0
    buffer_load_dwordx4 v154, s[84:87], s44 offen lds
    s_mov_b32 m0, 70656
    s_nop 0
    buffer_load_dwordx4 v158, s[84:87], s44 offen lds
    s_mov_b32 m0, 71680
    s_nop 0
    buffer_load_dwordx4 v155, s[84:87], s44 offen lds
    s_mov_b32 m0, 72704
    s_nop 0
    buffer_load_dwordx4 v159, s[84:87], s44 offen lds
    s_mov_b32 m0, 73728
    s_nop 0
    buffer_load_dwordx4 v152, s[8:11], s44 offen lds
    s_mov_b32 m0, 74752
    s_nop 0
    buffer_load_dwordx4 v156, s[8:11], s44 offen lds
    s_mov_b32 m0, 75776
    s_nop 0
    buffer_load_dwordx4 v153, s[8:11], s44 offen lds
    s_mov_b32 m0, 76800
    s_nop 0
    buffer_load_dwordx4 v157, s[8:11], s44 offen lds
    s_mov_b32 m0, 77824
    s_nop 0
    buffer_load_dwordx4 v154, s[8:11], s44 offen lds
    s_mov_b32 m0, 78848
    s_nop 0
    buffer_load_dwordx4 v158, s[8:11], s44 offen lds
    s_mov_b32 m0, 79872
    s_nop 0
    buffer_load_dwordx4 v155, s[8:11], s44 offen lds
    s_mov_b32 m0, 80896
    s_nop 0
    buffer_load_dwordx4 v159, s[8:11], s44 offen lds
    s_waitcnt vmcnt(52)
    buffer_load_dwordx4 a[4:7], v142, s[16:19], s60 offen
    buffer_load_dwordx4 a[28:31], v140, s[16:19], s60 offen
    buffer_load_dwordx4 a[8:11], v143, s[16:19], s60 offen
    buffer_load_dwordx4 a[32:35], v141, s[16:19], s60 offen
    buffer_load_dwordx4 a[12:15], v144, s[16:19], s60 offen
    buffer_load_dwordx4 a[20:23], v146, s[16:19], s60 offen
    buffer_load_dwordx4 a[16:19], v145, s[16:19], s60 offen
    buffer_load_dwordx4 a[24:27], v147, s[16:19], s60 offen
    buffer_load_dwordx4 a[0:3], v148, s[16:19], s60 offen
    s_waitcnt vmcnt(52)
    buffer_load_dwordx4 a[40:43], v142, s[16:19], s61 offen
    buffer_load_dwordx4 a[64:67], v140, s[16:19], s61 offen
    buffer_load_dwordx4 a[44:47], v143, s[16:19], s61 offen
    buffer_load_dwordx4 a[68:71], v141, s[16:19], s61 offen
    buffer_load_dwordx4 a[48:51], v144, s[16:19], s61 offen
    buffer_load_dwordx4 a[56:59], v146, s[16:19], s61 offen
    buffer_load_dwordx4 a[52:55], v145, s[16:19], s61 offen
    buffer_load_dwordx4 a[60:63], v147, s[16:19], s61 offen
    buffer_load_dwordx4 a[36:39], v148, s[16:19], s61 offen
    s_waitcnt vmcnt(52)
    buffer_load_dwordx4 a[76:79], v142, s[16:19], s62 offen
    buffer_load_dwordx4 a[100:103], v140, s[16:19], s62 offen
    buffer_load_dwordx4 a[80:83], v143, s[16:19], s62 offen
    buffer_load_dwordx4 a[104:107], v141, s[16:19], s62 offen
    buffer_load_dwordx4 a[84:87], v144, s[16:19], s62 offen
    buffer_load_dwordx4 a[92:95], v146, s[16:19], s62 offen
    buffer_load_dwordx4 a[88:91], v145, s[16:19], s62 offen
    buffer_load_dwordx4 a[96:99], v147, s[16:19], s62 offen
    buffer_load_dwordx4 a[72:75], v148, s[16:19], s62 offen
    s_waitcnt vmcnt(52)
    s_waitcnt vmcnt(18)
    buffer_store_dwordx4 a[0:3], v23, s[20:23], s63 offen offset:0 sc1
    buffer_store_dwordx4 a[4:7], v23, s[20:23], s63 offen offset:1024 sc1
    buffer_store_dwordx4 a[8:11], v23, s[20:23], s63 offen offset:2048 sc1
    buffer_store_dwordx4 a[12:15], v23, s[20:23], s63 offen offset:3072 sc1
    buffer_store_dwordx4 a[16:19], v34, s[20:23], s63 offen offset:0 sc1
    buffer_store_dwordx4 a[20:23], v34, s[20:23], s63 offen offset:1024 sc1
    buffer_store_dwordx4 a[24:27], v34, s[20:23], s63 offen offset:2048 sc1
    buffer_store_dwordx4 a[28:31], v34, s[20:23], s63 offen offset:3072 sc1
    buffer_store_dwordx4 a[32:35], v128, s[20:23], s63 offen offset:0 sc1
    s_waitcnt vmcnt(18)
    buffer_store_dwordx4 a[36:39], v23, s[20:23], s64 offen offset:0 sc1
    buffer_store_dwordx4 a[40:43], v23, s[20:23], s64 offen offset:1024 sc1
    buffer_store_dwordx4 a[44:47], v23, s[20:23], s64 offen offset:2048 sc1
    buffer_store_dwordx4 a[48:51], v23, s[20:23], s64 offen offset:3072 sc1
    buffer_store_dwordx4 a[52:55], v34, s[20:23], s64 offen offset:0 sc1
    buffer_store_dwordx4 a[56:59], v34, s[20:23], s64 offen offset:1024 sc1
    buffer_store_dwordx4 a[60:63], v34, s[20:23], s64 offen offset:2048 sc1
    buffer_store_dwordx4 a[64:67], v34, s[20:23], s64 offen offset:3072 sc1
    buffer_store_dwordx4 a[68:71], v128, s[20:23], s64 offen offset:0 sc1
    s_waitcnt vmcnt(18)
    buffer_store_dwordx4 a[72:75], v23, s[20:23], s65 offen offset:0 sc1
    buffer_store_dwordx4 a[76:79], v23, s[20:23], s65 offen offset:1024 sc1
    buffer_store_dwordx4 a[80:83], v23, s[20:23], s65 offen offset:2048 sc1
    buffer_store_dwordx4 a[84:87], v23, s[20:23], s65 offen offset:3072 sc1
    buffer_store_dwordx4 a[88:91], v34, s[20:23], s65 offen offset:0 sc1
    buffer_store_dwordx4 a[92:95], v34, s[20:23], s65 offen offset:1024 sc1
    buffer_store_dwordx4 a[96:99], v34, s[20:23], s65 offen offset:2048 sc1
    buffer_store_dwordx4 a[100:103], v34, s[20:23], s65 offen offset:3072 sc1
    buffer_store_dwordx4 a[104:107], v128, s[20:23], s65 offen offset:0 sc1
    s_branch JOIN
KGEN:
    s_waitcnt vmcnt(5)
    v_lshlrev_b32 v44, 16, v44
    v_lshlrev_b32 v140, 16, v40
    v_and_b32 v141, 0xffff0000, v40
    v_mul_f32 v44, 0x3fb8aa3b, v44
    v_mul_f32 v140, 0x3fb8aa3b, v140
    v_mul_f32 v141, 0x3fb8aa3b, v141
    v_exp_f32 v44, v44
    v_exp_f32 v140, v140
    v_exp_f32 v141, v141
    v_lshlrev_b32 v48, 16, v41
    v_and_b32 v49, 0xffff0000, v41
    v_cvt_pk_bf16_f32 v44, v44, v44
    v_cvt_pk_bf16_f32 v140, v140, v141
    v_lshlrev_b32 v54, 16, v42
    v_and_b32 v55, 0xffff0000, v42
    v_lshlrev_b32 v56, 16, v43
    v_and_b32 v57, 0xffff0000, v43
    v_lshlrev_b32 v44, 16, v44
    v_lshlrev_b32 v46, 16, v140
    v_and_b32 v47, 0xffff0000, v140
    v_pk_mul_f32 v[48:49], v[48:49], v[44:45] op_sel_hi:[1,0]
    v_pk_mul_f32 v[46:47], v[46:47], v[44:45] op_sel_hi:[1,0]
    v_add_f32 v44, v44, v44
    v_mul_f32 v46, 0xbfb8aa3b, v46
    v_mul_f32 v47, 0xbfb8aa3b, v47
    v_mul_f32 v48, 0.15915494, v48
    v_mul_f32 v49, 0.15915494, v49
    v_pk_mul_f32 v[54:55], v[54:55], v[44:45] op_sel_hi:[1,0]
    v_pk_mul_f32 v[56:57], v[56:57], v[44:45] op_sel_hi:[1,0] neg_lo:[1,0] neg_hi:[1,0]
    v_lshlrev_b32 v45, 16, v45
    v_cmp_eq_u32 vcc, 0, v1
    v_mul_f32 v140, 0x3f800000, v46
    v_mul_f32 v142, 0x3f800000, v48
    v_mul_f32 v141, 0x3f800000, v47
    v_mul_f32 v143, 0x3f800000, v49
    v_mul_f32 v144, 0x41800000, v46
    v_mul_f32 v146, 0x41800000, v48
    v_mul_f32 v145, 0x41800000, v47
    v_mul_f32 v147, 0x41800000, v49
    v_mul_f32 v148, 0x43800000, v46
    v_mul_f32 v150, 0x43800000, v48
    v_mul_f32 v149, 0x43800000, v47
    v_mul_f32 v151, 0x43800000, v49
    v_cndmask_b32 v45, 0, v45, vcc
    v_exp_f32 v140, v140
    v_fract_f32 v142, v142
    v_exp_f32 v141, v141
    v_fract_f32 v143, v143
    v_exp_f32 v144, v144
    v_fract_f32 v146, v146
    v_exp_f32 v145, v145
    v_fract_f32 v147, v147
    v_exp_f32 v148, v148
    v_fract_f32 v150, v150
    v_exp_f32 v149, v149
    v_fract_f32 v151, v151
    v_cos_f32 v192, v142
    v_sin_f32 v194, v142
    v_cos_f32 v193, v143
    v_sin_f32 v195, v143
    v_cos_f32 v50, v146
    v_sin_f32 v52, v146
    v_cos_f32 v51, v147
    v_sin_f32 v53, v147
    v_cos_f32 v66, v150
    v_sin_f32 v68, v150
    v_cos_f32 v67, v151
    v_sin_f32 v69, v151
    v_lshl_add_u32 v40, v1, 3, s4
    v_and_b32 v152, 15, v1
    v_lshrrev_b32 v153, 4, v1
    v_lshl_add_u32 v153, v153, 4, s4
    v_mov_b32 v155, 544
    v_mad_u32_u24 v41, v152, v155, v153
    v_pk_mul_f32 v[192:193], v[192:193], v[140:141]
    v_pk_mul_f32 v[194:195], v[194:195], v[140:141]
    v_pk_mul_f32 v[50:51], v[50:51], v[144:145]
    v_pk_mul_f32 v[52:53], v[52:53], v[144:145] neg_lo:[1,0] neg_hi:[1,0]
    v_pk_mul_f32 v[66:67], v[66:67], v[148:149]
    v_pk_mul_f32 v[68:69], v[68:69], v[148:149]
    v_bfe_u32 v154, v1, 1, 1
    v_add3_u32 v154, v154, v152, 0
    v_lshrrev_b32 v154, 1, v154
    v_mad_u32_u24 v42, v154, v155, v153
    v_bfe_u32 v154, v1, 2, 1
    v_add3_u32 v154, v154, v152, 1
    v_lshrrev_b32 v154, 2, v154
    v_mad_u32_u24 v43, v154, v155, v153
    v_bfe_u32 v154, v1, 3, 1
    v_add3_u32 v154, v154, v152, 3
    v_lshrrev_b32 v154, 3, v154
    v_mad_u32_u24 v44, v154, v155, v153
    v_mov_b32 v188, 0x3f803f80
    v_mov_b32 v189, 0
    ds_write_b64 v40, v[188:189] offset:8704
    v_pk_mul_f32 v[58:59], v[54:55], v[50:51]
    v_pk_mul_f32 v[196:197], v[192:193], v[192:193]
    v_pk_mul_f32 v[60:61], v[54:55], v[52:53]
    v_pk_mul_f32 v[198:199], v[192:193], v[194:195]
    v_pk_fma_f32 v[58:59], v[56:57], v[52:53], v[58:59] neg_lo:[1,0,0] neg_hi:[1,0,0]
    v_pk_fma_f32 v[196:197], v[194:195], v[194:195], v[196:197] neg_lo:[1,0,0] neg_hi:[1,0,0]
    v_pk_fma_f32 v[60:61], v[56:57], v[50:51], v[60:61]
    v_pk_fma_f32 v[198:199], v[194:195], v[192:193], v[198:199]
    v_cvt_pk_bf16_f32 v70, v54, v55
    v_cvt_pk_bf16_f32 v71, v56, v57
    ds_write_b64 v40, v[70:71] offset:0
    v_cvt_pk_bf16_f32 v72, v192, v193
    v_cvt_pk_bf16_f32 v73, v194, v195
    ds_write_b64 v40, v[72:73] offset:9248
    v_pk_mul_f32 v[54:55], v[58:59], v[50:51]
    v_pk_mul_f32 v[200:201], v[196:197], v[192:193]
    v_pk_mul_f32 v[56:57], v[58:59], v[52:53]
    v_pk_mul_f32 v[202:203], v[196:197], v[194:195]
    v_pk_fma_f32 v[54:55], v[60:61], v[52:53], v[54:55] neg_lo:[1,0,0] neg_hi:[1,0,0]
    v_pk_fma_f32 v[200:201], v[198:199], v[194:195], v[200:201] neg_lo:[1,0,0] neg_hi:[1,0,0]
    v_pk_fma_f32 v[56:57], v[60:61], v[50:51], v[56:57]
    v_pk_fma_f32 v[202:203], v[198:199], v[192:193], v[202:203]
    v_cvt_pk_bf16_f32 v74, v58, v59
    v_cvt_pk_bf16_f32 v75, v60, v61
    ds_write_b64 v40, v[74:75] offset:544
    v_cvt_pk_bf16_f32 v70, v196, v197
    v_cvt_pk_bf16_f32 v71, v198, v199
    ds_write_b64 v40, v[70:71] offset:9792
    v_pk_mul_f32 v[58:59], v[54:55], v[50:51]
    v_pk_mul_f32 v[204:205], v[200:201], v[192:193]
    v_pk_mul_f32 v[60:61], v[54:55], v[52:53]
    v_pk_mul_f32 v[206:207], v[200:201], v[194:195]
    v_pk_fma_f32 v[58:59], v[56:57], v[52:53], v[58:59] neg_lo:[1,0,0] neg_hi:[1,0,0]
    v_pk_fma_f32 v[204:205], v[202:203], v[194:195], v[204:205] neg_lo:[1,0,0] neg_hi:[1,0,0]
    v_pk_fma_f32 v[60:61], v[56:57], v[50:51], v[60:61]
    v_pk_fma_f32 v[206:207], v[202:203], v[192:193], v[206:207]
    v_cvt_pk_bf16_f32 v72, v54, v55
    v_cvt_pk_bf16_f32 v73, v56, v57
    ds_write_b64 v40, v[72:73] offset:1088
    v_cvt_pk_bf16_f32 v74, v200, v201
    v_cvt_pk_bf16_f32 v75, v202, v203
    ds_write_b64 v40, v[74:75] offset:10336
    v_pk_mul_f32 v[54:55], v[58:59], v[50:51]
    v_pk_mul_f32 v[208:209], v[204:205], v[192:193]
    v_pk_mul_f32 v[56:57], v[58:59], v[52:53]
    v_pk_mul_f32 v[210:211], v[204:205], v[194:195]
    v_pk_fma_f32 v[54:55], v[60:61], v[52:53], v[54:55] neg_lo:[1,0,0] neg_hi:[1,0,0]
    v_pk_fma_f32 v[208:209], v[206:207], v[194:195], v[208:209] neg_lo:[1,0,0] neg_hi:[1,0,0]
    v_pk_fma_f32 v[56:57], v[60:61], v[50:51], v[56:57]
    v_pk_fma_f32 v[210:211], v[206:207], v[192:193], v[210:211]
    v_cvt_pk_bf16_f32 v70, v58, v59
    v_cvt_pk_bf16_f32 v71, v60, v61
    ds_write_b64 v40, v[70:71] offset:1632
    v_cvt_pk_bf16_f32 v72, v204, v205
    v_cvt_pk_bf16_f32 v73, v206, v207
    ds_write_b64 v40, v[72:73] offset:10880
    v_pk_mul_f32 v[58:59], v[54:55], v[50:51]
    v_pk_mul_f32 v[212:213], v[208:209], v[192:193]
    v_pk_mul_f32 v[60:61], v[54:55], v[52:53]
    v_pk_mul_f32 v[214:215], v[208:209], v[194:195]
    v_pk_fma_f32 v[58:59], v[56:57], v[52:53], v[58:59] neg_lo:[1,0,0] neg_hi:[1,0,0]
    v_pk_fma_f32 v[212:213], v[210:211], v[194:195], v[212:213] neg_lo:[1,0,0] neg_hi:[1,0,0]
    v_pk_fma_f32 v[60:61], v[56:57], v[50:51], v[60:61]
    v_pk_fma_f32 v[214:215], v[210:211], v[192:193], v[214:215]
    v_cvt_pk_bf16_f32 v74, v54, v55
    v_cvt_pk_bf16_f32 v75, v56, v57
    ds_write_b64 v40, v[74:75] offset:2176
    v_cvt_pk_bf16_f32 v70, v208, v209
    v_cvt_pk_bf16_f32 v71, v210, v211
    ds_write_b64 v40, v[70:71] offset:11424
    v_pk_mul_f32 v[54:55], v[58:59], v[50:51]
    v_pk_mul_f32 v[216:217], v[212:213], v[192:193]
    v_pk_mul_f32 v[56:57], v[58:59], v[52:53]
    v_pk_mul_f32 v[218:219], v[212:213], v[194:195]
    v_pk_fma_f32 v[54:55], v[60:61], v[52:53], v[54:55] neg_lo:[1,0,0] neg_hi:[1,0,0]
    v_pk_fma_f32 v[216:217], v[214:215], v[194:195], v[216:217] neg_lo:[1,0,0] neg_hi:[1,0,0]
    v_pk_fma_f32 v[56:57], v[60:61], v[50:51], v[56:57]
    v_pk_fma_f32 v[218:219], v[214:215], v[192:193], v[218:219]
    v_cvt_pk_bf16_f32 v72, v58, v59
    v_cvt_pk_bf16_f32 v73, v60, v61
    ds_write_b64 v40, v[72:73] offset:2720
    v_cvt_pk_bf16_f32 v74, v212, v213
    v_cvt_pk_bf16_f32 v75, v214, v215
    ds_write_b64 v40, v[74:75] offset:11968
    v_pk_mul_f32 v[58:59], v[54:55], v[50:51]
    v_pk_mul_f32 v[220:221], v[216:217], v[192:193]
    v_pk_mul_f32 v[60:61], v[54:55], v[52:53]
    v_pk_mul_f32 v[222:223], v[216:217], v[194:195]
    v_pk_fma_f32 v[58:59], v[56:57], v[52:53], v[58:59] neg_lo:[1,0,0] neg_hi:[1,0,0]
    v_pk_fma_f32 v[220:221], v[218:219], v[194:195], v[220:221] neg_lo:[1,0,0] neg_hi:[1,0,0]
    v_pk_fma_f32 v[60:61], v[56:57], v[50:51], v[60:61]
    v_pk_fma_f32 v[222:223], v[218:219], v[192:193], v[222:223]
    v_cvt_pk_bf16_f32 v70, v54, v55
    v_cvt_pk_bf16_f32 v71, v56, v57
    ds_write_b64 v40, v[70:71] offset:3264
    v_cvt_pk_bf16_f32 v72, v216, v217
    v_cvt_pk_bf16_f32 v73, v218, v219
    ds_write_b64 v40, v[72:73] offset:12512
    v_pk_mul_f32 v[54:55], v[58:59], v[50:51]
    v_pk_mul_f32 v[224:225], v[220:221], v[192:193]
    v_pk_mul_f32 v[56:57], v[58:59], v[52:53]
    v_pk_mul_f32 v[226:227], v[220:221], v[194:195]
    v_pk_fma_f32 v[54:55], v[60:61], v[52:53], v[54:55] neg_lo:[1,0,0] neg_hi:[1,0,0]
    v_pk_fma_f32 v[224:225], v[222:223], v[194:195], v[224:225] neg_lo:[1,0,0] neg_hi:[1,0,0]
    v_pk_fma_f32 v[56:57], v[60:61], v[50:51], v[56:57]
    v_pk_fma_f32 v[226:227], v[222:223], v[192:193], v[226:227]
    v_cvt_pk_bf16_f32 v74, v58, v59
    v_cvt_pk_bf16_f32 v75, v60, v61
    ds_write_b64 v40, v[74:75] offset:3808
    v_cvt_pk_bf16_f32 v70, v220, v221
    v_cvt_pk_bf16_f32 v71, v222, v223
    ds_write_b64 v40, v[70:71] offset:13056
    v_pk_mul_f32 v[58:59], v[54:55], v[50:51]
    v_pk_mul_f32 v[228:229], v[224:225], v[192:193]
    v_pk_mul_f32 v[60:61], v[54:55], v[52:53]
    v_pk_mul_f32 v[230:231], v[224:225], v[194:195]
    v_pk_fma_f32 v[58:59], v[56:57], v[52:53], v[58:59] neg_lo:[1,0,0] neg_hi:[1,0,0]
    v_pk_fma_f32 v[228:229], v[226:227], v[194:195], v[228:229] neg_lo:[1,0,0] neg_hi:[1,0,0]
    v_pk_fma_f32 v[60:61], v[56:57], v[50:51], v[60:61]
    v_pk_fma_f32 v[230:231], v[226:227], v[192:193], v[230:231]
    v_cvt_pk_bf16_f32 v72, v54, v55
    v_cvt_pk_bf16_f32 v73, v56, v57
    ds_write_b64 v40, v[72:73] offset:4352
    v_cvt_pk_bf16_f32 v74, v224, v225
    v_cvt_pk_bf16_f32 v75, v226, v227
    ds_write_b64 v40, v[74:75] offset:13600
    v_pk_mul_f32 v[54:55], v[58:59], v[50:51]
    v_pk_mul_f32 v[232:233], v[228:229], v[192:193]
    v_pk_mul_f32 v[56:57], v[58:59], v[52:53]
    v_pk_mul_f32 v[234:235], v[228:229], v[194:195]
    v_pk_fma_f32 v[54:55], v[60:61], v[52:53], v[54:55] neg_lo:[1,0,0] neg_hi:[1,0,0]
    v_pk_fma_f32 v[232:233], v[230:231], v[194:195], v[232:233] neg_lo:[1,0,0] neg_hi:[1,0,0]
    v_pk_fma_f32 v[56:57], v[60:61], v[50:51], v[56:57]
    v_pk_fma_f32 v[234:235], v[230:231], v[192:193], v[234:235]
    v_cvt_pk_bf16_f32 v70, v58, v59
    v_cvt_pk_bf16_f32 v71, v60, v61
    ds_write_b64 v40, v[70:71] offset:4896
    v_cvt_pk_bf16_f32 v72, v228, v229
    v_cvt_pk_bf16_f32 v73, v230, v231
CH_A1:
PG2:
    s_cbranch_execz RT_A
    ds_write_b64 v40, v[72:73] offset:14144
    v_pk_mul_f32 v[58:59], v[54:55], v[50:51]
    v_pk_mul_f32 v[236:237], v[232:233], v[192:193]
    v_pk_mul_f32 v[60:61], v[54:55], v[52:53]
    v_pk_mul_f32 v[238:239], v[232:233], v[194:195]
    v_pk_fma_f32 v[58:59], v[56:57], v[52:53], v[58:59] neg_lo:[1,0,0] neg_hi:[1,0,0]
    v_pk_fma_f32 v[236:237], v[234:235], v[194:195], v[236:237] neg_lo:[1,0,0] neg_hi:[1,0,0]
    v_pk_fma_f32 v[60:61], v[56:57], v[50:51], v[60:61]
    v_pk_fma_f32 v[238:239], v[234:235], v[192:193], v[238:239]
    v_cvt_pk_bf16_f32 v74, v54, v55
    v_cvt_pk_bf16_f32 v75, v56, v57
    ds_write_b64 v40, v[74:75] offset:5440
    v_cvt_pk_bf16_f32 v70, v232, v233
    v_cvt_pk_bf16_f32 v71, v234, v235
    ds_write_b64 v40, v[70:71] offset:14688
    v_pk_mul_f32 v[54:55], v[58:59], v[50:51]
    v_pk_mul_f32 v[240:241], v[236:237], v[192:193]
    v_pk_mul_f32 v[56:57], v[58:59], v[52:53]
    v_pk_mul_f32 v[242:243], v[236:237], v[194:195]
    v_pk_fma_f32 v[54:55], v[60:61], v[52:53], v[54:55] neg_lo:[1,0,0] neg_hi:[1,0,0]
    v_pk_fma_f32 v[240:241], v[238:239], v[194:195], v[240:241] neg_lo:[1,0,0] neg_hi:[1,0,0]
    v_pk_fma_f32 v[56:57], v[60:61], v[50:51], v[56:57]
    v_pk_fma_f32 v[242:243], v[238:239], v[192:193], v[242:243]
    v_cvt_pk_bf16_f32 v72, v58, v59
    v_cvt_pk_bf16_f32 v73, v60, v61
    ds_write_b64 v40, v[72:73] offset:5984
    v_cvt_pk_bf16_f32 v74, v236, v237
    v_cvt_pk_bf16_f32 v75, v238, v239
    ds_write_b64 v40, v[74:75] offset:15232
    v_pk_mul_f32 v[58:59], v[54:55], v[50:51]
    v_pk_mul_f32 v[244:245], v[240:241], v[192:193]
    v_pk_mul_f32 v[60:61], v[54:55], v[52:53]
    v_pk_mul_f32 v[246:247], v[240:241], v[194:195]
    v_pk_fma_f32 v[58:59], v[56:57], v[52:53], v[58:59] neg_lo:[1,0,0] neg_hi:[1,0,0]
    v_pk_fma_f32 v[244:245], v[242:243], v[194:195], v[244:245] neg_lo:[1,0,0] neg_hi:[1,0,0]
    v_pk_fma_f32 v[60:61], v[56:57], v[50:51], v[60:61]
    v_pk_fma_f32 v[246:247], v[242:243], v[192:193], v[246:247]
    v_cvt_pk_bf16_f32 v70, v54, v55
    v_cvt_pk_bf16_f32 v71, v56, v57
    ds_write_b64 v40, v[70:71] offset:6528
    v_cvt_pk_bf16_f32 v72, v240, v241
    v_cvt_pk_bf16_f32 v73, v242, v243
    ds_write_b64 v40, v[72:73] offset:15776
    v_pk_mul_f32 v[54:55], v[58:59], v[50:51]
    v_pk_mul_f32 v[248:249], v[244:245], v[192:193]
    v_pk_mul_f32 v[56:57], v[58:59], v[52:53]
    v_pk_mul_f32 v[250:251], v[244:245], v[194:195]
    v_pk_fma_f32 v[54:55], v[60:61], v[52:53], v[54:55] neg_lo:[1,0,0] neg_hi:[1,0,0]
    v_pk_fma_f32 v[248:249], v[246:247], v[194:195], v[248:249] neg_lo:[1,0,0] neg_hi:[1,0,0]
    v_pk_fma_f32 v[56:57], v[60:61], v[50:51], v[56:57]
    v_pk_fma_f32 v[250:251], v[246:247], v[192:193], v[250:251]
    v_cvt_pk_bf16_f32 v74, v58, v59
    v_cvt_pk_bf16_f32 v75, v60, v61
    ds_write_b64 v40, v[74:75] offset:7072
    v_cvt_pk_bf16_f32 v70, v244, v245
    v_cvt_pk_bf16_f32 v71, v246, v247
    ds_write_b64 v40, v[70:71] offset:16320
    v_pk_mul_f32 v[58:59], v[54:55], v[50:51]
    v_pk_mul_f32 v[252:253], v[248:249], v[192:193]
    v_pk_mul_f32 v[60:61], v[54:55], v[52:53]
    v_pk_mul_f32 v[254:255], v[248:249], v[194:195]
    v_pk_fma_f32 v[58:59], v[56:57], v[52:53], v[58:59] neg_lo:[1,0,0] neg_hi:[1,0,0]
    v_pk_fma_f32 v[252:253], v[250:251], v[194:195], v[252:253] neg_lo:[1,0,0] neg_hi:[1,0,0]
    v_pk_fma_f32 v[60:61], v[56:57], v[50:51], v[60:61]
    v_pk_fma_f32 v[254:255], v[250:251], v[192:193], v[254:255]
    v_cvt_pk_bf16_f32 v72, v54, v55
    v_cvt_pk_bf16_f32 v73, v56, v57
    ds_write_b64 v40, v[72:73] offset:7616
    v_cvt_pk_bf16_f32 v74, v248, v249
    v_cvt_pk_bf16_f32 v75, v250, v251
    ds_write_b64 v40, v[74:75] offset:16864
    v_cvt_pk_bf16_f32 v70, v58, v59
    v_cvt_pk_bf16_f32 v71, v60, v61
    ds_write_b64 v40, v[70:71] offset:8160
    ds_read_b128 v[108:111], v41 offset:0
    ds_read_b128 v[112:115], v41 offset:64
    ds_read_b128 v[116:119], v41 offset:128
    ds_read_b128 v[120:123], v41 offset:192
    ds_read_b128 v[124:127], v41 offset:256
    ds_read_b128 v[128:131], v41 offset:320
    ds_read_b128 v[132:135], v41 offset:384
    ds_read_b128 v[136:139], v41 offset:448
    ds_read_b128 v[140:143], v41 offset:8704
    ds_read_b128 v[144:147], v41 offset:8768
    ds_read_b128 v[148:151], v41 offset:8832
    ds_read_b128 v[152:155], v41 offset:8896
    ds_read_b128 v[156:159], v41 offset:8960
    ds_read_b128 v[160:163], v41 offset:9024
    ds_read_b128 v[164:167], v41 offset:9088
    ds_read_b128 v[168:171], v41 offset:9152
    v_mov_b32 v50, v66
    v_mov_b32 v51, v67
    v_mov_b32 v52, v68
    v_mov_b32 v53, v69
    v_cvt_pk_bf16_f32 v72, v66, v67
    v_cvt_pk_bf16_f32 v73, v68, v69
    ds_write_b64 v40, v[72:73] offset:0
    v_pk_mul_f32 v[58:59], v[66:67], v[196:197]
    v_pk_mul_f32 v[60:61], v[66:67], v[198:199]
    v_pk_fma_f32 v[58:59], v[68:69], v[198:199], v[58:59] neg_lo:[1,0,0] neg_hi:[1,0,0]
    v_pk_fma_f32 v[60:61], v[68:69], v[196:197], v[60:61]
    v_cvt_pk_bf16_f32 v74, v58, v59
    v_cvt_pk_bf16_f32 v75, v60, v61
    ds_write_b64 v40, v[74:75] offset:544
    v_pk_mul_f32 v[54:55], v[66:67], v[204:205]
    v_pk_mul_f32 v[56:57], v[66:67], v[206:207]
    v_pk_fma_f32 v[54:55], v[68:69], v[206:207], v[54:55] neg_lo:[1,0,0] neg_hi:[1,0,0]
    v_pk_fma_f32 v[56:57], v[68:69], v[204:205], v[56:57]
    v_cvt_pk_bf16_f32 v70, v54, v55
    v_cvt_pk_bf16_f32 v71, v56, v57
    ds_write_b64 v40, v[70:71] offset:1088
    v_pk_mul_f32 v[58:59], v[66:67], v[212:213]
    v_pk_mul_f32 v[60:61], v[66:67], v[214:215]
    v_pk_fma_f32 v[58:59], v[68:69], v[214:215], v[58:59] neg_lo:[1,0,0] neg_hi:[1,0,0]
    v_pk_fma_f32 v[60:61], v[68:69], v[212:213], v[60:61]
    v_cvt_pk_bf16_f32 v72, v58, v59
    v_cvt_pk_bf16_f32 v73, v60, v61
    ds_write_b64 v40, v[72:73] offset:1632
    v_pk_mul_f32 v[54:55], v[66:67], v[220:221]
    v_pk_mul_f32 v[56:57], v[66:67], v[222:223]
    v_pk_fma_f32 v[54:55], v[68:69], v[222:223], v[54:55] neg_lo:[1,0,0] neg_hi:[1,0,0]
    v_pk_fma_f32 v[56:57], v[68:69], v[220:221], v[56:57]
    v_cvt_pk_bf16_f32 v74, v54, v55
    v_cvt_pk_bf16_f32 v75, v56, v57
    ds_write_b64 v40, v[74:75] offset:2176
    v_pk_mul_f32 v[58:59], v[66:67], v[228:229]
    v_pk_mul_f32 v[60:61], v[66:67], v[230:231]
    v_pk_fma_f32 v[58:59], v[68:69], v[230:231], v[58:59] neg_lo:[1,0,0] neg_hi:[1,0,0]
    v_pk_fma_f32 v[60:61], v[68:69], v[228:229], v[60:61]
    v_cvt_pk_bf16_f32 v70, v58, v59
    v_cvt_pk_bf16_f32 v71, v60, v61
    ds_write_b64 v40, v[70:71] offset:2720
    v_pk_mul_f32 v[54:55], v[66:67], v[236:237]
    v_pk_mul_f32 v[56:57], v[66:67], v[238:239]
    v_pk_fma_f32 v[54:55], v[68:69], v[238:239], v[54:55] neg_lo:[1,0,0] neg_hi:[1,0,0]
    v_pk_fma_f32 v[56:57], v[68:69], v[236:237], v[56:57]
    v_cvt_pk_bf16_f32 v72, v54, v55
    v_cvt_pk_bf16_f32 v73, v56, v57
    ds_write_b64 v40, v[72:73] offset:3264
    v_pk_mul_f32 v[58:59], v[66:67], v[244:245]
    v_pk_mul_f32 v[60:61], v[66:67], v[246:247]
    v_pk_fma_f32 v[58:59], v[68:69], v[246:247], v[58:59] neg_lo:[1,0,0] neg_hi:[1,0,0]
    v_pk_fma_f32 v[60:61], v[68:69], v[244:245], v[60:61]
    v_cvt_pk_bf16_f32 v74, v58, v59
    v_cvt_pk_bf16_f32 v75, v60, v61
    ds_write_b64 v40, v[74:75] offset:3808
    v_pk_mul_f32 v[54:55], v[66:67], v[252:253]
    v_pk_mul_f32 v[56:57], v[66:67], v[254:255]
    v_pk_fma_f32 v[54:55], v[68:69], v[254:255], v[54:55] neg_lo:[1,0,0] neg_hi:[1,0,0]
    v_pk_fma_f32 v[56:57], v[68:69], v[252:253], v[56:57]
    v_cvt_pk_bf16_f32 v70, v54, v55
    v_cvt_pk_bf16_f32 v71, v56, v57
    ds_write_b64 v40, v[70:71] offset:4352
    ds_read_b128 v[172:175], v42 offset:0
    s_waitcnt lgkmcnt(15)
    v_mfma_f32_16x16x32_bf16 v[76:79], v[140:143], v[108:111], 0
    v_pk_mul_f32 v[62:63], v[66:67], v[50:51]
    v_pk_mul_f32 v[64:65], v[66:67], v[52:53]
    v_pk_fma_f32 v[62:63], v[68:69], v[52:53], v[62:63] neg_lo:[1,0,0] neg_hi:[1,0,0]
    v_pk_fma_f32 v[64:65], v[68:69], v[50:51], v[64:65]
    v_cvt_pk_bf16_f32 v72, v62, v63
    ds_read_b128 v[176:179], v42 offset:64
    v_mfma_f32_16x16x32_bf16 v[76:79], v[144:147], v[112:115], v[76:79]
    v_cvt_pk_bf16_f32 v73, v64, v65
    ds_write_b64 v40, v[72:73] offset:4896
    v_pk_mul_f32 v[58:59], v[62:63], v[204:205]
    v_pk_mul_f32 v[60:61], v[62:63], v[206:207]
    v_pk_fma_f32 v[58:59], v[64:65], v[206:207], v[58:59] neg_lo:[1,0,0] neg_hi:[1,0,0]
    ds_read_b128 v[180:183], v42 offset:128
    v_mfma_f32_16x16x32_bf16 v[76:79], v[148:151], v[116:119], v[76:79]
    v_pk_fma_f32 v[60:61], v[64:65], v[204:205], v[60:61]
    v_cvt_pk_bf16_f32 v74, v58, v59
    v_cvt_pk_bf16_f32 v75, v60, v61
    ds_write_b64 v40, v[74:75] offset:5440
    v_pk_mul_f32 v[54:55], v[62:63], v[220:221]
    ds_read_b128 v[184:187], v42 offset:192
    s_waitcnt lgkmcnt(15)
    v_mfma_f32_16x16x32_bf16 v[76:79], v[152:155], v[120:123], v[76:79]
    v_pk_mul_f32 v[56:57], v[62:63], v[222:223]
    v_pk_fma_f32 v[54:55], v[64:65], v[222:223], v[54:55] neg_lo:[1,0,0] neg_hi:[1,0,0]
    v_pk_fma_f32 v[56:57], v[64:65], v[220:221], v[56:57]
    v_cvt_pk_bf16_f32 v70, v54, v55
    v_cvt_pk_bf16_f32 v71, v56, v57
    v_mfma_f32_16x16x32_bf16 v[76:79], v[156:159], v[124:127], v[76:79]
    ds_read_b128 v[140:143], v42 offset:256
    ds_write_b64 v40, v[70:71] offset:5984
    v_pk_mul_f32 v[58:59], v[62:63], v[236:237]
    v_pk_mul_f32 v[60:61], v[62:63], v[238:239]
    v_pk_fma_f32 v[58:59], v[64:65], v[238:239], v[58:59] neg_lo:[1,0,0] neg_hi:[1,0,0]
    v_pk_fma_f32 v[60:61], v[64:65], v[236:237], v[60:61]
    v_mfma_f32_16x16x32_bf16 v[76:79], v[160:163], v[128:131], v[76:79]
    ds_read_b128 v[144:147], v42 offset:320
    v_cvt_pk_bf16_f32 v72, v58, v59
    v_cvt_pk_bf16_f32 v73, v60, v61
    ds_write_b64 v40, v[72:73] offset:6528
    v_pk_mul_f32 v[54:55], v[62:63], v[252:253]
    v_pk_mul_f32 v[56:57], v[62:63], v[254:255]
    v_mfma_f32_16x16x32_bf16 v[76:79], v[164:167], v[132:135], v[76:79]
    ds_read_b128 v[148:151], v42 offset:384
    v_pk_fma_f32 v[54:55], v[64:65], v[254:255], v[54:55] neg_lo:[1,0,0] neg_hi:[1,0,0]
    v_pk_fma_f32 v[56:57], v[64:65], v[252:253], v[56:57]
    v_cvt_pk_bf16_f32 v74, v54, v55
    v_cvt_pk_bf16_f32 v75, v56, v57
    ds_write_b64 v40, v[74:75] offset:7072
    v_mfma_f32_16x16x32_bf16 v[76:79], v[168:171], v[136:139], v[76:79]
    ds_read_b128 v[152:155], v42 offset:448
    ds_read_b128 v[156:159], v43 offset:4896
    s_waitcnt lgkmcnt(13)
    v_mfma_f32_16x16x32_bf16 v[80:83], v[172:175], v[108:111], 0
    v_pk_mul_f32 v[66:67], v[62:63], v[50:51]
    v_pk_mul_f32 v[68:69], v[62:63], v[52:53]
    v_pk_fma_f32 v[66:67], v[64:65], v[52:53], v[66:67] neg_lo:[1,0,0] neg_hi:[1,0,0]
    v_pk_fma_f32 v[68:69], v[64:65], v[50:51], v[68:69]
    v_cvt_pk_bf16_f32 v70, v66, v67
    ds_read_b128 v[160:163], v43 offset:4960
    s_waitcnt lgkmcnt(13)
    v_mfma_f32_16x16x32_bf16 v[80:83], v[176:179], v[112:115], v[80:83]
    v_cvt_pk_bf16_f32 v71, v68, v69
    ds_write_b64 v40, v[70:71] offset:7616
    v_pk_mul_f32 v[58:59], v[66:67], v[204:205]
    v_pk_mul_f32 v[60:61], v[66:67], v[206:207]
    v_pk_fma_f32 v[58:59], v[68:69], v[206:207], v[58:59] neg_lo:[1,0,0] neg_hi:[1,0,0]
    ds_read_b128 v[164:167], v43 offset:5024
    s_waitcnt lgkmcnt(13)
    v_mfma_f32_16x16x32_bf16 v[80:83], v[180:183], v[116:119], v[80:83]
    v_pk_fma_f32 v[60:61], v[68:69], v[204:205], v[60:61]
    v_cvt_pk_bf16_f32 v72, v58, v59
    v_cvt_pk_bf16_f32 v73, v60, v61
    ds_write_b64 v40, v[72:73] offset:8160
    v_pk_mul_f32 v[54:55], v[66:67], v[220:221]
    ds_read_b128 v[168:171], v43 offset:5088
    s_waitcnt lgkmcnt(13)
    v_mfma_f32_16x16x32_bf16 v[80:83], v[184:187], v[120:123], v[80:83]
    v_pk_mul_f32 v[56:57], v[66:67], v[222:223]
    v_pk_fma_f32 v[54:55], v[68:69], v[222:223], v[54:55] neg_lo:[1,0,0] neg_hi:[1,0,0]
    v_pk_fma_f32 v[56:57], v[68:69], v[220:221], v[56:57]
    v_cvt_pk_bf16_f32 v74, v54, v55
    v_cvt_pk_bf16_f32 v75, v56, v57
    s_waitcnt lgkmcnt(12)
    v_mfma_f32_16x16x32_bf16 v[80:83], v[140:143], v[124:127], v[80:83]
    ds_read_b128 v[172:175], v43 offset:5152
    ds_write_b64 v40, v[74:75] offset:8704
    v_pk_mul_f32 v[58:59], v[66:67], v[236:237]
    v_pk_mul_f32 v[60:61], v[66:67], v[238:239]
    v_pk_fma_f32 v[58:59], v[68:69], v[238:239], v[58:59] neg_lo:[1,0,0] neg_hi:[1,0,0]
    v_pk_fma_f32 v[60:61], v[68:69], v[236:237], v[60:61]
    s_waitcnt lgkmcnt(12)
    v_mfma_f32_16x16x32_bf16 v[80:83], v[144:147], v[128:131], v[80:83]
    ds_read_b128 v[176:179], v43 offset:5216
    v_cvt_pk_bf16_f32 v70, v58, v59
    v_cvt_pk_bf16_f32 v71, v60, v61
    ds_write_b64 v40, v[70:71] offset:9248
    v_pk_mul_f32 v[54:55], v[66:67], v[252:253]
    v_pk_mul_f32 v[56:57], v[66:67], v[254:255]
    s_waitcnt lgkmcnt(12)
    v_mfma_f32_16x16x32_bf16 v[80:83], v[148:151], v[132:135], v[80:83]
    ds_read_b128 v[180:183], v43 offset:5280
    v_pk_fma_f32 v[54:55], v[68:69], v[254:255], v[54:55] neg_lo:[1,0,0] neg_hi:[1,0,0]
    v_pk_fma_f32 v[56:57], v[68:69], v[252:253], v[56:57]
    v_cvt_pk_bf16_f32 v72, v54, v55
    v_cvt_pk_bf16_f32 v73, v56, v57
    ds_write_b64 v40, v[72:73] offset:9792
    s_waitcnt lgkmcnt(12)
    v_mfma_f32_16x16x32_bf16 v[80:83], v[152:155], v[136:139], v[80:83]
    ds_read_b128 v[184:187], v43 offset:5344
    ds_read_b128 v[140:143], v43 offset:7616
    s_waitcnt lgkmcnt(13)
    v_mfma_f32_16x16x32_bf16 v[84:87], v[156:159], v[108:111], 0
    v_pk_mul_f32 v[62:63], v[66:67], v[50:51]
    v_pk_mul_f32 v[64:65], v[66:67], v[52:53]
    v_pk_fma_f32 v[62:63], v[68:69], v[52:53], v[62:63] neg_lo:[1,0,0] neg_hi:[1,0,0]
    ds_read_b128 v[144:147], v43 offset:7680
    s_waitcnt lgkmcnt(13)
    v_mfma_f32_16x16x32_bf16 v[84:87], v[160:163], v[112:115], v[84:87]
    v_pk_fma_f32 v[64:65], v[68:69], v[50:51], v[64:65]
    v_cvt_pk_bf16_f32 v74, v62, v63
    v_cvt_pk_bf16_f32 v75, v64, v65
    ds_read_b128 v[148:151], v43 offset:7744
    s_waitcnt lgkmcnt(12)
    v_mfma_f32_16x16x32_bf16 v[84:87], v[164:167], v[116:119], v[84:87]
    ds_write_b64 v40, v[74:75] offset:10336
    v_pk_mul_f32 v[58:59], v[62:63], v[220:221]
    v_pk_mul_f32 v[60:61], v[62:63], v[222:223]
    ds_read_b128 v[152:155], v43 offset:7808
    s_waitcnt lgkmcnt(12)
    v_mfma_f32_16x16x32_bf16 v[84:87], v[168:171], v[120:123], v[84:87]
    v_pk_fma_f32 v[58:59], v[64:65], v[222:223], v[58:59] neg_lo:[1,0,0] neg_hi:[1,0,0]
    v_pk_fma_f32 v[60:61], v[64:65], v[220:221], v[60:61]
    v_cvt_pk_bf16_f32 v70, v58, v59
    s_waitcnt lgkmcnt(11)
    v_mfma_f32_16x16x32_bf16 v[84:87], v[172:175], v[124:127], v[84:87]
    ds_read_b128 v[156:159], v43 offset:7872
    v_cvt_pk_bf16_f32 v71, v60, v61
    ds_write_b64 v40, v[70:71] offset:10880
    v_pk_mul_f32 v[54:55], v[62:63], v[252:253]
    s_waitcnt lgkmcnt(11)
    v_mfma_f32_16x16x32_bf16 v[84:87], v[176:179], v[128:131], v[84:87]
    ds_read_b128 v[160:163], v43 offset:7936
    v_pk_mul_f32 v[56:57], v[62:63], v[254:255]
    v_pk_fma_f32 v[54:55], v[64:65], v[254:255], v[54:55] neg_lo:[1,0,0] neg_hi:[1,0,0]
    v_pk_fma_f32 v[56:57], v[64:65], v[252:253], v[56:57]
    s_waitcnt lgkmcnt(10)
    v_mfma_f32_16x16x32_bf16 v[84:87], v[180:183], v[132:135], v[84:87]
    ds_read_b128 v[164:167], v43 offset:8000
    v_cvt_pk_bf16_f32 v72, v54, v55
    v_cvt_pk_bf16_f32 v73, v56, v57
    ds_write_b64 v40, v[72:73] offset:11424
    s_waitcnt lgkmcnt(10)
    v_mfma_f32_16x16x32_bf16 v[84:87], v[184:187], v[136:139], v[84:87]
    ds_read_b128 v[168:171], v43 offset:8064
    ds_read_b128 v[172:175], v44 offset:10336
    s_waitcnt lgkmcnt(11)
    v_mfma_f32_16x16x32_bf16 v[88:91], v[140:143], v[108:111], 0
    v_pk_mul_f32 v[66:67], v[62:63], v[50:51]
    v_pk_mul_f32 v[68:69], v[62:63], v[52:53]
    v_pk_fma_f32 v[66:67], v[64:65], v[52:53], v[66:67] neg_lo:[1,0,0] neg_hi:[1,0,0]
    ds_read_b128 v[176:179], v44 offset:10400
    s_waitcnt lgkmcnt(11)
    v_mfma_f32_16x16x32_bf16 v[88:91], v[144:147], v[112:115], v[88:91]
    v_pk_fma_f32 v[68:69], v[64:65], v[50:51], v[68:69]
    v_cvt_pk_bf16_f32 v74, v66, v67
    v_cvt_pk_bf16_f32 v75, v68, v69
    ds_read_b128 v[180:183], v44 offset:10464
    s_waitcnt lgkmcnt(11)
    v_mfma_f32_16x16x32_bf16 v[88:91], v[148:151], v[116:119], v[88:91]
    ds_write_b64 v40, v[74:75] offset:11968
    v_pk_mul_f32 v[58:59], v[66:67], v[220:221]
    v_pk_mul_f32 v[60:61], v[66:67], v[222:223]
    ds_read_b128 v[184:187], v44 offset:10528
    s_waitcnt lgkmcnt(11)
    v_mfma_f32_16x16x32_bf16 v[88:91], v[152:155], v[120:123], v[88:91]
    v_pk_fma_f32 v[58:59], v[68:69], v[222:223], v[58:59] neg_lo:[1,0,0] neg_hi:[1,0,0]
    v_pk_fma_f32 v[60:61], v[68:69], v[220:221], v[60:61]
    v_cvt_pk_bf16_f32 v70, v58, v59
    s_waitcnt lgkmcnt(10)
    v_mfma_f32_16x16x32_bf16 v[88:91], v[156:159], v[124:127], v[88:91]
    ds_read_b128 v[140:143], v44 offset:10592
    v_cvt_pk_bf16_f32 v71, v60, v61
    ds_write_b64 v40, v[70:71] offset:12512
    v_pk_mul_f32 v[54:55], v[66:67], v[252:253]
    s_waitcnt lgkmcnt(10)
    v_mfma_f32_16x16x32_bf16 v[88:91], v[160:163], v[128:131], v[88:91]
    ds_read_b128 v[144:147], v44 offset:10656
    v_pk_mul_f32 v[56:57], v[66:67], v[254:255]
    v_pk_fma_f32 v[54:55], v[68:69], v[254:255], v[54:55] neg_lo:[1,0,0] neg_hi:[1,0,0]
    v_pk_fma_f32 v[56:57], v[68:69], v[252:253], v[56:57]
    s_waitcnt lgkmcnt(10)
    v_mfma_f32_16x16x32_bf16 v[88:91], v[164:167], v[132:135], v[88:91]
    ds_read_b128 v[148:151], v44 offset:10720
    v_cvt_pk_bf16_f32 v72, v54, v55
    v_cvt_pk_bf16_f32 v73, v56, v57
    ds_write_b64 v40, v[72:73] offset:13056
    s_waitcnt lgkmcnt(10)
    v_mfma_f32_16x16x32_bf16 v[88:91], v[168:171], v[136:139], v[88:91]
    ds_read_b128 v[152:155], v44 offset:10784
    ds_read_b128 v[156:159], v44 offset:11968
    s_waitcnt lgkmcnt(11)
    v_mfma_f32_16x16x32_bf16 v[92:95], v[172:175], v[108:111], 0
    v_pk_mul_f32 v[62:63], v[66:67], v[50:51]
    v_pk_mul_f32 v[64:65], v[66:67], v[52:53]
    v_pk_fma_f32 v[62:63], v[68:69], v[52:53], v[62:63] neg_lo:[1,0,0] neg_hi:[1,0,0]
    ds_read_b128 v[160:163], v44 offset:12032
    s_waitcnt lgkmcnt(11)
    v_mfma_f32_16x16x32_bf16 v[92:95], v[176:179], v[112:115], v[92:95]
    v_pk_fma_f32 v[64:65], v[68:69], v[50:51], v[64:65]
    v_cvt_pk_bf16_f32 v74, v62, v63
    v_cvt_pk_bf16_f32 v75, v64, v65
    ds_read_b128 v[164:167], v44 offset:12096
    s_waitcnt lgkmcnt(11)
    v_mfma_f32_16x16x32_bf16 v[92:95], v[180:183], v[116:119], v[92:95]
    ds_write_b64 v40, v[74:75] offset:13600
    v_pk_mul_f32 v[58:59], v[62:63], v[220:221]
    v_pk_mul_f32 v[60:61], v[62:63], v[222:223]
    ds_read_b128 v[168:171], v44 offset:12160
    s_waitcnt lgkmcnt(11)
    v_mfma_f32_16x16x32_bf16 v[92:95], v[184:187], v[120:123], v[92:95]
    v_pk_fma_f32 v[58:59], v[64:65], v[222:223], v[58:59] neg_lo:[1,0,0] neg_hi:[1,0,0]
    v_pk_fma_f32 v[60:61], v[64:65], v[220:221], v[60:61]
    v_cvt_pk_bf16_f32 v70, v58, v59
    s_waitcnt lgkmcnt(10)
    v_mfma_f32_16x16x32_bf16 v[92:95], v[140:143], v[124:127], v[92:95]
    ds_read_b128 v[172:175], v44 offset:12224
    v_cvt_pk_bf16_f32 v71, v60, v61
    ds_write_b64 v40, v[70:71] offset:14144
    v_pk_mul_f32 v[54:55], v[62:63], v[252:253]
    s_waitcnt lgkmcnt(10)
    v_mfma_f32_16x16x32_bf16 v[92:95], v[144:147], v[128:131], v[92:95]
    ds_read_b128 v[176:179], v44 offset:12288
    v_pk_mul_f32 v[56:57], v[62:63], v[254:255]
    v_pk_fma_f32 v[54:55], v[64:65], v[254:255], v[54:55] neg_lo:[1,0,0] neg_hi:[1,0,0]
    v_pk_fma_f32 v[56:57], v[64:65], v[252:253], v[56:57]
    s_waitcnt lgkmcnt(10)
    v_mfma_f32_16x16x32_bf16 v[92:95], v[148:151], v[132:135], v[92:95]
    ds_read_b128 v[180:183], v44 offset:12352
    v_cvt_pk_bf16_f32 v72, v54, v55
    v_cvt_pk_bf16_f32 v73, v56, v57
    ds_write_b64 v40, v[72:73] offset:14688
    s_waitcnt lgkmcnt(10)
    v_mfma_f32_16x16x32_bf16 v[92:95], v[152:155], v[136:139], v[92:95]
    ds_read_b128 v[184:187], v44 offset:12416
    ds_read_b128 v[140:143], v44 offset:13600
    s_waitcnt lgkmcnt(11)
    v_mfma_f32_16x16x32_bf16 v[96:99], v[156:159], v[108:111], 0
    v_pk_mul_f32 v[66:67], v[62:63], v[50:51]
    v_pk_mul_f32 v[68:69], v[62:63], v[52:53]
    v_pk_fma_f32 v[66:67], v[64:65], v[52:53], v[66:67] neg_lo:[1,0,0] neg_hi:[1,0,0]
    ds_read_b128 v[144:147], v44 offset:13664
    s_waitcnt lgkmcnt(11)
    v_mfma_f32_16x16x32_bf16 v[96:99], v[160:163], v[112:115], v[96:99]
    v_pk_fma_f32 v[68:69], v[64:65], v[50:51], v[68:69]
    v_cvt_pk_bf16_f32 v74, v66, v67
    v_cvt_pk_bf16_f32 v75, v68, v69
    ds_read_b128 v[148:151], v44 offset:13728
    s_waitcnt lgkmcnt(11)
    v_mfma_f32_16x16x32_bf16 v[96:99], v[164:167], v[116:119], v[96:99]
    ds_write_b64 v40, v[74:75] offset:15232
    v_pk_mul_f32 v[58:59], v[66:67], v[220:221]
    v_pk_mul_f32 v[60:61], v[66:67], v[222:223]
    ds_read_b128 v[152:155], v44 offset:13792
    s_waitcnt lgkmcnt(11)
    v_mfma_f32_16x16x32_bf16 v[96:99], v[168:171], v[120:123], v[96:99]
    v_pk_fma_f32 v[58:59], v[68:69], v[222:223], v[58:59] neg_lo:[1,0,0] neg_hi:[1,0,0]
    v_pk_fma_f32 v[60:61], v[68:69], v[220:221], v[60:61]
    v_cvt_pk_bf16_f32 v70, v58, v59
    s_waitcnt lgkmcnt(10)
    v_mfma_f32_16x16x32_bf16 v[96:99], v[172:175], v[124:127], v[96:99]
    ds_read_b128 v[156:159], v44 offset:13856
    v_cvt_pk_bf16_f32 v71, v60, v61
    ds_write_b64 v40, v[70:71] offset:15776
    v_pk_mul_f32 v[54:55], v[66:67], v[252:253]
    s_waitcnt lgkmcnt(10)
    v_mfma_f32_16x16x32_bf16 v[96:99], v[176:179], v[128:131], v[96:99]
    ds_read_b128 v[160:163], v44 offset:13920
    v_pk_mul_f32 v[56:57], v[66:67], v[254:255]
    v_pk_fma_f32 v[54:55], v[68:69], v[254:255], v[54:55] neg_lo:[1,0,0] neg_hi:[1,0,0]
    v_pk_fma_f32 v[56:57], v[68:69], v[252:253], v[56:57]
    s_waitcnt lgkmcnt(10)
    v_mfma_f32_16x16x32_bf16 v[96:99], v[180:183], v[132:135], v[96:99]
    ds_read_b128 v[164:167], v44 offset:13984
    v_cvt_pk_bf16_f32 v72, v54, v55
    v_cvt_pk_bf16_f32 v73, v56, v57
    ds_write_b64 v40, v[72:73] offset:16320
    s_waitcnt lgkmcnt(10)
    v_mfma_f32_16x16x32_bf16 v[96:99], v[184:187], v[136:139], v[96:99]
    ds_read_b128 v[168:171], v44 offset:14048
    ds_read_b128 v[172:175], v44 offset:15232
    s_waitcnt lgkmcnt(11)
    v_mfma_f32_16x16x32_bf16 v[100:103], v[140:143], v[108:111], 0
    ds_read_b128 v[176:179], v44 offset:15296
    s_waitcnt lgkmcnt(11)
    v_mfma_f32_16x16x32_bf16 v[100:103], v[144:147], v[112:115], v[100:103]
    ds_read_b128 v[180:183], v44 offset:15360
    s_waitcnt lgkmcnt(11)
    v_mfma_f32_16x16x32_bf16 v[100:103], v[148:151], v[116:119], v[100:103]
    ds_read_b128 v[184:187], v44 offset:15424
    s_waitcnt lgkmcnt(10)
    v_mfma_f32_16x16x32_bf16 v[100:103], v[152:155], v[120:123], v[100:103]
    s_waitcnt lgkmcnt(9)
    v_mfma_f32_16x16x32_bf16 v[100:103], v[156:159], v[124:127], v[100:103]
    ds_read_b128 v[140:143], v44 offset:15488
    s_waitcnt lgkmcnt(8)
    v_mfma_f32_16x16x32_bf16 v[100:103], v[160:163], v[128:131], v[100:103]
    ds_read_b128 v[144:147], v44 offset:15552
    s_waitcnt lgkmcnt(8)
    v_mfma_f32_16x16x32_bf16 v[100:103], v[164:167], v[132:135], v[100:103]
    ds_read_b128 v[148:151], v44 offset:15616
    s_waitcnt lgkmcnt(7)
    v_mfma_f32_16x16x32_bf16 v[100:103], v[168:171], v[136:139], v[100:103]
    ds_read_b128 v[152:155], v44 offset:15680
    s_waitcnt lgkmcnt(7)
    v_mfma_f32_16x16x32_bf16 v[104:107], v[172:175], v[108:111], 0
    s_waitcnt lgkmcnt(6)
    v_mfma_f32_16x16x32_bf16 v[104:107], v[176:179], v[112:115], v[104:107]
    s_waitcnt lgkmcnt(5)
    v_mfma_f32_16x16x32_bf16 v[104:107], v[180:183], v[116:119], v[104:107]
    s_waitcnt lgkmcnt(4)
    v_mfma_f32_16x16x32_bf16 v[104:107], v[184:187], v[120:123], v[104:107]
    s_waitcnt lgkmcnt(3)
    v_mfma_f32_16x16x32_bf16 v[104:107], v[140:143], v[124:127], v[104:107]
    s_waitcnt lgkmcnt(2)
    v_mfma_f32_16x16x32_bf16 v[104:107], v[144:147], v[128:131], v[104:107]
    s_waitcnt lgkmcnt(1)
    v_mfma_f32_16x16x32_bf16 v[104:107], v[148:151], v[132:135], v[104:107]
    s_waitcnt lgkmcnt(0)
    v_mfma_f32_16x16x32_bf16 v[104:107], v[152:155], v[136:139], v[104:107]
    v_add_f32 v76, v76, v45
    v_and_b32 v188, 15, v1
    v_bfe_u32 v189, v1, 4, 1
    v_lshrrev_b32 v190, 5, v1
    v_lshlrev_b32 v188, 5, v188
    v_lshl_add_u32 v188, v189, 9, v188
    v_lshl_add_u32 v188, v190, 4, v188
    v_add_u32 v188, s4, v188
    v_lshl_add_u32 v189, v1, 4, s4
    v_bfe_u32 v190, v1, 1, 2
    v_mul_u32_u24 v190, 4160, v190
    v_and_b32 v191, 1, v1
    v_lshl_add_u32 v190, v191, 4, v190
    v_add_u32 v190, s4, v190
    v_cmp_gt_u32 vcc, 32, v1
    v_add_u32 v191, 16640, v189
    v_mov_b32 v192, 0
    v_mov_b32 v193, 0
    v_mov_b32 v194, 0
    v_mov_b32 v195, 0
    v_cndmask_b32 v190, v190, v191, vcc
    ds_write_b128 v190, v[192:195]
    v_cvt_pk_bf16_f32 v108, v76, v77
    v_cvt_pk_bf16_f32 v109, v78, v79
    v_cvt_pk_bf16_f32 v110, v80, v81
    v_cvt_pk_bf16_f32 v111, v82, v83
    s_nop 0
    v_permlane16_swap_b32 v108, v110
    v_permlane16_swap_b32 v109, v111
    ds_write_b128 v188, v[108:111] offset:32
    v_cvt_pk_bf16_f32 v112, v84, v85
    v_cvt_pk_bf16_f32 v113, v86, v87
    v_cvt_pk_bf16_f32 v114, v88, v89
    v_cvt_pk_bf16_f32 v115, v90, v91
    s_nop 0
    v_permlane16_swap_b32 v112, v114
    v_permlane16_swap_b32 v113, v115
    ds_write_b128 v188, v[112:115] offset:1056
    v_cvt_pk_bf16_f32 v116, v92, v93
    v_cvt_pk_bf16_f32 v117, v94, v95
    v_cvt_pk_bf16_f32 v118, v96, v97
    v_cvt_pk_bf16_f32 v119, v98, v99
    s_nop 0
    v_permlane16_swap_b32 v116, v118
    v_permlane16_swap_b32 v117, v119
    ds_write_b128 v188, v[116:119] offset:2080
    v_cvt_pk_bf16_f32 v120, v100, v101
    v_cvt_pk_bf16_f32 v121, v102, v103
    v_cvt_pk_bf16_f32 v122, v104, v105
    v_cvt_pk_bf16_f32 v123, v106, v107
    s_nop 0
    v_permlane16_swap_b32 v120, v122
    v_permlane16_swap_b32 v121, v123
    ds_write_b128 v188, v[120:123] offset:3104
    ds_read_b64 v[142:143], v189 offset:24
    ds_read_b128 v[144:147], v189 offset:32
    ds_read_b64 v[150:151], v189 offset:1048
    ds_read_b128 v[152:155], v189 offset:1056
    ds_read_b64 v[158:159], v189 offset:2072
    ds_read_b128 v[160:163], v189 offset:2080
    ds_read_b64 v[166:167], v189 offset:3096
    ds_read_b128 v[168:171], v189 offset:3104
    s_waitcnt lgkmcnt(6)
    v_alignbit_b32 v76, v144, v143, 16
    v_alignbit_b32 v77, v145, v144, 16
    v_alignbit_b32 v78, v146, v145, 16
    v_alignbit_b32 v79, v147, v146, 16
    ds_write_b128 v189, v[76:79] offset:4192
    v_mov_b32 v80, v143
    v_mov_b32 v81, v144
    v_mov_b32 v82, v145
    v_mov_b32 v83, v146
    ds_write_b128 v189, v[80:83] offset:8352
CH_A2:
PG3:
    s_cbranch_execz RT_A
    v_alignbit_b32 v84, v143, v142, 16
    v_alignbit_b32 v85, v144, v143, 16
    v_alignbit_b32 v86, v145, v144, 16
    v_alignbit_b32 v87, v146, v145, 16
    ds_write_b128 v189, v[84:87] offset:12512
    s_waitcnt lgkmcnt(7)
    v_alignbit_b32 v88, v152, v151, 16
    v_alignbit_b32 v89, v153, v152, 16
    v_alignbit_b32 v90, v154, v153, 16
    v_alignbit_b32 v91, v155, v154, 16
    ds_write_b128 v189, v[88:91] offset:5216
    v_mov_b32 v92, v151
    v_mov_b32 v93, v152
    v_mov_b32 v94, v153
    v_mov_b32 v95, v154
    ds_write_b128 v189, v[92:95] offset:9376
    v_alignbit_b32 v96, v151, v150, 16
    v_alignbit_b32 v97, v152, v151, 16
    v_alignbit_b32 v98, v153, v152, 16
    v_alignbit_b32 v99, v154, v153, 16
    ds_write_b128 v189, v[96:99] offset:13536
    s_waitcnt lgkmcnt(8)
    v_alignbit_b32 v76, v160, v159, 16
    v_alignbit_b32 v77, v161, v160, 16
    v_alignbit_b32 v78, v162, v161, 16
    v_alignbit_b32 v79, v163, v162, 16
    ds_write_b128 v189, v[76:79] offset:6240
    v_mov_b32 v80, v159
    v_mov_b32 v81, v160
    v_mov_b32 v82, v161
    v_mov_b32 v83, v162
    ds_write_b128 v189, v[80:83] offset:10400
    v_alignbit_b32 v84, v159, v158, 16
    v_alignbit_b32 v85, v160, v159, 16
    v_alignbit_b32 v86, v161, v160, 16
    v_alignbit_b32 v87, v162, v161, 16
    ds_write_b128 v189, v[84:87] offset:14560
    s_waitcnt lgkmcnt(9)
    v_alignbit_b32 v88, v168, v167, 16
    v_alignbit_b32 v89, v169, v168, 16
    v_alignbit_b32 v90, v170, v169, 16
    v_alignbit_b32 v91, v171, v170, 16
    ds_write_b128 v189, v[88:91] offset:7264
    v_mov_b32 v92, v167
    v_mov_b32 v93, v168
    v_mov_b32 v94, v169
    v_mov_b32 v95, v170
    ds_write_b128 v189, v[92:95] offset:11424
    v_alignbit_b32 v96, v167, v166, 16
    v_alignbit_b32 v97, v168, v167, 16
    v_alignbit_b32 v98, v169, v168, 16
    v_alignbit_b32 v99, v170, v169, 16
    ds_write_b128 v189, v[96:99] offset:15584
    s_waitcnt lgkmcnt(0)
JOIN:
    buffer_load_dword v36, v37, s[20:23], s1 offen offset:0 sc1
    s_waitcnt vmcnt(0)
    v_cmp_ne_u32 vcc, s59, v36
    s_cbranch_vccnz SLOW_xn
RET_xn:
    buffer_load_dwordx4 a[0:3], v19, s[20:23], s49 offen offset:0 sc1
    buffer_load_dwordx4 a[16:19], v19, s[20:23], s49 offen offset:1024 sc1
    buffer_load_dwordx4 a[4:7], v20, s[20:23], s49 offen offset:0 sc1
    buffer_load_dwordx4 a[20:23], v20, s[20:23], s49 offen offset:1024 sc1
    buffer_load_dwordx4 a[8:11], v21, s[20:23], s49 offen offset:0 sc1
    buffer_load_dwordx4 a[24:27], v21, s[20:23], s49 offen offset:1024 sc1
    buffer_load_dwordx4 a[12:15], v22, s[20:23], s49 offen offset:0 sc1
    buffer_load_dwordx4 a[28:31], v22, s[20:23], s49 offen offset:1024 sc1
    buffer_load_dwordx4 a[32:35], v19, s[20:23], s50 offen offset:0 sc1
    buffer_load_dwordx4 a[48:51], v19, s[20:23], s50 offen offset:1024 sc1
    buffer_load_dwordx4 a[36:39], v20, s[20:23], s50 offen offset:0 sc1
    buffer_load_dwordx4 a[52:55], v20, s[20:23], s50 offen offset:1024 sc1
    buffer_load_dwordx4 a[40:43], v21, s[20:23], s50 offen offset:0 sc1
    buffer_load_dwordx4 a[56:59], v21, s[20:23], s50 offen offset:1024 sc1
    buffer_load_dwordx4 a[44:47], v22, s[20:23], s50 offen offset:0 sc1
    buffer_load_dwordx4 a[60:63], v22, s[20:23], s50 offen offset:1024 sc1
    buffer_load_dwordx4 a[64:67], v19, s[20:23], s51 offen offset:0 sc1
    buffer_load_dwordx4 a[80:83], v19, s[20:23], s51 offen offset:1024 sc1
    buffer_load_dwordx4 a[68:71], v20, s[20:23], s51 offen offset:0 sc1
    buffer_load_dwordx4 a[84:87], v20, s[20:23], s51 offen offset:1024 sc1
    buffer_load_dwordx4 a[72:75], v21, s[20:23], s51 offen offset:0 sc1
    buffer_load_dwordx4 a[88:91], v21, s[20:23], s51 offen offset:1024 sc1
    buffer_load_dwordx4 a[76:79], v22, s[20:23], s51 offen offset:0 sc1
    buffer_load_dwordx4 a[92:95], v22, s[20:23], s51 offen offset:1024 sc1
XDONE:
    s_barrier
    ds_read_b64_tr_b16 v[72:73], v2 offset:0
    ds_read_b64_tr_b16 v[74:75], v2 offset:512
    ds_read_b64_tr_b16 v[76:77], v2 offset:4096
    ds_read_b64_tr_b16 v[78:79], v2 offset:4608
    ds_read_b64_tr_b16 v[80:81], v2 offset:8192
    ds_read_b64_tr_b16 v[82:83], v2 offset:8704
    ds_read_b64_tr_b16 v[84:85], v2 offset:12288
    ds_read_b64_tr_b16 v[86:87], v2 offset:12800
    s_waitcnt vmcnt(16) lgkmcnt(4)
    v_mfma_f32_16x16x32_bf16 v[128:131], v[72:75], a[0:3], 0
    ds_read_b64_tr_b16 v[88:89], v3 offset:0
    v_mfma_f32_16x16x32_bf16 v[128:131], v[76:79], a[16:19], v[128:131]
    buffer_load_dwordx4 a[96:99], v19, s[20:23], s52 offen offset:0 sc1
    v_mfma_f32_16x16x32_bf16 v[132:135], v[72:75], a[4:7], 0
    ds_read_b64_tr_b16 v[90:91], v3 offset:512
    v_mfma_f32_16x16x32_bf16 v[132:135], v[76:79], a[20:23], v[132:135]
    v_mfma_f32_16x16x32_bf16 v[136:139], v[72:75], a[8:11], 0
    ds_read_b64_tr_b16 v[92:93], v3 offset:4096
    v_mfma_f32_16x16x32_bf16 v[136:139], v[76:79], a[24:27], v[136:139]
    buffer_load_dwordx4 a[112:115], v19, s[20:23], s52 offen offset:1024 sc1
    v_mfma_f32_16x16x32_bf16 v[140:143], v[72:75], a[12:15], 0
    ds_read_b64_tr_b16 v[94:95], v3 offset:4608
    v_mfma_f32_16x16x32_bf16 v[140:143], v[76:79], a[28:31], v[140:143]
    s_waitcnt lgkmcnt(4)
    v_mfma_f32_16x16x32_bf16 v[192:195], v[80:83], a[0:3], 0
    ds_read_b64_tr_b16 v[72:73], v3 offset:8192
    v_bfe_u32 v44, v1, 2, 2
    v_mfma_f32_16x16x32_bf16 v[192:195], v[84:87], a[16:19], v[192:195]
    buffer_load_dwordx4 a[100:103], v20, s[20:23], s52 offen offset:0 sc1
    v_mul_u32_u24 v44, 4160, v44
    v_mfma_f32_16x16x32_bf16 v[196:199], v[80:83], a[4:7], 0
    ds_read_b64_tr_b16 v[74:75], v3 offset:8704
    v_and_b32 v45, 3, v1
    v_mfma_f32_16x16x32_bf16 v[196:199], v[84:87], a[20:23], v[196:199]
    v_lshl_add_u32 v44, v45, 3, v44
    v_and_b32 v45, 48, v1
    v_mfma_f32_16x16x32_bf16 v[200:203], v[80:83], a[8:11], 0
    ds_read_b64_tr_b16 v[76:77], v3 offset:12288
    v_sub_u32 v44, v44, v45
    v_mfma_f32_16x16x32_bf16 v[200:203], v[84:87], a[24:27], v[200:203]
    buffer_load_dwordx4 a[116:119], v20, s[20:23], s52 offen offset:1024 sc1
    v_add3_u32 v27, v44, s4, 56
    v_mfma_f32_16x16x32_bf16 v[204:207], v[80:83], a[12:15], 0
    ds_read_b64_tr_b16 v[78:79], v3 offset:12800
    v_and_b32 v44, 15, v1
    v_mfma_f32_16x16x32_bf16 v[204:207], v[84:87], a[28:31], v[204:207]
    v_lshl_add_u32 v45, v44, 5, v45
    s_waitcnt lgkmcnt(4)
    v_mfma_f32_16x16x32_bf16 v[144:147], v[88:91], a[0:3], 0
    ds_read_b64_tr_b16 v[80:81], v4 offset:0
    v_add_u32 v45, 16672, v45
    v_mfma_f32_16x16x32_bf16 v[144:147], v[92:95], a[16:19], v[144:147]
    buffer_load_dwordx4 a[104:107], v21, s[20:23], s52 offen offset:0 sc1
    v_add_u32 v28, s4, v45
    v_mfma_f32_16x16x32_bf16 v[148:151], v[88:91], a[4:7], 0
    ds_read_b64_tr_b16 v[82:83], v4 offset:512
    v_bfe_u32 v45, v1, 4, 1
    v_mfma_f32_16x16x32_bf16 v[148:151], v[92:95], a[20:23], v[148:151]
    v_lshrrev_b32 v46, 5, v1
    v_lshlrev_b32 v44, 5, v44
    v_mfma_f32_16x16x32_bf16 v[152:155], v[88:91], a[8:11], 0
    ds_read_b64_tr_b16 v[84:85], v4 offset:4096
    v_lshl_add_u32 v44, v45, 9, v44
    v_mfma_f32_16x16x32_bf16 v[152:155], v[92:95], a[24:27], v[152:155]
    buffer_load_dwordx4 a[120:123], v21, s[20:23], s52 offen offset:1024 sc1
    v_lshl_add_u32 v29, v46, 4, v44
    v_mfma_f32_16x16x32_bf16 v[156:159], v[88:91], a[12:15], 0
    ds_read_b64_tr_b16 v[86:87], v4 offset:4608
    s_and_b32 s60, s37, 1
    v_mfma_f32_16x16x32_bf16 v[156:159], v[92:95], a[28:31], v[156:159]
    s_lshl_b32 s61, s92, 2
    s_waitcnt lgkmcnt(4)
    v_mfma_f32_16x16x32_bf16 v[208:211], v[72:75], a[0:3], 0
    ds_read_b64_tr_b16 v[88:89], v4 offset:8192
    s_add_u32 s62, s61, s3
    v_mfma_f32_16x16x32_bf16 v[208:211], v[76:79], a[16:19], v[208:211]
    buffer_load_dwordx4 a[108:111], v22, s[20:23], s52 offen offset:0 sc1
    s_lshl_b32 s96, s62, 5
    v_mfma_f32_16x16x32_bf16 v[212:215], v[72:75], a[4:7], 0
    ds_read_b64_tr_b16 v[90:91], v4 offset:8704
    s_mul_i32 s62, s62, 294912
    v_mfma_f32_16x16x32_bf16 v[212:215], v[76:79], a[20:23], v[212:215]
    s_mul_i32 s63, s35, 36864
    s_add_u32 s62, s62, s63
    v_mfma_f32_16x16x32_bf16 v[216:219], v[72:75], a[8:11], 0
    ds_read_b64_tr_b16 v[92:93], v4 offset:12288
    s_add_u32 s62, s62, 8388608
    v_mfma_f32_16x16x32_bf16 v[216:219], v[76:79], a[24:27], v[216:219]
    buffer_load_dwordx4 a[124:127], v22, s[20:23], s52 offen offset:1024 sc1
    s_lshl_b32 s63, s35, 2
    v_mfma_f32_16x16x32_bf16 v[220:223], v[72:75], a[12:15], 0
    ds_read_b64_tr_b16 v[94:95], v4 offset:12800
    s_add_u32 s63, s63, s93
    v_mfma_f32_16x16x32_bf16 v[220:223], v[76:79], a[28:31], v[220:223]
    s_mul_i32 s63, s63, 36
    s_waitcnt lgkmcnt(4)
    v_mfma_f32_16x16x32_bf16 v[160:163], v[80:83], a[0:3], 0
    ds_read_b64_tr_b16 v[72:73], v5 offset:0
    s_add_u32 s63, s63, s3
    v_mfma_f32_16x16x32_bf16 v[160:163], v[84:87], a[16:19], v[160:163]
    s_mul_i32 s63, s63, 9216
    s_add_u32 s63, s63, 37748736
    v_mfma_f32_16x16x32_bf16 v[164:167], v[80:83], a[4:7], 0
    ds_read_b64_tr_b16 v[74:75], v5 offset:512
    s_mul_i32 s88, s3, 7168
    v_mfma_f32_16x16x32_bf16 v[164:167], v[84:87], a[20:23], v[164:167]
    s_lshl_b32 s89, s3, 11
    s_add_u32 s87, s62, 32768
    v_mfma_f32_16x16x32_bf16 v[168:171], v[80:83], a[8:11], 0
    ds_read_b64_tr_b16 v[76:77], v5 offset:4096
    s_add_u32 s78, s63, 294912
    v_mfma_f32_16x16x32_bf16 v[168:171], v[84:87], a[24:27], v[168:171]
    s_add_u32 s64, s93, 0
    s_and_b32 s64, s64, 3
    v_mfma_f32_16x16x32_bf16 v[172:175], v[80:83], a[12:15], 0
    ds_read_b64_tr_b16 v[78:79], v5 offset:4608
    s_lshl_b32 s65, s64, 12
    v_mfma_f32_16x16x32_bf16 v[172:175], v[84:87], a[28:31], v[172:175]
    s_add_u32 s79, s65, s62
    s_waitcnt lgkmcnt(4)
    v_mfma_f32_16x16x32_bf16 v[224:227], v[88:91], a[0:3], 0
    ds_read_b64_tr_b16 v[80:81], v5 offset:8192
    s_add_u32 s83, s79, 16384
    v_mfma_f32_16x16x32_bf16 v[224:227], v[92:95], a[16:19], v[224:227]
    s_mul_i32 s65, s64, 36864
    s_add_u32 s70, s65, s63
    v_mfma_f32_16x16x32_bf16 v[228:231], v[88:91], a[4:7], 0
    ds_read_b64_tr_b16 v[82:83], v5 offset:8704
    s_add_u32 s74, s70, 147456
    v_mfma_f32_16x16x32_bf16 v[228:231], v[92:95], a[20:23], v[228:231]
    s_add_u32 s64, s93, 1
    s_and_b32 s64, s64, 3
    v_mfma_f32_16x16x32_bf16 v[232:235], v[88:91], a[8:11], 0
    ds_read_b64_tr_b16 v[84:85], v5 offset:12288
    s_lshl_b32 s65, s64, 12
    v_mfma_f32_16x16x32_bf16 v[232:235], v[92:95], a[24:27], v[232:235]
    s_add_u32 s80, s65, s62
    s_add_u32 s84, s80, 16384
    v_mfma_f32_16x16x32_bf16 v[236:239], v[88:91], a[12:15], 0
    ds_read_b64_tr_b16 v[86:87], v5 offset:12800
    s_mul_i32 s65, s64, 36864
    v_mfma_f32_16x16x32_bf16 v[236:239], v[92:95], a[28:31], v[236:239]
    s_add_u32 s71, s65, s63
    s_waitcnt lgkmcnt(4)
    v_mfma_f32_16x16x32_bf16 v[176:179], v[72:75], a[0:3], 0
    s_barrier
    v_mfma_f32_16x16x32_bf16 v[176:179], v[76:79], a[16:19], v[176:179]
    ds_read_b64_tr_b16 v[88:89], v2 offset:16384
    s_add_u32 s75, s71, 147456
    v_mfma_f32_16x16x32_bf16 v[180:183], v[72:75], a[4:7], 0
    ds_read_b64_tr_b16 v[90:91], v2 offset:16896
    s_add_u32 s64, s93, 2
    v_mfma_f32_16x16x32_bf16 v[180:183], v[76:79], a[20:23], v[180:183]
    ds_read_b64_tr_b16 v[92:93], v2 offset:20480
    s_and_b32 s64, s64, 3
    v_mfma_f32_16x16x32_bf16 v[184:187], v[72:75], a[8:11], 0
    ds_read_b64_tr_b16 v[94:95], v2 offset:20992
    s_lshl_b32 s65, s64, 12
    v_mfma_f32_16x16x32_bf16 v[184:187], v[76:79], a[24:27], v[184:187]
    s_add_u32 s81, s65, s62
    s_add_u32 s85, s81, 16384
    v_mfma_f32_16x16x32_bf16 v[188:191], v[72:75], a[12:15], 0
    s_mul_i32 s65, s64, 36864
    s_add_u32 s72, s65, s63
    v_mfma_f32_16x16x32_bf16 v[188:191], v[76:79], a[28:31], v[188:191]
    s_add_u32 s76, s72, 147456
    s_waitcnt lgkmcnt(4)
    v_mfma_f32_16x16x32_bf16 v[240:243], v[80:83], a[0:3], 0
    ds_read_b64_tr_b16 v[72:73], v2 offset:24576
    s_add_u32 s64, s93, 3
    v_mfma_f32_16x16x32_bf16 v[240:243], v[84:87], a[16:19], v[240:243]
    s_and_b32 s64, s64, 3
    s_lshl_b32 s65, s64, 12
    v_mfma_f32_16x16x32_bf16 v[244:247], v[80:83], a[4:7], 0
    ds_read_b64_tr_b16 v[74:75], v2 offset:25088
    s_add_u32 s82, s65, s62
    v_mfma_f32_16x16x32_bf16 v[244:247], v[84:87], a[20:23], v[244:247]
    s_add_u32 s86, s82, 16384
    s_mul_i32 s65, s64, 36864
    v_mfma_f32_16x16x32_bf16 v[248:251], v[80:83], a[8:11], 0
    ds_read_b64_tr_b16 v[76:77], v2 offset:28672
    s_add_u32 s73, s65, s63
    v_mfma_f32_16x16x32_bf16 v[248:251], v[84:87], a[24:27], v[248:251]
    s_add_u32 s77, s73, 147456
    s_lshl_b32 s62, s36, 2
    v_mfma_f32_16x16x32_bf16 v[252:255], v[80:83], a[12:15], 0
    ds_read_b64_tr_b16 v[78:79], v2 offset:29184
    s_add_u32 s62, s62, s35
    v_mfma_f32_16x16x32_bf16 v[252:255], v[84:87], a[28:31], v[252:255]
    s_lshl_b32 s62, s62, 11
    s_waitcnt vmcnt(16) lgkmcnt(4)
    v_mfma_f32_16x16x32_bf16 v[128:131], v[88:91], a[32:35], v[128:131]
    ds_read_b64_tr_b16 v[80:81], v3 offset:16384
    buffer_load_dwordx4 a[128:131], v19, s[20:23], s53 offen offset:0 sc1
    v_mfma_f32_16x16x32_bf16 v[128:131], v[92:95], a[48:51], v[128:131]
    s_add_u32 s62, s62, 34603008
    s_lshl_b32 s63, s3, 9
    v_mfma_f32_16x16x32_bf16 v[132:135], v[88:91], a[36:39], v[132:135]
    ds_read_b64_tr_b16 v[82:83], v3 offset:16896
    s_lshl_b32 s64, s37, 2
    v_mfma_f32_16x16x32_bf16 v[132:135], v[92:95], a[52:55], v[132:135]
    s_add_u32 s63, s63, s64
    s_add_u32 s90, s62, s63
    v_mfma_f32_16x16x32_bf16 v[136:139], v[88:91], a[40:43], v[136:139]
    ds_read_b64_tr_b16 v[84:85], v3 offset:20480
    buffer_load_dwordx4 a[144:147], v19, s[20:23], s53 offen offset:1024 sc1
    v_mfma_f32_16x16x32_bf16 v[136:139], v[92:95], a[56:59], v[136:139]
    s_lshl_b32 s64, s60, 1
    s_lshr_b32 s65, s3, 1
    v_mfma_f32_16x16x32_bf16 v[140:143], v[88:91], a[44:47], v[140:143]
    ds_read_b64_tr_b16 v[86:87], v3 offset:20992
    s_add_u32 s64, s64, s65
    v_mfma_f32_16x16x32_bf16 v[140:143], v[92:95], a[60:63], v[140:143]
    s_lshl_b32 s64, s64, 9
    s_waitcnt lgkmcnt(4)
    v_mfma_f32_16x16x32_bf16 v[192:195], v[72:75], a[32:35], v[192:195]
    ds_read_b64_tr_b16 v[88:89], v3 offset:24576
    buffer_load_dwordx4 a[132:135], v20, s[20:23], s53 offen offset:0 sc1
    v_mfma_f32_16x16x32_bf16 v[192:195], v[76:79], a[48:51], v[192:195]
    s_add_u32 s91, s62, s64
    s_lshl_b32 s62, s36, 13
    v_mfma_f32_16x16x32_bf16 v[196:199], v[72:75], a[36:39], v[196:199]
    ds_read_b64_tr_b16 v[90:91], v3 offset:25088
    s_add_u32 s62, s62, s63
    v_mfma_f32_16x16x32_bf16 v[196:199], v[76:79], a[52:55], v[196:199]
    s_add_u32 s62, s62, 34603136
    s_lshl_b32 s63, s93, 2
    v_mfma_f32_16x16x32_bf16 v[200:203], v[72:75], a[40:43], v[200:203]
    ds_read_b64_tr_b16 v[92:93], v3 offset:28672
    buffer_load_dwordx4 a[148:151], v20, s[20:23], s53 offen offset:1024 sc1
    v_mfma_f32_16x16x32_bf16 v[200:203], v[76:79], a[56:59], v[200:203]
    s_add_u32 s63, s63, s35
    s_lshl_b32 s63, s63, 7
    v_mfma_f32_16x16x32_bf16 v[204:207], v[72:75], a[44:47], v[204:207]
    ds_read_b64_tr_b16 v[94:95], v3 offset:29184
    s_add_u32 s63, s63, 34668544
    v_mfma_f32_16x16x32_bf16 v[204:207], v[76:79], a[60:63], v[204:207]
    s_lshl_b32 s64, s93, 6
    s_waitcnt lgkmcnt(4)
    v_mfma_f32_16x16x32_bf16 v[144:147], v[80:83], a[32:35], v[144:147]
    ds_read_b64_tr_b16 v[72:73], v4 offset:16384
    buffer_load_dwordx4 a[136:139], v21, s[20:23], s53 offen offset:0 sc1
    v_mfma_f32_16x16x32_bf16 v[144:147], v[84:87], a[48:51], v[144:147]
    s_add_u32 s64, s64, 34670464
    v_lshl_add_u32 v40, v1, 2, s63
    v_mfma_f32_16x16x32_bf16 v[148:151], v[80:83], a[36:39], v[148:151]
    ds_read_b64_tr_b16 v[74:75], v4 offset:16896
    v_lshl_add_u32 v41, v1, 2, s64
    v_mfma_f32_16x16x32_bf16 v[148:151], v[84:87], a[52:55], v[148:151]
    v_and_b32 v42, 3, v1
    v_lshlrev_b32 v42, 11, v42
    v_mfma_f32_16x16x32_bf16 v[152:155], v[80:83], a[40:43], v[152:155]
    ds_read_b64_tr_b16 v[76:77], v4 offset:20480
    buffer_load_dwordx4 a[152:155], v21, s[20:23], s53 offen offset:1024 sc1
    v_mfma_f32_16x16x32_bf16 v[152:155], v[84:87], a[56:59], v[152:155]
    v_add_u32 v42, s62, v42
    v_cmp_gt_u32 vcc, 48, v1
    v_mfma_f32_16x16x32_bf16 v[156:159], v[80:83], a[44:47], v[156:159]
    ds_read_b64_tr_b16 v[78:79], v4 offset:20992
    v_cndmask_b32 v41, v42, v41, vcc
    v_mfma_f32_16x16x32_bf16 v[156:159], v[84:87], a[60:63], v[156:159]
    v_cmp_gt_u32 vcc, 32, v1
    s_waitcnt lgkmcnt(4)
    v_mfma_f32_16x16x32_bf16 v[208:211], v[88:91], a[32:35], v[208:211]
    ds_read_b64_tr_b16 v[80:81], v4 offset:24576
    buffer_load_dwordx4 a[140:143], v22, s[20:23], s53 offen offset:0 sc1
    v_mfma_f32_16x16x32_bf16 v[208:211], v[92:95], a[48:51], v[208:211]
    v_cndmask_b32 v39, v41, v40, vcc
    s_lshl_b32 s62, s35, 11
    v_mfma_f32_16x16x32_bf16 v[212:215], v[88:91], a[36:39], v[212:215]
    ds_read_b64_tr_b16 v[82:83], v4 offset:25088
    s_lshl_b32 s63, s93, 3
    v_mfma_f32_16x16x32_bf16 v[212:215], v[92:95], a[52:55], v[212:215]
    s_add_u32 s62, s62, s63
    s_add_u32 s62, s62, 34604032
    v_mfma_f32_16x16x32_bf16 v[216:219], v[88:91], a[40:43], v[216:219]
    ds_read_b64_tr_b16 v[84:85], v4 offset:28672
    buffer_load_dwordx4 a[156:159], v22, s[20:23], s53 offen offset:1024 sc1
    v_mfma_f32_16x16x32_bf16 v[216:219], v[92:95], a[56:59], v[216:219]
    v_bfe_u32 v40, v1, 1, 3
    v_lshlrev_b32 v40, 13, v40
    v_mfma_f32_16x16x32_bf16 v[220:223], v[88:91], a[44:47], v[220:223]
    ds_read_b64_tr_b16 v[86:87], v4 offset:29184
    v_and_b32 v41, 1, v1
    v_mfma_f32_16x16x32_bf16 v[220:223], v[92:95], a[60:63], v[220:223]
    v_lshlrev_b32 v41, 2, v41
    s_waitcnt lgkmcnt(4)
    v_mfma_f32_16x16x32_bf16 v[160:163], v[72:75], a[32:35], v[160:163]
    ds_read_b64_tr_b16 v[88:89], v5 offset:16384
    s_add_u32 m0, s38, 81920
    v_mfma_f32_16x16x32_bf16 v[160:163], v[76:79], a[48:51], v[160:163]
    buffer_load_dwordx4 v14, s[8:11], s45 offen lds
    v_add3_u32 v40, v40, v41, s62
    v_mfma_f32_16x16x32_bf16 v[164:167], v[72:75], a[36:39], v[164:167]
    ds_read_b64_tr_b16 v[90:91], v5 offset:16896
    v_add_u32 v41, s91, v37
    v_mfma_f32_16x16x32_bf16 v[164:167], v[76:79], a[52:55], v[164:167]
    v_cndmask_b32 v35, v40, v41, vcc
    v_add_u32 v34, 4096, v23
    v_mfma_f32_16x16x32_bf16 v[168:171], v[72:75], a[40:43], v[168:171]
    ds_read_b64_tr_b16 v[92:93], v5 offset:20480
    s_add_u32 s61, s61, s93
    v_mfma_f32_16x16x32_bf16 v[168:171], v[76:79], a[56:59], v[168:171]
    s_add_u32 m0, s38, 83968
    s_lshl_b32 s62, s61, 4
    v_mfma_f32_16x16x32_bf16 v[172:175], v[72:75], a[44:47], v[172:175]
    ds_read_b64_tr_b16 v[94:95], v5 offset:20992
    buffer_load_dwordx4 v15, s[8:11], s45 offen lds
    v_mfma_f32_16x16x32_bf16 v[172:175], v[76:79], a[60:63], v[172:175]
    s_add_u32 s62, s62, s3
    s_waitcnt lgkmcnt(4)
    v_mfma_f32_16x16x32_bf16 v[224:227], v[80:83], a[32:35], v[224:227]
    ds_read_b64_tr_b16 v[72:73], v5 offset:24576
    s_mul_i32 s62, s62, 6144
    v_mfma_f32_16x16x32_bf16 v[224:227], v[84:87], a[48:51], v[224:227]
    s_add_u32 s62, s62, 27262976
    s_mul_i32 s95, s35, 24576
    v_mfma_f32_16x16x32_bf16 v[228:231], v[80:83], a[36:39], v[228:231]
    ds_read_b64_tr_b16 v[74:75], v5 offset:25088
    s_add_u32 m0, s38, 86016
    v_mfma_f32_16x16x32_bf16 v[228:231], v[84:87], a[52:55], v[228:231]
    buffer_load_dwordx4 v16, s[8:11], s45 offen lds
    s_add_u32 s95, s95, s62
    v_mfma_f32_16x16x32_bf16 v[232:235], v[80:83], a[40:43], v[232:235]
    ds_read_b64_tr_b16 v[76:77], v5 offset:28672
    s_lshl_b32 s97, s61, 2
    v_mfma_f32_16x16x32_bf16 v[232:235], v[84:87], a[56:59], v[232:235]
    s_add_u32 s97, s97, s3
    s_lshl_b32 s97, s97, 12
    v_mfma_f32_16x16x32_bf16 v[236:239], v[80:83], a[44:47], v[236:239]
    ds_read_b64_tr_b16 v[78:79], v5 offset:29184
    s_add_u32 s97, s97, 33554432
    v_mfma_f32_16x16x32_bf16 v[236:239], v[84:87], a[60:63], v[236:239]
    s_add_u32 m0, s38, 88064
    s_waitcnt lgkmcnt(4)
    v_mfma_f32_16x16x32_bf16 v[176:179], v[88:91], a[32:35], v[176:179]
    s_barrier
    v_mfma_f32_16x16x32_bf16 v[176:179], v[92:95], a[48:51], v[176:179]
    ds_read_b64_tr_b16 v[80:81], v2 offset:32768
    buffer_load_dwordx4 v17, s[8:11], s45 offen lds
    v_mfma_f32_16x16x32_bf16 v[180:183], v[88:91], a[36:39], v[180:183]
    ds_read_b64_tr_b16 v[82:83], v2 offset:33280
    s_lshl_b32 s15, s35, 10
    v_mfma_f32_16x16x32_bf16 v[180:183], v[92:95], a[52:55], v[180:183]
    ds_read_b64_tr_b16 v[84:85], v2 offset:36864
    s_add_u32 s15, s15, s97
    v_mfma_f32_16x16x32_bf16 v[184:187], v[88:91], a[40:43], v[184:187]
    ds_read_b64_tr_b16 v[86:87], v2 offset:37376
    s_xor_b32 s63, s35, 1
    v_mfma_f32_16x16x32_bf16 v[184:187], v[92:95], a[56:59], v[184:187]
    s_mul_i32 s63, s63, 24576
    s_add_u32 s63, s63, s62
    v_mfma_f32_16x16x32_bf16 v[188:191], v[88:91], a[44:47], v[188:191]
    s_add_u32 s12, s63, 0
    s_xor_b32 s63, s35, 2
    v_mfma_f32_16x16x32_bf16 v[188:191], v[92:95], a[60:63], v[188:191]
    s_mul_i32 s63, s63, 24576
    s_waitcnt lgkmcnt(4)
    v_mfma_f32_16x16x32_bf16 v[240:243], v[72:75], a[32:35], v[240:243]
    ds_read_b64_tr_b16 v[88:89], v2 offset:40960
    s_add_u32 s63, s63, s62
    v_mfma_f32_16x16x32_bf16 v[240:243], v[76:79], a[48:51], v[240:243]
    s_add_u32 s13, s63, 2048
    s_xor_b32 s63, s35, 3
    v_mfma_f32_16x16x32_bf16 v[244:247], v[72:75], a[36:39], v[244:247]
    ds_read_b64_tr_b16 v[90:91], v2 offset:41472
    s_mul_i32 s63, s63, 24576
    v_mfma_f32_16x16x32_bf16 v[244:247], v[76:79], a[52:55], v[244:247]
    s_add_u32 s63, s63, s62
    s_add_u32 s14, s63, 4096
    v_mfma_f32_16x16x32_bf16 v[248:251], v[72:75], a[40:43], v[248:251]
    ds_read_b64_tr_b16 v[92:93], v2 offset:45056
    v_mfma_f32_16x16x32_bf16 v[248:251], v[76:79], a[56:59], v[248:251]
    v_mfma_f32_16x16x32_bf16 v[252:255], v[72:75], a[44:47], v[252:255]
    ds_read_b64_tr_b16 v[94:95], v2 offset:45568
    v_mfma_f32_16x16x32_bf16 v[252:255], v[76:79], a[60:63], v[252:255]
    s_waitcnt vmcnt(20) lgkmcnt(4)
    v_mfma_f32_16x16x32_bf16 v[128:131], v[80:83], a[64:67], v[128:131]
    ds_read_b64_tr_b16 v[72:73], v3 offset:32768
    buffer_load_dwordx4 a[160:163], v19, s[20:23], s54 offen offset:0 sc1
    v_mfma_f32_16x16x32_bf16 v[128:131], v[84:87], a[80:83], v[128:131]
    v_mfma_f32_16x16x32_bf16 v[132:135], v[80:83], a[68:71], v[132:135]
    ds_read_b64_tr_b16 v[74:75], v3 offset:33280
    v_mfma_f32_16x16x32_bf16 v[132:135], v[84:87], a[84:87], v[132:135]
    v_mfma_f32_16x16x32_bf16 v[136:139], v[80:83], a[72:75], v[136:139]
    ds_read_b64_tr_b16 v[76:77], v3 offset:36864
    buffer_load_dwordx4 a[176:179], v19, s[20:23], s54 offen offset:1024 sc1
    v_mfma_f32_16x16x32_bf16 v[136:139], v[84:87], a[88:91], v[136:139]
    v_mfma_f32_16x16x32_bf16 v[140:143], v[80:83], a[76:79], v[140:143]
    ds_read_b64_tr_b16 v[78:79], v3 offset:37376
    v_mfma_f32_16x16x32_bf16 v[140:143], v[84:87], a[92:95], v[140:143]
    s_waitcnt lgkmcnt(4)
    v_mfma_f32_16x16x32_bf16 v[192:195], v[88:91], a[64:67], v[192:195]
    ds_read_b64_tr_b16 v[80:81], v3 offset:40960
    buffer_load_dwordx4 a[164:167], v20, s[20:23], s54 offen offset:0 sc1
    v_mfma_f32_16x16x32_bf16 v[192:195], v[92:95], a[80:83], v[192:195]
    v_mfma_f32_16x16x32_bf16 v[196:199], v[88:91], a[68:71], v[196:199]
    ds_read_b64_tr_b16 v[82:83], v3 offset:41472
    v_mfma_f32_16x16x32_bf16 v[196:199], v[92:95], a[84:87], v[196:199]
    v_mfma_f32_16x16x32_bf16 v[200:203], v[88:91], a[72:75], v[200:203]
    ds_read_b64_tr_b16 v[84:85], v3 offset:45056
    buffer_load_dwordx4 a[180:183], v20, s[20:23], s54 offen offset:1024 sc1
    v_mfma_f32_16x16x32_bf16 v[200:203], v[92:95], a[88:91], v[200:203]
    v_mfma_f32_16x16x32_bf16 v[204:207], v[88:91], a[76:79], v[204:207]
    ds_read_b64_tr_b16 v[86:87], v3 offset:45568
    v_mfma_f32_16x16x32_bf16 v[204:207], v[92:95], a[92:95], v[204:207]
    s_waitcnt lgkmcnt(4)
    v_mfma_f32_16x16x32_bf16 v[144:147], v[72:75], a[64:67], v[144:147]
    ds_read_b64_tr_b16 v[88:89], v4 offset:32768
    buffer_load_dwordx4 a[168:171], v21, s[20:23], s54 offen offset:0 sc1
    v_mfma_f32_16x16x32_bf16 v[144:147], v[76:79], a[80:83], v[144:147]
    v_mfma_f32_16x16x32_bf16 v[148:151], v[72:75], a[68:71], v[148:151]
    ds_read_b64_tr_b16 v[90:91], v4 offset:33280
    v_mfma_f32_16x16x32_bf16 v[148:151], v[76:79], a[84:87], v[148:151]
    v_mfma_f32_16x16x32_bf16 v[152:155], v[72:75], a[72:75], v[152:155]
    ds_read_b64_tr_b16 v[92:93], v4 offset:36864
    buffer_load_dwordx4 a[184:187], v21, s[20:23], s54 offen offset:1024 sc1
    v_mfma_f32_16x16x32_bf16 v[152:155], v[76:79], a[88:91], v[152:155]
    v_mfma_f32_16x16x32_bf16 v[156:159], v[72:75], a[76:79], v[156:159]
    ds_read_b64_tr_b16 v[94:95], v4 offset:37376
    v_mfma_f32_16x16x32_bf16 v[156:159], v[76:79], a[92:95], v[156:159]
    s_waitcnt lgkmcnt(4)
    v_mfma_f32_16x16x32_bf16 v[208:211], v[80:83], a[64:67], v[208:211]
    ds_read_b64_tr_b16 v[72:73], v4 offset:40960
    buffer_load_dwordx4 a[172:175], v22, s[20:23], s54 offen offset:0 sc1
    v_mfma_f32_16x16x32_bf16 v[208:211], v[84:87], a[80:83], v[208:211]
    v_mfma_f32_16x16x32_bf16 v[212:215], v[80:83], a[68:71], v[212:215]
    ds_read_b64_tr_b16 v[74:75], v4 offset:41472
    v_mfma_f32_16x16x32_bf16 v[212:215], v[84:87], a[84:87], v[212:215]
    v_mfma_f32_16x16x32_bf16 v[216:219], v[80:83], a[72:75], v[216:219]
    ds_read_b64_tr_b16 v[76:77], v4 offset:45056
    buffer_load_dwordx4 a[188:191], v22, s[20:23], s54 offen offset:1024 sc1
    v_mfma_f32_16x16x32_bf16 v[216:219], v[84:87], a[88:91], v[216:219]
    v_mfma_f32_16x16x32_bf16 v[220:223], v[80:83], a[76:79], v[220:223]
    ds_read_b64_tr_b16 v[78:79], v4 offset:45568
    v_mfma_f32_16x16x32_bf16 v[220:223], v[84:87], a[92:95], v[220:223]
    s_waitcnt lgkmcnt(4)
    v_mfma_f32_16x16x32_bf16 v[160:163], v[88:91], a[64:67], v[160:163]
    ds_read_b64_tr_b16 v[80:81], v5 offset:32768
    s_add_u32 m0, s38, 0
    v_mfma_f32_16x16x32_bf16 v[160:163], v[92:95], a[80:83], v[160:163]
    buffer_load_dwordx4 v14, s[8:11], s46 offen lds
    v_mfma_f32_16x16x32_bf16 v[164:167], v[88:91], a[68:71], v[164:167]
    ds_read_b64_tr_b16 v[82:83], v5 offset:33280
    v_mfma_f32_16x16x32_bf16 v[164:167], v[92:95], a[84:87], v[164:167]
    v_mfma_f32_16x16x32_bf16 v[168:171], v[88:91], a[72:75], v[168:171]
    ds_read_b64_tr_b16 v[84:85], v5 offset:36864
    v_mfma_f32_16x16x32_bf16 v[168:171], v[92:95], a[88:91], v[168:171]
    s_add_u32 m0, s38, 2048
    v_mfma_f32_16x16x32_bf16 v[172:175], v[88:91], a[76:79], v[172:175]
    ds_read_b64_tr_b16 v[86:87], v5 offset:37376
    buffer_load_dwordx4 v15, s[8:11], s46 offen lds
    v_mfma_f32_16x16x32_bf16 v[172:175], v[92:95], a[92:95], v[172:175]
    s_waitcnt lgkmcnt(4)
    v_mfma_f32_16x16x32_bf16 v[224:227], v[72:75], a[64:67], v[224:227]
    ds_read_b64_tr_b16 v[88:89], v5 offset:40960
    v_mfma_f32_16x16x32_bf16 v[224:227], v[76:79], a[80:83], v[224:227]
    v_mfma_f32_16x16x32_bf16 v[228:231], v[72:75], a[68:71], v[228:231]
    ds_read_b64_tr_b16 v[90:91], v5 offset:41472
    s_add_u32 m0, s38, 4096
    v_mfma_f32_16x16x32_bf16 v[228:231], v[76:79], a[84:87], v[228:231]
    buffer_load_dwordx4 v16, s[8:11], s46 offen lds
    v_mfma_f32_16x16x32_bf16 v[232:235], v[72:75], a[72:75], v[232:235]
    ds_read_b64_tr_b16 v[92:93], v5 offset:45056
    v_mfma_f32_16x16x32_bf16 v[232:235], v[76:79], a[88:91], v[232:235]
    v_mfma_f32_16x16x32_bf16 v[236:239], v[72:75], a[76:79], v[236:239]
    ds_read_b64_tr_b16 v[94:95], v5 offset:45568
    v_mfma_f32_16x16x32_bf16 v[236:239], v[76:79], a[92:95], v[236:239]
    s_add_u32 m0, s38, 6144
    s_waitcnt lgkmcnt(4)
    v_mfma_f32_16x16x32_bf16 v[176:179], v[80:83], a[64:67], v[176:179]
    s_barrier
    v_mfma_f32_16x16x32_bf16 v[176:179], v[84:87], a[80:83], v[176:179]
    ds_read_b64_tr_b16 v[72:73], v2 offset:49152
    buffer_load_dwordx4 v17, s[8:11], s46 offen lds
    v_mfma_f32_16x16x32_bf16 v[180:183], v[80:83], a[68:71], v[180:183]
    ds_read_b64_tr_b16 v[74:75], v2 offset:49664
    v_mfma_f32_16x16x32_bf16 v[180:183], v[84:87], a[84:87], v[180:183]
    ds_read_b64_tr_b16 v[76:77], v2 offset:53248
    v_mfma_f32_16x16x32_bf16 v[184:187], v[80:83], a[72:75], v[184:187]
    ds_read_b64_tr_b16 v[78:79], v2 offset:53760
    v_mfma_f32_16x16x32_bf16 v[184:187], v[84:87], a[88:91], v[184:187]
    v_mfma_f32_16x16x32_bf16 v[188:191], v[80:83], a[76:79], v[188:191]
    v_mfma_f32_16x16x32_bf16 v[188:191], v[84:87], a[92:95], v[188:191]
    s_waitcnt lgkmcnt(4)
    v_mfma_f32_16x16x32_bf16 v[240:243], v[88:91], a[64:67], v[240:243]
    ds_read_b64_tr_b16 v[80:81], v2 offset:57344
    v_mfma_f32_16x16x32_bf16 v[240:243], v[92:95], a[80:83], v[240:243]
    v_mfma_f32_16x16x32_bf16 v[244:247], v[88:91], a[68:71], v[244:247]
    ds_read_b64_tr_b16 v[82:83], v2 offset:57856
    v_mfma_f32_16x16x32_bf16 v[244:247], v[92:95], a[84:87], v[244:247]
    v_mfma_f32_16x16x32_bf16 v[248:251], v[88:91], a[72:75], v[248:251]
    ds_read_b64_tr_b16 v[84:85], v2 offset:61440
    v_mfma_f32_16x16x32_bf16 v[248:251], v[92:95], a[88:91], v[248:251]
    v_mfma_f32_16x16x32_bf16 v[252:255], v[88:91], a[76:79], v[252:255]
CH_A3:
PG4:
    s_cbranch_execz RT_A
    ds_read_b64_tr_b16 v[86:87], v2 offset:61952
    v_mfma_f32_16x16x32_bf16 v[252:255], v[92:95], a[92:95], v[252:255]
    s_waitcnt vmcnt(24) lgkmcnt(4)
    v_mfma_f32_16x16x32_bf16 v[128:131], v[72:75], a[96:99], v[128:131]
    ds_read_b64_tr_b16 v[88:89], v3 offset:49152
    buffer_load_dwordx4 a[192:195], v19, s[20:23], s55 offen offset:0 sc1
    v_mfma_f32_16x16x32_bf16 v[128:131], v[76:79], a[112:115], v[128:131]
    v_mfma_f32_16x16x32_bf16 v[132:135], v[72:75], a[100:103], v[132:135]
    ds_read_b64_tr_b16 v[90:91], v3 offset:49664
    v_mfma_f32_16x16x32_bf16 v[132:135], v[76:79], a[116:119], v[132:135]
    v_mfma_f32_16x16x32_bf16 v[136:139], v[72:75], a[104:107], v[136:139]
    ds_read_b64_tr_b16 v[92:93], v3 offset:53248
    buffer_load_dwordx4 a[208:211], v19, s[20:23], s55 offen offset:1024 sc1
    v_mfma_f32_16x16x32_bf16 v[136:139], v[76:79], a[120:123], v[136:139]
    v_mfma_f32_16x16x32_bf16 v[140:143], v[72:75], a[108:111], v[140:143]
    ds_read_b64_tr_b16 v[94:95], v3 offset:53760
    v_mfma_f32_16x16x32_bf16 v[140:143], v[76:79], a[124:127], v[140:143]
    s_waitcnt lgkmcnt(4)
    v_mfma_f32_16x16x32_bf16 v[192:195], v[80:83], a[96:99], v[192:195]
    ds_read_b64_tr_b16 v[72:73], v3 offset:57344
    buffer_load_dwordx4 a[196:199], v20, s[20:23], s55 offen offset:0 sc1
    v_mfma_f32_16x16x32_bf16 v[192:195], v[84:87], a[112:115], v[192:195]
    v_mfma_f32_16x16x32_bf16 v[196:199], v[80:83], a[100:103], v[196:199]
    ds_read_b64_tr_b16 v[74:75], v3 offset:57856
    v_mfma_f32_16x16x32_bf16 v[196:199], v[84:87], a[116:119], v[196:199]
    v_mfma_f32_16x16x32_bf16 v[200:203], v[80:83], a[104:107], v[200:203]
    ds_read_b64_tr_b16 v[76:77], v3 offset:61440
    buffer_load_dwordx4 a[212:215], v20, s[20:23], s55 offen offset:1024 sc1
    v_mfma_f32_16x16x32_bf16 v[200:203], v[84:87], a[120:123], v[200:203]
    v_mfma_f32_16x16x32_bf16 v[204:207], v[80:83], a[108:111], v[204:207]
    ds_read_b64_tr_b16 v[78:79], v3 offset:61952
    v_mfma_f32_16x16x32_bf16 v[204:207], v[84:87], a[124:127], v[204:207]
    s_waitcnt lgkmcnt(4)
    v_mfma_f32_16x16x32_bf16 v[144:147], v[88:91], a[96:99], v[144:147]
    ds_read_b64_tr_b16 v[80:81], v4 offset:49152
    buffer_load_dwordx4 a[200:203], v21, s[20:23], s55 offen offset:0 sc1
    v_mfma_f32_16x16x32_bf16 v[144:147], v[92:95], a[112:115], v[144:147]
    v_mfma_f32_16x16x32_bf16 v[148:151], v[88:91], a[100:103], v[148:151]
    ds_read_b64_tr_b16 v[82:83], v4 offset:49664
    v_mfma_f32_16x16x32_bf16 v[148:151], v[92:95], a[116:119], v[148:151]
    v_mfma_f32_16x16x32_bf16 v[152:155], v[88:91], a[104:107], v[152:155]
    ds_read_b64_tr_b16 v[84:85], v4 offset:53248
    buffer_load_dwordx4 a[216:219], v21, s[20:23], s55 offen offset:1024 sc1
    v_mfma_f32_16x16x32_bf16 v[152:155], v[92:95], a[120:123], v[152:155]
    v_mfma_f32_16x16x32_bf16 v[156:159], v[88:91], a[108:111], v[156:159]
    ds_read_b64_tr_b16 v[86:87], v4 offset:53760
    v_mfma_f32_16x16x32_bf16 v[156:159], v[92:95], a[124:127], v[156:159]
    s_waitcnt lgkmcnt(4)
    v_mfma_f32_16x16x32_bf16 v[208:211], v[72:75], a[96:99], v[208:211]
    ds_read_b64_tr_b16 v[88:89], v4 offset:57344
    buffer_load_dwordx4 a[204:207], v22, s[20:23], s55 offen offset:0 sc1
    v_mfma_f32_16x16x32_bf16 v[208:211], v[76:79], a[112:115], v[208:211]
    v_mfma_f32_16x16x32_bf16 v[212:215], v[72:75], a[100:103], v[212:215]
    ds_read_b64_tr_b16 v[90:91], v4 offset:57856
    v_mfma_f32_16x16x32_bf16 v[212:215], v[76:79], a[116:119], v[212:215]
    v_mfma_f32_16x16x32_bf16 v[216:219], v[72:75], a[104:107], v[216:219]
    ds_read_b64_tr_b16 v[92:93], v4 offset:61440
    buffer_load_dwordx4 a[220:223], v22, s[20:23], s55 offen offset:1024 sc1
    v_mfma_f32_16x16x32_bf16 v[216:219], v[76:79], a[120:123], v[216:219]
    v_mfma_f32_16x16x32_bf16 v[220:223], v[72:75], a[108:111], v[220:223]
    ds_read_b64_tr_b16 v[94:95], v4 offset:61952
    v_mfma_f32_16x16x32_bf16 v[220:223], v[76:79], a[124:127], v[220:223]
    s_waitcnt lgkmcnt(4)
    v_mfma_f32_16x16x32_bf16 v[160:163], v[80:83], a[96:99], v[160:163]
    ds_read_b64_tr_b16 v[72:73], v5 offset:49152
    s_add_u32 m0, s38, 16384
    v_mfma_f32_16x16x32_bf16 v[160:163], v[84:87], a[112:115], v[160:163]
    buffer_load_dwordx4 v14, s[8:11], s47 offen lds
    v_mfma_f32_16x16x32_bf16 v[164:167], v[80:83], a[100:103], v[164:167]
    ds_read_b64_tr_b16 v[74:75], v5 offset:49664
    v_mfma_f32_16x16x32_bf16 v[164:167], v[84:87], a[116:119], v[164:167]
    v_mfma_f32_16x16x32_bf16 v[168:171], v[80:83], a[104:107], v[168:171]
    ds_read_b64_tr_b16 v[76:77], v5 offset:53248
    v_mfma_f32_16x16x32_bf16 v[168:171], v[84:87], a[120:123], v[168:171]
    s_add_u32 m0, s38, 18432
    v_mfma_f32_16x16x32_bf16 v[172:175], v[80:83], a[108:111], v[172:175]
    ds_read_b64_tr_b16 v[78:79], v5 offset:53760
    buffer_load_dwordx4 v15, s[8:11], s47 offen lds
    v_mfma_f32_16x16x32_bf16 v[172:175], v[84:87], a[124:127], v[172:175]
    s_waitcnt lgkmcnt(4)
    v_mfma_f32_16x16x32_bf16 v[224:227], v[88:91], a[96:99], v[224:227]
    ds_read_b64_tr_b16 v[80:81], v5 offset:57344
    v_mfma_f32_16x16x32_bf16 v[224:227], v[92:95], a[112:115], v[224:227]
    v_mfma_f32_16x16x32_bf16 v[228:231], v[88:91], a[100:103], v[228:231]
    ds_read_b64_tr_b16 v[82:83], v5 offset:57856
    s_add_u32 m0, s38, 20480
    v_mfma_f32_16x16x32_bf16 v[228:231], v[92:95], a[116:119], v[228:231]
    buffer_load_dwordx4 v16, s[8:11], s47 offen lds
    v_mfma_f32_16x16x32_bf16 v[232:235], v[88:91], a[104:107], v[232:235]
    ds_read_b64_tr_b16 v[84:85], v5 offset:61440
    v_mfma_f32_16x16x32_bf16 v[232:235], v[92:95], a[120:123], v[232:235]
    v_mfma_f32_16x16x32_bf16 v[236:239], v[88:91], a[108:111], v[236:239]
    ds_read_b64_tr_b16 v[86:87], v5 offset:61952
    v_mfma_f32_16x16x32_bf16 v[236:239], v[92:95], a[124:127], v[236:239]
    s_add_u32 m0, s38, 22528
    s_waitcnt lgkmcnt(4)
    v_mfma_f32_16x16x32_bf16 v[176:179], v[72:75], a[96:99], v[176:179]
    s_barrier
    v_mfma_f32_16x16x32_bf16 v[176:179], v[76:79], a[112:115], v[176:179]
    ds_read_b64_tr_b16 v[88:89], v6 offset:0
    buffer_load_dwordx4 v17, s[8:11], s47 offen lds
    v_mfma_f32_16x16x32_bf16 v[180:183], v[72:75], a[100:103], v[180:183]
    ds_read_b64_tr_b16 v[90:91], v6 offset:512
    v_mfma_f32_16x16x32_bf16 v[180:183], v[76:79], a[116:119], v[180:183]
    ds_read_b64_tr_b16 v[92:93], v6 offset:4096
    v_mfma_f32_16x16x32_bf16 v[184:187], v[72:75], a[104:107], v[184:187]
    ds_read_b64_tr_b16 v[94:95], v6 offset:4608
    v_mfma_f32_16x16x32_bf16 v[184:187], v[76:79], a[120:123], v[184:187]
    v_mfma_f32_16x16x32_bf16 v[188:191], v[72:75], a[108:111], v[188:191]
    v_mfma_f32_16x16x32_bf16 v[188:191], v[76:79], a[124:127], v[188:191]
    s_waitcnt lgkmcnt(4)
    v_mfma_f32_16x16x32_bf16 v[240:243], v[80:83], a[96:99], v[240:243]
    ds_read_b64_tr_b16 v[72:73], v6 offset:8192
    v_mfma_f32_16x16x32_bf16 v[240:243], v[84:87], a[112:115], v[240:243]
    v_mfma_f32_16x16x32_bf16 v[244:247], v[80:83], a[100:103], v[244:247]
    ds_read_b64_tr_b16 v[74:75], v6 offset:8704
    v_mfma_f32_16x16x32_bf16 v[244:247], v[84:87], a[116:119], v[244:247]
    v_mfma_f32_16x16x32_bf16 v[248:251], v[80:83], a[104:107], v[248:251]
    ds_read_b64_tr_b16 v[76:77], v6 offset:12288
    v_mfma_f32_16x16x32_bf16 v[248:251], v[84:87], a[120:123], v[248:251]
    v_mfma_f32_16x16x32_bf16 v[252:255], v[80:83], a[108:111], v[252:255]
    ds_read_b64_tr_b16 v[78:79], v6 offset:12800
    v_mfma_f32_16x16x32_bf16 v[252:255], v[84:87], a[124:127], v[252:255]
    s_waitcnt vmcnt(28) lgkmcnt(4)
    v_mfma_f32_16x16x32_bf16 v[128:131], v[88:91], a[128:131], v[128:131]
    ds_read_b64_tr_b16 v[80:81], v7 offset:0
    buffer_load_dwordx4 a[224:227], v19, s[20:23], s56 offen offset:0 sc1
    v_mfma_f32_16x16x32_bf16 v[128:131], v[92:95], a[144:147], v[128:131]
    v_mfma_f32_16x16x32_bf16 v[132:135], v[88:91], a[132:135], v[132:135]
    ds_read_b64_tr_b16 v[82:83], v7 offset:512
    v_mfma_f32_16x16x32_bf16 v[132:135], v[92:95], a[148:151], v[132:135]
    v_mfma_f32_16x16x32_bf16 v[136:139], v[88:91], a[136:139], v[136:139]
    ds_read_b64_tr_b16 v[84:85], v7 offset:4096
    buffer_load_dwordx4 a[240:243], v19, s[20:23], s56 offen offset:1024 sc1
    v_mfma_f32_16x16x32_bf16 v[136:139], v[92:95], a[152:155], v[136:139]
    v_mfma_f32_16x16x32_bf16 v[140:143], v[88:91], a[140:143], v[140:143]
    ds_read_b64_tr_b16 v[86:87], v7 offset:4608
    v_mfma_f32_16x16x32_bf16 v[140:143], v[92:95], a[156:159], v[140:143]
    s_waitcnt lgkmcnt(4)
    v_mfma_f32_16x16x32_bf16 v[192:195], v[72:75], a[128:131], v[192:195]
    ds_read_b64_tr_b16 v[88:89], v7 offset:8192
    buffer_load_dwordx4 a[228:231], v20, s[20:23], s56 offen offset:0 sc1
    v_mfma_f32_16x16x32_bf16 v[192:195], v[76:79], a[144:147], v[192:195]
    v_mfma_f32_16x16x32_bf16 v[196:199], v[72:75], a[132:135], v[196:199]
    ds_read_b64_tr_b16 v[90:91], v7 offset:8704
    v_mfma_f32_16x16x32_bf16 v[196:199], v[76:79], a[148:151], v[196:199]
    v_mfma_f32_16x16x32_bf16 v[200:203], v[72:75], a[136:139], v[200:203]
    ds_read_b64_tr_b16 v[92:93], v7 offset:12288
    buffer_load_dwordx4 a[244:247], v20, s[20:23], s56 offen offset:1024 sc1
    v_mfma_f32_16x16x32_bf16 v[200:203], v[76:79], a[152:155], v[200:203]
    v_mfma_f32_16x16x32_bf16 v[204:207], v[72:75], a[140:143], v[204:207]
    ds_read_b64_tr_b16 v[94:95], v7 offset:12800
    v_mfma_f32_16x16x32_bf16 v[204:207], v[76:79], a[156:159], v[204:207]
    s_waitcnt lgkmcnt(4)
    v_mfma_f32_16x16x32_bf16 v[144:147], v[80:83], a[128:131], v[144:147]
    ds_read_b64_tr_b16 v[72:73], v8 offset:0
    buffer_load_dwordx4 a[232:235], v21, s[20:23], s56 offen offset:0 sc1
    v_mfma_f32_16x16x32_bf16 v[144:147], v[84:87], a[144:147], v[144:147]
    v_mfma_f32_16x16x32_bf16 v[148:151], v[80:83], a[132:135], v[148:151]
    ds_read_b64_tr_b16 v[74:75], v8 offset:512
    v_mfma_f32_16x16x32_bf16 v[148:151], v[84:87], a[148:151], v[148:151]
    v_mfma_f32_16x16x32_bf16 v[152:155], v[80:83], a[136:139], v[152:155]
    ds_read_b64_tr_b16 v[76:77], v8 offset:4096
    buffer_load_dwordx4 a[248:251], v21, s[20:23], s56 offen offset:1024 sc1
    v_mfma_f32_16x16x32_bf16 v[152:155], v[84:87], a[152:155], v[152:155]
    v_mfma_f32_16x16x32_bf16 v[156:159], v[80:83], a[140:143], v[156:159]
    ds_read_b64_tr_b16 v[78:79], v8 offset:4608
    v_mfma_f32_16x16x32_bf16 v[156:159], v[84:87], a[156:159], v[156:159]
    s_waitcnt lgkmcnt(4)
    v_mfma_f32_16x16x32_bf16 v[208:211], v[88:91], a[128:131], v[208:211]
    ds_read_b64_tr_b16 v[80:81], v8 offset:8192
    buffer_load_dwordx4 a[236:239], v22, s[20:23], s56 offen offset:0 sc1
    v_mfma_f32_16x16x32_bf16 v[208:211], v[92:95], a[144:147], v[208:211]
    v_mfma_f32_16x16x32_bf16 v[212:215], v[88:91], a[132:135], v[212:215]
    ds_read_b64_tr_b16 v[82:83], v8 offset:8704
    v_mfma_f32_16x16x32_bf16 v[212:215], v[92:95], a[148:151], v[212:215]
    v_mfma_f32_16x16x32_bf16 v[216:219], v[88:91], a[136:139], v[216:219]
    ds_read_b64_tr_b16 v[84:85], v8 offset:12288
    buffer_load_dwordx4 a[252:255], v22, s[20:23], s56 offen offset:1024 sc1
    v_mfma_f32_16x16x32_bf16 v[216:219], v[92:95], a[152:155], v[216:219]
    v_mfma_f32_16x16x32_bf16 v[220:223], v[88:91], a[140:143], v[220:223]
    ds_read_b64_tr_b16 v[86:87], v8 offset:12800
    v_mfma_f32_16x16x32_bf16 v[220:223], v[92:95], a[156:159], v[220:223]
    s_waitcnt lgkmcnt(4)
    v_mfma_f32_16x16x32_bf16 v[160:163], v[72:75], a[128:131], v[160:163]
    ds_read_b64_tr_b16 v[88:89], v9 offset:0
    s_add_u32 m0, s38, 32768
    v_mfma_f32_16x16x32_bf16 v[160:163], v[76:79], a[144:147], v[160:163]
    buffer_load_dwordx4 v14, s[8:11], s48 offen lds
    v_mfma_f32_16x16x32_bf16 v[164:167], v[72:75], a[132:135], v[164:167]
    ds_read_b64_tr_b16 v[90:91], v9 offset:512
    v_mfma_f32_16x16x32_bf16 v[164:167], v[76:79], a[148:151], v[164:167]
    v_mfma_f32_16x16x32_bf16 v[168:171], v[72:75], a[136:139], v[168:171]
    ds_read_b64_tr_b16 v[92:93], v9 offset:4096
    v_mfma_f32_16x16x32_bf16 v[168:171], v[76:79], a[152:155], v[168:171]
    s_add_u32 m0, s38, 34816
    v_mfma_f32_16x16x32_bf16 v[172:175], v[72:75], a[140:143], v[172:175]
    ds_read_b64_tr_b16 v[94:95], v9 offset:4608
    buffer_load_dwordx4 v15, s[8:11], s48 offen lds
    v_mfma_f32_16x16x32_bf16 v[172:175], v[76:79], a[156:159], v[172:175]
    s_waitcnt lgkmcnt(4)
    v_mfma_f32_16x16x32_bf16 v[224:227], v[80:83], a[128:131], v[224:227]
    ds_read_b64_tr_b16 v[72:73], v9 offset:8192
    v_mfma_f32_16x16x32_bf16 v[224:227], v[84:87], a[144:147], v[224:227]
    v_mfma_f32_16x16x32_bf16 v[228:231], v[80:83], a[132:135], v[228:231]
    ds_read_b64_tr_b16 v[74:75], v9 offset:8704
    s_add_u32 m0, s38, 36864
    v_mfma_f32_16x16x32_bf16 v[228:231], v[84:87], a[148:151], v[228:231]
    buffer_load_dwordx4 v16, s[8:11], s48 offen lds
    v_mfma_f32_16x16x32_bf16 v[232:235], v[80:83], a[136:139], v[232:235]
    ds_read_b64_tr_b16 v[76:77], v9 offset:12288
    v_mfma_f32_16x16x32_bf16 v[232:235], v[84:87], a[152:155], v[232:235]
    v_mfma_f32_16x16x32_bf16 v[236:239], v[80:83], a[140:143], v[236:239]
    ds_read_b64_tr_b16 v[78:79], v9 offset:12800
    v_mfma_f32_16x16x32_bf16 v[236:239], v[84:87], a[156:159], v[236:239]
    s_add_u32 m0, s38, 38912
    s_waitcnt lgkmcnt(4)
    v_mfma_f32_16x16x32_bf16 v[176:179], v[88:91], a[128:131], v[176:179]
    s_waitcnt vmcnt(35)
    s_barrier
    v_mfma_f32_16x16x32_bf16 v[176:179], v[92:95], a[144:147], v[176:179]
    ds_read_b64_tr_b16 v[80:81], v6 offset:16384
    buffer_load_dwordx4 v17, s[8:11], s48 offen lds
    v_mfma_f32_16x16x32_bf16 v[180:183], v[88:91], a[132:135], v[180:183]
    ds_read_b64_tr_b16 v[82:83], v6 offset:16896
    v_mfma_f32_16x16x32_bf16 v[180:183], v[92:95], a[148:151], v[180:183]
    ds_read_b64_tr_b16 v[84:85], v6 offset:20480
    v_mfma_f32_16x16x32_bf16 v[184:187], v[88:91], a[136:139], v[184:187]
    ds_read_b64_tr_b16 v[86:87], v6 offset:20992
    v_mfma_f32_16x16x32_bf16 v[184:187], v[92:95], a[152:155], v[184:187]
    v_mfma_f32_16x16x32_bf16 v[188:191], v[88:91], a[140:143], v[188:191]
    v_mfma_f32_16x16x32_bf16 v[188:191], v[92:95], a[156:159], v[188:191]
    s_waitcnt lgkmcnt(4)
    v_mfma_f32_16x16x32_bf16 v[240:243], v[72:75], a[128:131], v[240:243]
    ds_read_b64_tr_b16 v[88:89], v6 offset:24576
    v_mfma_f32_16x16x32_bf16 v[240:243], v[76:79], a[144:147], v[240:243]
    v_mfma_f32_16x16x32_bf16 v[244:247], v[72:75], a[132:135], v[244:247]
    ds_read_b64_tr_b16 v[90:91], v6 offset:25088
    v_mfma_f32_16x16x32_bf16 v[244:247], v[76:79], a[148:151], v[244:247]
    v_mfma_f32_16x16x32_bf16 v[248:251], v[72:75], a[136:139], v[248:251]
    ds_read_b64_tr_b16 v[92:93], v6 offset:28672
    v_mfma_f32_16x16x32_bf16 v[248:251], v[76:79], a[152:155], v[248:251]
    v_mfma_f32_16x16x32_bf16 v[252:255], v[72:75], a[140:143], v[252:255]
    ds_read_b64_tr_b16 v[94:95], v6 offset:29184
    v_mfma_f32_16x16x32_bf16 v[252:255], v[76:79], a[156:159], v[252:255]
    s_waitcnt vmcnt(28) lgkmcnt(4)
    v_mfma_f32_16x16x32_bf16 v[128:131], v[80:83], a[160:163], v[128:131]
    ds_read_b64_tr_b16 v[72:73], v7 offset:16384
    buffer_load_dwordx4 v[96:99], v19, s[20:23], s57 offen offset:0 sc1
    v_mfma_f32_16x16x32_bf16 v[128:131], v[84:87], a[176:179], v[128:131]
    v_mfma_f32_16x16x32_bf16 v[132:135], v[80:83], a[164:167], v[132:135]
    ds_read_b64_tr_b16 v[74:75], v7 offset:16896
    v_mfma_f32_16x16x32_bf16 v[132:135], v[84:87], a[180:183], v[132:135]
    v_mfma_f32_16x16x32_bf16 v[136:139], v[80:83], a[168:171], v[136:139]
    ds_read_b64_tr_b16 v[76:77], v7 offset:20480
    buffer_load_dwordx4 v[112:115], v19, s[20:23], s57 offen offset:1024 sc1
    v_mfma_f32_16x16x32_bf16 v[136:139], v[84:87], a[184:187], v[136:139]
    v_mfma_f32_16x16x32_bf16 v[140:143], v[80:83], a[172:175], v[140:143]
    ds_read_b64_tr_b16 v[78:79], v7 offset:20992
    v_mfma_f32_16x16x32_bf16 v[140:143], v[84:87], a[188:191], v[140:143]
    s_waitcnt lgkmcnt(4)
    v_mfma_f32_16x16x32_bf16 v[192:195], v[88:91], a[160:163], v[192:195]
    ds_read_b64_tr_b16 v[80:81], v7 offset:24576
    buffer_load_dwordx4 v[100:103], v20, s[20:23], s57 offen offset:0 sc1
    v_mfma_f32_16x16x32_bf16 v[192:195], v[92:95], a[176:179], v[192:195]
    v_mfma_f32_16x16x32_bf16 v[196:199], v[88:91], a[164:167], v[196:199]
    ds_read_b64_tr_b16 v[82:83], v7 offset:25088
    v_mfma_f32_16x16x32_bf16 v[196:199], v[92:95], a[180:183], v[196:199]
    v_mfma_f32_16x16x32_bf16 v[200:203], v[88:91], a[168:171], v[200:203]
    ds_read_b64_tr_b16 v[84:85], v7 offset:28672
    buffer_load_dwordx4 v[116:119], v20, s[20:23], s57 offen offset:1024 sc1
    v_mfma_f32_16x16x32_bf16 v[200:203], v[92:95], a[184:187], v[200:203]
    v_mfma_f32_16x16x32_bf16 v[204:207], v[88:91], a[172:175], v[204:207]
    ds_read_b64_tr_b16 v[86:87], v7 offset:29184
    v_mfma_f32_16x16x32_bf16 v[204:207], v[92:95], a[188:191], v[204:207]
    s_waitcnt lgkmcnt(4)
    v_mfma_f32_16x16x32_bf16 v[144:147], v[72:75], a[160:163], v[144:147]
    ds_read_b64_tr_b16 v[88:89], v8 offset:16384
    buffer_load_dwordx4 v[104:107], v21, s[20:23], s57 offen offset:0 sc1
    v_mfma_f32_16x16x32_bf16 v[144:147], v[76:79], a[176:179], v[144:147]
    v_mfma_f32_16x16x32_bf16 v[148:151], v[72:75], a[164:167], v[148:151]
    ds_read_b64_tr_b16 v[90:91], v8 offset:16896
    v_mfma_f32_16x16x32_bf16 v[148:151], v[76:79], a[180:183], v[148:151]
    v_mfma_f32_16x16x32_bf16 v[152:155], v[72:75], a[168:171], v[152:155]
    ds_read_b64_tr_b16 v[92:93], v8 offset:20480
    buffer_load_dwordx4 v[120:123], v21, s[20:23], s57 offen offset:1024 sc1
    v_mfma_f32_16x16x32_bf16 v[152:155], v[76:79], a[184:187], v[152:155]
    v_mfma_f32_16x16x32_bf16 v[156:159], v[72:75], a[172:175], v[156:159]
    ds_read_b64_tr_b16 v[94:95], v8 offset:20992
    v_mfma_f32_16x16x32_bf16 v[156:159], v[76:79], a[188:191], v[156:159]
    s_waitcnt lgkmcnt(4)
    v_mfma_f32_16x16x32_bf16 v[208:211], v[80:83], a[160:163], v[208:211]
    ds_read_b64_tr_b16 v[72:73], v8 offset:24576
    buffer_load_dwordx4 v[108:111], v22, s[20:23], s57 offen offset:0 sc1
    v_mfma_f32_16x16x32_bf16 v[208:211], v[84:87], a[176:179], v[208:211]
    v_mfma_f32_16x16x32_bf16 v[212:215], v[80:83], a[164:167], v[212:215]
    ds_read_b64_tr_b16 v[74:75], v8 offset:25088
    v_mfma_f32_16x16x32_bf16 v[212:215], v[84:87], a[180:183], v[212:215]
    v_mfma_f32_16x16x32_bf16 v[216:219], v[80:83], a[168:171], v[216:219]
    ds_read_b64_tr_b16 v[76:77], v8 offset:28672
    buffer_load_dwordx4 v[124:127], v22, s[20:23], s57 offen offset:1024 sc1
    v_mfma_f32_16x16x32_bf16 v[216:219], v[84:87], a[184:187], v[216:219]
    v_mfma_f32_16x16x32_bf16 v[220:223], v[80:83], a[172:175], v[220:223]
    ds_read_b64_tr_b16 v[78:79], v8 offset:29184
    v_mfma_f32_16x16x32_bf16 v[220:223], v[84:87], a[188:191], v[220:223]
    s_waitcnt lgkmcnt(4)
    v_mfma_f32_16x16x32_bf16 v[160:163], v[88:91], a[160:163], v[160:163]
    ds_read_b64_tr_b16 v[80:81], v9 offset:16384
    s_xor_b32 s94, s37, 12
    v_mfma_f32_16x16x32_bf16 v[160:163], v[92:95], a[176:179], v[160:163]
    s_sub_u32 s94, s94, s37
    v_mfma_f32_16x16x32_bf16 v[164:167], v[88:91], a[164:167], v[164:167]
    ds_read_b64_tr_b16 v[82:83], v9 offset:16896
    v_lshl_add_u32 v14, s94, 7, v14
    v_mfma_f32_16x16x32_bf16 v[164:167], v[92:95], a[180:183], v[164:167]
    v_lshl_add_u32 v15, s94, 7, v15
    v_mfma_f32_16x16x32_bf16 v[168:171], v[88:91], a[168:171], v[168:171]
    ds_read_b64_tr_b16 v[84:85], v9 offset:20480
    v_lshl_add_u32 v16, s94, 7, v16
    v_mfma_f32_16x16x32_bf16 v[168:171], v[92:95], a[184:187], v[168:171]
    v_lshl_add_u32 v17, s94, 7, v17
    v_mfma_f32_16x16x32_bf16 v[172:175], v[88:91], a[172:175], v[172:175]
    ds_read_b64_tr_b16 v[86:87], v9 offset:20992
    s_add_u32 m0, s38, 49152
    v_mfma_f32_16x16x32_bf16 v[172:175], v[92:95], a[188:191], v[172:175]
    buffer_load_dwordx4 v14, s[8:11], s40 offen lds
    s_waitcnt lgkmcnt(4)
    v_mfma_f32_16x16x32_bf16 v[224:227], v[72:75], a[160:163], v[224:227]
    ds_read_b64_tr_b16 v[88:89], v9 offset:24576
    v_mfma_f32_16x16x32_bf16 v[224:227], v[76:79], a[176:179], v[224:227]
    v_mfma_f32_16x16x32_bf16 v[228:231], v[72:75], a[164:167], v[228:231]
    ds_read_b64_tr_b16 v[90:91], v9 offset:25088
    v_mfma_f32_16x16x32_bf16 v[228:231], v[76:79], a[180:183], v[228:231]
    s_add_u32 m0, s38, 51200
    v_mfma_f32_16x16x32_bf16 v[232:235], v[72:75], a[168:171], v[232:235]
    ds_read_b64_tr_b16 v[92:93], v9 offset:28672
    buffer_load_dwordx4 v15, s[8:11], s40 offen lds
    v_mfma_f32_16x16x32_bf16 v[232:235], v[76:79], a[184:187], v[232:235]
    v_mfma_f32_16x16x32_bf16 v[236:239], v[72:75], a[172:175], v[236:239]
    ds_read_b64_tr_b16 v[94:95], v9 offset:29184
    v_mfma_f32_16x16x32_bf16 v[236:239], v[76:79], a[188:191], v[236:239]
    s_waitcnt lgkmcnt(4)
    v_mfma_f32_16x16x32_bf16 v[176:179], v[80:83], a[160:163], v[176:179]
    s_waitcnt vmcnt(34)
    s_barrier
    v_mfma_f32_16x16x32_bf16 v[176:179], v[84:87], a[176:179], v[176:179]
    ds_read_b64_tr_b16 v[72:73], v2 offset:0
    s_add_u32 m0, s38, 53248
    v_mfma_f32_16x16x32_bf16 v[180:183], v[80:83], a[164:167], v[180:183]
    ds_read_b64_tr_b16 v[74:75], v2 offset:512
    buffer_load_dwordx4 v16, s[8:11], s40 offen lds
    v_mfma_f32_16x16x32_bf16 v[180:183], v[84:87], a[180:183], v[180:183]
    ds_read_b64_tr_b16 v[76:77], v2 offset:4096
    s_add_u32 m0, s38, 65536
    v_mfma_f32_16x16x32_bf16 v[184:187], v[80:83], a[168:171], v[184:187]
    ds_read_b64_tr_b16 v[78:79], v2 offset:4608
    buffer_load_dwordx4 v14, s[8:11], s41 offen lds
    v_mfma_f32_16x16x32_bf16 v[184:187], v[84:87], a[184:187], v[184:187]
    v_mfma_f32_16x16x32_bf16 v[188:191], v[80:83], a[172:175], v[188:191]
    s_add_u32 m0, s38, 55296
    v_mfma_f32_16x16x32_bf16 v[188:191], v[84:87], a[188:191], v[188:191]
    buffer_load_dwordx4 v17, s[8:11], s40 offen lds
    s_waitcnt lgkmcnt(4)
    v_mfma_f32_16x16x32_bf16 v[240:243], v[88:91], a[160:163], v[240:243]
    ds_read_b64_tr_b16 v[80:81], v2 offset:8192
    s_add_u32 m0, s38, 67584
    v_mfma_f32_16x16x32_bf16 v[240:243], v[92:95], a[176:179], v[240:243]
    buffer_load_dwordx4 v15, s[8:11], s41 offen lds
    v_mfma_f32_16x16x32_bf16 v[244:247], v[88:91], a[164:167], v[244:247]
    ds_read_b64_tr_b16 v[82:83], v2 offset:8704
    v_mfma_f32_16x16x32_bf16 v[244:247], v[92:95], a[180:183], v[244:247]
    v_mfma_f32_16x16x32_bf16 v[248:251], v[88:91], a[168:171], v[248:251]
    ds_read_b64_tr_b16 v[84:85], v2 offset:12288
    v_mfma_f32_16x16x32_bf16 v[248:251], v[92:95], a[184:187], v[248:251]
    s_add_u32 m0, s38, 69632
    v_mfma_f32_16x16x32_bf16 v[252:255], v[88:91], a[172:175], v[252:255]
    ds_read_b64_tr_b16 v[86:87], v2 offset:12800
    buffer_load_dwordx4 v16, s[8:11], s41 offen lds
    v_mfma_f32_16x16x32_bf16 v[252:255], v[92:95], a[188:191], v[252:255]
    s_waitcnt vmcnt(31) lgkmcnt(4)
    v_mfma_f32_16x16x32_bf16 v[128:131], v[72:75], a[192:195], v[128:131]
    ds_read_b64_tr_b16 v[88:89], v3 offset:0
    v_mfma_f32_16x16x32_bf16 v[128:131], v[76:79], a[208:211], v[128:131]
    v_mfma_f32_16x16x32_bf16 v[132:135], v[72:75], a[196:199], v[132:135]
    ds_read_b64_tr_b16 v[90:91], v3 offset:512
    s_add_u32 m0, s38, 71680
    v_mfma_f32_16x16x32_bf16 v[132:135], v[76:79], a[212:215], v[132:135]
    buffer_load_dwordx4 v17, s[8:11], s41 offen lds
    v_mfma_f32_16x16x32_bf16 v[136:139], v[72:75], a[200:203], v[136:139]
    ds_read_b64_tr_b16 v[92:93], v3 offset:4096
    v_mfma_f32_16x16x32_bf16 v[136:139], v[76:79], a[216:219], v[136:139]
    v_mfma_f32_16x16x32_bf16 v[140:143], v[72:75], a[204:207], v[140:143]
    ds_read_b64_tr_b16 v[94:95], v3 offset:4608
    v_mfma_f32_16x16x32_bf16 v[140:143], v[76:79], a[220:223], v[140:143]
    s_waitcnt lgkmcnt(4)
    v_mfma_f32_16x16x32_bf16 v[192:195], v[80:83], a[192:195], v[192:195]
    ds_read_b64_tr_b16 v[72:73], v3 offset:8192
    v_mfma_f32_16x16x32_bf16 v[192:195], v[84:87], a[208:211], v[192:195]
    v_mfma_f32_16x16x32_bf16 v[196:199], v[80:83], a[196:199], v[196:199]
    ds_read_b64_tr_b16 v[74:75], v3 offset:8704
    v_mfma_f32_16x16x32_bf16 v[196:199], v[84:87], a[212:215], v[196:199]
    v_mfma_f32_16x16x32_bf16 v[200:203], v[80:83], a[200:203], v[200:203]
    ds_read_b64_tr_b16 v[76:77], v3 offset:12288
    v_mfma_f32_16x16x32_bf16 v[200:203], v[84:87], a[216:219], v[200:203]
    v_mfma_f32_16x16x32_bf16 v[204:207], v[80:83], a[204:207], v[204:207]
    ds_read_b64_tr_b16 v[78:79], v3 offset:12800
    v_mfma_f32_16x16x32_bf16 v[204:207], v[84:87], a[220:223], v[204:207]
    s_waitcnt lgkmcnt(4)
    v_mfma_f32_16x16x32_bf16 v[144:147], v[88:91], a[192:195], v[144:147]
    ds_read_b64_tr_b16 v[80:81], v4 offset:0
    v_mfma_f32_16x16x32_bf16 v[144:147], v[92:95], a[208:211], v[144:147]
    v_mfma_f32_16x16x32_bf16 v[148:151], v[88:91], a[196:199], v[148:151]
    ds_read_b64_tr_b16 v[82:83], v4 offset:512
    v_mfma_f32_16x16x32_bf16 v[148:151], v[92:95], a[212:215], v[148:151]
    v_mfma_f32_16x16x32_bf16 v[152:155], v[88:91], a[200:203], v[152:155]
    ds_read_b64_tr_b16 v[84:85], v4 offset:4096
    v_mfma_f32_16x16x32_bf16 v[152:155], v[92:95], a[216:219], v[152:155]
    v_mfma_f32_16x16x32_bf16 v[156:159], v[88:91], a[204:207], v[156:159]
    ds_read_b64_tr_b16 v[86:87], v4 offset:4608
    v_mfma_f32_16x16x32_bf16 v[156:159], v[92:95], a[220:223], v[156:159]
    s_waitcnt lgkmcnt(4)
    v_mfma_f32_16x16x32_bf16 v[208:211], v[72:75], a[192:195], v[208:211]
    ds_read_b64_tr_b16 v[88:89], v4 offset:8192
    v_mfma_f32_16x16x32_bf16 v[208:211], v[76:79], a[208:211], v[208:211]
    v_mfma_f32_16x16x32_bf16 v[212:215], v[72:75], a[196:199], v[212:215]
    ds_read_b64_tr_b16 v[90:91], v4 offset:8704
    v_mfma_f32_16x16x32_bf16 v[212:215], v[76:79], a[212:215], v[212:215]
    v_mfma_f32_16x16x32_bf16 v[216:219], v[72:75], a[200:203], v[216:219]
    ds_read_b64_tr_b16 v[92:93], v4 offset:12288
    v_mfma_f32_16x16x32_bf16 v[216:219], v[76:79], a[216:219], v[216:219]
    v_mfma_f32_16x16x32_bf16 v[220:223], v[72:75], a[204:207], v[220:223]
    ds_read_b64_tr_b16 v[94:95], v4 offset:12800
    v_mfma_f32_16x16x32_bf16 v[220:223], v[76:79], a[220:223], v[220:223]
    s_waitcnt lgkmcnt(4)
    v_mfma_f32_16x16x32_bf16 v[160:163], v[80:83], a[192:195], v[160:163]
    ds_read_b64_tr_b16 v[72:73], v5 offset:0
    v_mfma_f32_16x16x32_bf16 v[160:163], v[84:87], a[208:211], v[160:163]
    v_mfma_f32_16x16x32_bf16 v[164:167], v[80:83], a[196:199], v[164:167]
    ds_read_b64_tr_b16 v[74:75], v5 offset:512
    v_mfma_f32_16x16x32_bf16 v[164:167], v[84:87], a[212:215], v[164:167]
    v_mfma_f32_16x16x32_bf16 v[168:171], v[80:83], a[200:203], v[168:171]
    ds_read_b64_tr_b16 v[76:77], v5 offset:4096
    v_mfma_f32_16x16x32_bf16 v[168:171], v[84:87], a[216:219], v[168:171]
    v_mfma_f32_16x16x32_bf16 v[172:175], v[80:83], a[204:207], v[172:175]
    ds_read_b64_tr_b16 v[78:79], v5 offset:4608
    v_mfma_f32_16x16x32_bf16 v[172:175], v[84:87], a[220:223], v[172:175]
    s_waitcnt lgkmcnt(4)
    v_mfma_f32_16x16x32_bf16 v[224:227], v[88:91], a[192:195], v[224:227]
    ds_read_b64_tr_b16 v[80:81], v5 offset:8192
    v_mfma_f32_16x16x32_bf16 v[224:227], v[92:95], a[208:211], v[224:227]
    v_mfma_f32_16x16x32_bf16 v[228:231], v[88:91], a[196:199], v[228:231]
    ds_read_b64_tr_b16 v[82:83], v5 offset:8704
    v_mfma_f32_16x16x32_bf16 v[228:231], v[92:95], a[212:215], v[228:231]
    v_mfma_f32_16x16x32_bf16 v[232:235], v[88:91], a[200:203], v[232:235]
    ds_read_b64_tr_b16 v[84:85], v5 offset:12288
    v_mfma_f32_16x16x32_bf16 v[232:235], v[92:95], a[216:219], v[232:235]
    v_mfma_f32_16x16x32_bf16 v[236:239], v[88:91], a[204:207], v[236:239]
    ds_read_b64_tr_b16 v[86:87], v5 offset:12800
    v_mfma_f32_16x16x32_bf16 v[236:239], v[92:95], a[220:223], v[236:239]
    s_waitcnt lgkmcnt(4)
    v_mfma_f32_16x16x32_bf16 v[176:179], v[72:75], a[192:195], v[176:179]
    s_waitcnt vmcnt(28)
    s_barrier
    v_mfma_f32_16x16x32_bf16 v[176:179], v[76:79], a[208:211], v[176:179]
    ds_read_b64_tr_b16 v[88:89], v2 offset:16384
    s_add_u32 m0, s38, 81920
    v_mfma_f32_16x16x32_bf16 v[180:183], v[72:75], a[196:199], v[180:183]
    ds_read_b64_tr_b16 v[90:91], v2 offset:16896
    buffer_load_dwordx4 v14, s[8:11], s42 offen lds
    v_mfma_f32_16x16x32_bf16 v[180:183], v[76:79], a[212:215], v[180:183]
    ds_read_b64_tr_b16 v[92:93], v2 offset:20480
    v_mfma_f32_16x16x32_bf16 v[184:187], v[72:75], a[200:203], v[184:187]
    ds_read_b64_tr_b16 v[94:95], v2 offset:20992
    v_mfma_f32_16x16x32_bf16 v[184:187], v[76:79], a[216:219], v[184:187]
    v_mfma_f32_16x16x32_bf16 v[188:191], v[72:75], a[204:207], v[188:191]
    s_add_u32 m0, s38, 83968
    v_mfma_f32_16x16x32_bf16 v[188:191], v[76:79], a[220:223], v[188:191]
    buffer_load_dwordx4 v15, s[8:11], s42 offen lds
    s_waitcnt lgkmcnt(4)
    v_mfma_f32_16x16x32_bf16 v[240:243], v[80:83], a[192:195], v[240:243]
    ds_read_b64_tr_b16 v[72:73], v2 offset:24576
    v_mfma_f32_16x16x32_bf16 v[240:243], v[84:87], a[208:211], v[240:243]
    v_mfma_f32_16x16x32_bf16 v[244:247], v[80:83], a[196:199], v[244:247]
    ds_read_b64_tr_b16 v[74:75], v2 offset:25088
    v_mfma_f32_16x16x32_bf16 v[244:247], v[84:87], a[212:215], v[244:247]
    s_add_u32 m0, s38, 86016
    v_mfma_f32_16x16x32_bf16 v[248:251], v[80:83], a[200:203], v[248:251]
    ds_read_b64_tr_b16 v[76:77], v2 offset:28672
    buffer_load_dwordx4 v16, s[8:11], s42 offen lds
    v_mfma_f32_16x16x32_bf16 v[248:251], v[84:87], a[216:219], v[248:251]
    v_mfma_f32_16x16x32_bf16 v[252:255], v[80:83], a[204:207], v[252:255]
    ds_read_b64_tr_b16 v[78:79], v2 offset:29184
    v_mfma_f32_16x16x32_bf16 v[252:255], v[84:87], a[220:223], v[252:255]
    s_waitcnt vmcnt(23) lgkmcnt(4)
    v_mfma_f32_16x16x32_bf16 v[128:131], v[88:91], a[224:227], v[128:131]
    ds_read_b64_tr_b16 v[80:81], v3 offset:16384
    s_add_u32 m0, s38, 88064
    v_mfma_f32_16x16x32_bf16 v[128:131], v[92:95], a[240:243], v[128:131]
    buffer_load_dwordx4 v17, s[8:11], s42 offen lds
    v_mfma_f32_16x16x32_bf16 v[132:135], v[88:91], a[228:231], v[132:135]
    ds_read_b64_tr_b16 v[82:83], v3 offset:16896
    v_mfma_f32_16x16x32_bf16 v[132:135], v[92:95], a[244:247], v[132:135]
    v_mfma_f32_16x16x32_bf16 v[136:139], v[88:91], a[232:235], v[136:139]
    ds_read_b64_tr_b16 v[84:85], v3 offset:20480
    v_mfma_f32_16x16x32_bf16 v[136:139], v[92:95], a[248:251], v[136:139]
    v_mfma_f32_16x16x32_bf16 v[140:143], v[88:91], a[236:239], v[140:143]
    ds_read_b64_tr_b16 v[86:87], v3 offset:20992
    v_mfma_f32_16x16x32_bf16 v[140:143], v[92:95], a[252:255], v[140:143]
    s_waitcnt lgkmcnt(4)
    v_mfma_f32_16x16x32_bf16 v[192:195], v[72:75], a[224:227], v[192:195]
    ds_read_b64_tr_b16 v[88:89], v3 offset:24576
    v_mfma_f32_16x16x32_bf16 v[192:195], v[76:79], a[240:243], v[192:195]
    v_mfma_f32_16x16x32_bf16 v[196:199], v[72:75], a[228:231], v[196:199]
    ds_read_b64_tr_b16 v[90:91], v3 offset:25088
    v_mfma_f32_16x16x32_bf16 v[196:199], v[76:79], a[244:247], v[196:199]
    v_mfma_f32_16x16x32_bf16 v[200:203], v[72:75], a[232:235], v[200:203]
    ds_read_b64_tr_b16 v[92:93], v3 offset:28672
    v_mfma_f32_16x16x32_bf16 v[200:203], v[76:79], a[248:251], v[200:203]
    v_mfma_f32_16x16x32_bf16 v[204:207], v[72:75], a[236:239], v[204:207]
    ds_read_b64_tr_b16 v[94:95], v3 offset:29184
    v_mfma_f32_16x16x32_bf16 v[204:207], v[76:79], a[252:255], v[204:207]
    s_waitcnt lgkmcnt(4)
    v_mfma_f32_16x16x32_bf16 v[144:147], v[80:83], a[224:227], v[144:147]
    ds_read_b64_tr_b16 v[72:73], v4 offset:16384
    v_mfma_f32_16x16x32_bf16 v[144:147], v[84:87], a[240:243], v[144:147]
    v_mfma_f32_16x16x32_bf16 v[148:151], v[80:83], a[228:231], v[148:151]
    ds_read_b64_tr_b16 v[74:75], v4 offset:16896
    v_mfma_f32_16x16x32_bf16 v[148:151], v[84:87], a[244:247], v[148:151]
    v_mfma_f32_16x16x32_bf16 v[152:155], v[80:83], a[232:235], v[152:155]
    ds_read_b64_tr_b16 v[76:77], v4 offset:20480
    v_mfma_f32_16x16x32_bf16 v[152:155], v[84:87], a[248:251], v[152:155]
    v_mfma_f32_16x16x32_bf16 v[156:159], v[80:83], a[236:239], v[156:159]
    ds_read_b64_tr_b16 v[78:79], v4 offset:20992
    v_mfma_f32_16x16x32_bf16 v[156:159], v[84:87], a[252:255], v[156:159]
CH_B:
PG5:
    s_cbranch_execz PG6
    s_waitcnt lgkmcnt(4)
    v_mfma_f32_16x16x32_bf16 v[208:211], v[88:91], a[224:227], v[208:211]
    ds_read_b64_tr_b16 v[80:81], v4 offset:24576
    v_mfma_f32_16x16x32_bf16 v[208:211], v[92:95], a[240:243], v[208:211]
    v_mfma_f32_16x16x32_bf16 v[212:215], v[88:91], a[228:231], v[212:215]
    ds_read_b64_tr_b16 v[82:83], v4 offset:25088
    v_mfma_f32_16x16x32_bf16 v[212:215], v[92:95], a[244:247], v[212:215]
    v_mfma_f32_16x16x32_bf16 v[216:219], v[88:91], a[232:235], v[216:219]
    ds_read_b64_tr_b16 v[84:85], v4 offset:28672
    v_mfma_f32_16x16x32_bf16 v[216:219], v[92:95], a[248:251], v[216:219]
    v_mfma_f32_16x16x32_bf16 v[220:223], v[88:91], a[236:239], v[220:223]
    ds_read_b64_tr_b16 v[86:87], v4 offset:29184
    v_mfma_f32_16x16x32_bf16 v[220:223], v[92:95], a[252:255], v[220:223]
    s_waitcnt lgkmcnt(4)
    v_mfma_f32_16x16x32_bf16 v[160:163], v[72:75], a[224:227], v[160:163]
    ds_read_b64_tr_b16 v[88:89], v5 offset:16384
    v_mfma_f32_16x16x32_bf16 v[160:163], v[76:79], a[240:243], v[160:163]
    v_mfma_f32_16x16x32_bf16 v[164:167], v[72:75], a[228:231], v[164:167]
    ds_read_b64_tr_b16 v[90:91], v5 offset:16896
    v_mfma_f32_16x16x32_bf16 v[164:167], v[76:79], a[244:247], v[164:167]
    v_mfma_f32_16x16x32_bf16 v[168:171], v[72:75], a[232:235], v[168:171]
    ds_read_b64_tr_b16 v[92:93], v5 offset:20480
    v_mfma_f32_16x16x32_bf16 v[168:171], v[76:79], a[248:251], v[168:171]
    v_mfma_f32_16x16x32_bf16 v[172:175], v[72:75], a[236:239], v[172:175]
    ds_read_b64_tr_b16 v[94:95], v5 offset:20992
    v_mfma_f32_16x16x32_bf16 v[172:175], v[76:79], a[252:255], v[172:175]
    s_waitcnt lgkmcnt(4)
    v_mfma_f32_16x16x32_bf16 v[224:227], v[80:83], a[224:227], v[224:227]
    ds_read_b64_tr_b16 v[72:73], v5 offset:24576
    v_mfma_f32_16x16x32_bf16 v[224:227], v[84:87], a[240:243], v[224:227]
    v_mfma_f32_16x16x32_bf16 v[228:231], v[80:83], a[228:231], v[228:231]
    ds_read_b64_tr_b16 v[74:75], v5 offset:25088
    v_mfma_f32_16x16x32_bf16 v[228:231], v[84:87], a[244:247], v[228:231]
    v_mfma_f32_16x16x32_bf16 v[232:235], v[80:83], a[232:235], v[232:235]
    ds_read_b64_tr_b16 v[76:77], v5 offset:28672
    v_mfma_f32_16x16x32_bf16 v[232:235], v[84:87], a[248:251], v[232:235]
    v_mfma_f32_16x16x32_bf16 v[236:239], v[80:83], a[236:239], v[236:239]
    ds_read_b64_tr_b16 v[78:79], v5 offset:29184
    v_mfma_f32_16x16x32_bf16 v[236:239], v[84:87], a[252:255], v[236:239]
    s_waitcnt lgkmcnt(4)
    v_mfma_f32_16x16x32_bf16 v[176:179], v[88:91], a[224:227], v[176:179]
    s_waitcnt vmcnt(20)
    s_barrier
    v_mfma_f32_16x16x32_bf16 v[176:179], v[92:95], a[240:243], v[176:179]
    ds_read_b64_tr_b16 v[80:81], v2 offset:32768
    s_add_u32 m0, s38, 0
    v_mfma_f32_16x16x32_bf16 v[180:183], v[88:91], a[228:231], v[180:183]
    ds_read_b64_tr_b16 v[82:83], v2 offset:33280
    buffer_load_dwordx4 v14, s[8:11], s43 offen lds
    v_mfma_f32_16x16x32_bf16 v[180:183], v[92:95], a[244:247], v[180:183]
    ds_read_b64_tr_b16 v[84:85], v2 offset:36864
    v_mfma_f32_16x16x32_bf16 v[184:187], v[88:91], a[232:235], v[184:187]
    ds_read_b64_tr_b16 v[86:87], v2 offset:37376
    v_mfma_f32_16x16x32_bf16 v[184:187], v[92:95], a[248:251], v[184:187]
    v_mfma_f32_16x16x32_bf16 v[188:191], v[88:91], a[236:239], v[188:191]
    s_add_u32 m0, s38, 2048
    v_mfma_f32_16x16x32_bf16 v[188:191], v[92:95], a[252:255], v[188:191]
    buffer_load_dwordx4 v15, s[8:11], s43 offen lds
    s_waitcnt lgkmcnt(4)
    v_mfma_f32_16x16x32_bf16 v[240:243], v[72:75], a[224:227], v[240:243]
    ds_read_b64_tr_b16 v[88:89], v2 offset:40960
    v_mfma_f32_16x16x32_bf16 v[240:243], v[76:79], a[240:243], v[240:243]
    v_mfma_f32_16x16x32_bf16 v[244:247], v[72:75], a[228:231], v[244:247]
    ds_read_b64_tr_b16 v[90:91], v2 offset:41472
    v_mfma_f32_16x16x32_bf16 v[244:247], v[76:79], a[244:247], v[244:247]
    s_add_u32 m0, s38, 4096
    v_mfma_f32_16x16x32_bf16 v[248:251], v[72:75], a[232:235], v[248:251]
    ds_read_b64_tr_b16 v[92:93], v2 offset:45056
    buffer_load_dwordx4 v16, s[8:11], s43 offen lds
    v_mfma_f32_16x16x32_bf16 v[248:251], v[76:79], a[248:251], v[248:251]
    v_mfma_f32_16x16x32_bf16 v[252:255], v[72:75], a[236:239], v[252:255]
    ds_read_b64_tr_b16 v[94:95], v2 offset:45568
    v_mfma_f32_16x16x32_bf16 v[252:255], v[76:79], a[252:255], v[252:255]
    s_waitcnt vmcnt(15) lgkmcnt(4)
    v_mfma_f32_16x16x32_bf16 v[128:131], v[80:83], v[96:99], v[128:131]
    ds_read_b64_tr_b16 v[72:73], v3 offset:32768
    s_add_u32 m0, s38, 6144
    v_mfma_f32_16x16x32_bf16 v[128:131], v[84:87], v[112:115], v[128:131]
    buffer_load_dwordx4 v17, s[8:11], s43 offen lds
    v_mfma_f32_16x16x32_bf16 v[132:135], v[80:83], v[100:103], v[132:135]
    ds_read_b64_tr_b16 v[74:75], v3 offset:33280
    v_mfma_f32_16x16x32_bf16 v[132:135], v[84:87], v[116:119], v[132:135]
    v_mfma_f32_16x16x32_bf16 v[136:139], v[80:83], v[104:107], v[136:139]
    ds_read_b64_tr_b16 v[76:77], v3 offset:36864
    v_mfma_f32_16x16x32_bf16 v[136:139], v[84:87], v[120:123], v[136:139]
    v_mfma_f32_16x16x32_bf16 v[140:143], v[80:83], v[108:111], v[140:143]
    ds_read_b64_tr_b16 v[78:79], v3 offset:37376
    v_mfma_f32_16x16x32_bf16 v[140:143], v[84:87], v[124:127], v[140:143]
    s_waitcnt lgkmcnt(4)
    v_mfma_f32_16x16x32_bf16 v[192:195], v[88:91], v[96:99], v[192:195]
    ds_read_b64_tr_b16 v[80:81], v3 offset:40960
    v_mfma_f32_16x16x32_bf16 v[192:195], v[92:95], v[112:115], v[192:195]
    v_mfma_f32_16x16x32_bf16 v[196:199], v[88:91], v[100:103], v[196:199]
    ds_read_b64_tr_b16 v[82:83], v3 offset:41472
    v_mfma_f32_16x16x32_bf16 v[196:199], v[92:95], v[116:119], v[196:199]
    v_mfma_f32_16x16x32_bf16 v[200:203], v[88:91], v[104:107], v[200:203]
    ds_read_b64_tr_b16 v[84:85], v3 offset:45056
    v_mfma_f32_16x16x32_bf16 v[200:203], v[92:95], v[120:123], v[200:203]
    v_mfma_f32_16x16x32_bf16 v[204:207], v[88:91], v[108:111], v[204:207]
    ds_read_b64_tr_b16 v[86:87], v3 offset:45568
    v_mfma_f32_16x16x32_bf16 v[204:207], v[92:95], v[124:127], v[204:207]
    s_waitcnt lgkmcnt(4)
    v_mfma_f32_16x16x32_bf16 v[144:147], v[72:75], v[96:99], v[144:147]
    ds_read_b64_tr_b16 v[88:89], v4 offset:32768
    v_mfma_f32_16x16x32_bf16 v[144:147], v[76:79], v[112:115], v[144:147]
    v_mfma_f32_16x16x32_bf16 v[148:151], v[72:75], v[100:103], v[148:151]
    ds_read_b64_tr_b16 v[90:91], v4 offset:33280
    s_xor_b32 s69, s37, 0
    v_mfma_f32_16x16x32_bf16 v[148:151], v[76:79], v[116:119], v[148:151]
    s_lshl_b32 s69, s69, 11
    s_add_u32 s69, s69, s58
    v_mfma_f32_16x16x32_bf16 v[152:155], v[72:75], v[104:107], v[152:155]
    ds_read_b64_tr_b16 v[92:93], v4 offset:36864
    v_mul_f32 v128, v128, v192
    v_mfma_f32_16x16x32_bf16 v[152:155], v[76:79], v[120:123], v[152:155]
    v_mul_f32 v129, v129, v193
    v_mul_f32 v130, v130, v194
    v_mfma_f32_16x16x32_bf16 v[156:159], v[72:75], v[108:111], v[156:159]
    ds_read_b64_tr_b16 v[94:95], v4 offset:37376
    v_mul_f32 v131, v131, v195
    v_mfma_f32_16x16x32_bf16 v[156:159], v[76:79], v[124:127], v[156:159]
    v_cvt_pk_bf16_f32 v40, v128, v129
    s_waitcnt lgkmcnt(4)
    v_mfma_f32_16x16x32_bf16 v[208:211], v[80:83], v[96:99], v[208:211]
    ds_read_b64_tr_b16 v[72:73], v4 offset:40960
    v_cvt_pk_bf16_f32 v41, v130, v131
    v_mfma_f32_16x16x32_bf16 v[208:211], v[84:87], v[112:115], v[208:211]
    v_mul_f32 v132, v132, v196
    v_mul_f32 v133, v133, v197
    v_mfma_f32_16x16x32_bf16 v[212:215], v[80:83], v[100:103], v[212:215]
    ds_read_b64_tr_b16 v[74:75], v4 offset:41472
    v_mul_f32 v134, v134, v198
    v_mfma_f32_16x16x32_bf16 v[212:215], v[84:87], v[116:119], v[212:215]
    v_mul_f32 v135, v135, v199
    v_cvt_pk_bf16_f32 v44, v132, v133
    v_mfma_f32_16x16x32_bf16 v[216:219], v[80:83], v[104:107], v[216:219]
    ds_read_b64_tr_b16 v[76:77], v4 offset:45056
    v_cvt_pk_bf16_f32 v45, v134, v135
    v_mfma_f32_16x16x32_bf16 v[216:219], v[84:87], v[120:123], v[216:219]
    v_mul_f32 v136, v136, v200
    v_mul_f32 v137, v137, v201
    v_mfma_f32_16x16x32_bf16 v[220:223], v[80:83], v[108:111], v[220:223]
    ds_read_b64_tr_b16 v[78:79], v4 offset:45568
    v_mul_f32 v138, v138, v202
    v_mfma_f32_16x16x32_bf16 v[220:223], v[84:87], v[124:127], v[220:223]
    v_mul_f32 v139, v139, v203
    s_waitcnt lgkmcnt(4)
    v_mfma_f32_16x16x32_bf16 v[160:163], v[88:91], v[96:99], v[160:163]
    ds_read_b64_tr_b16 v[80:81], v5 offset:32768
    v_cvt_pk_bf16_f32 v48, v136, v137
    v_mfma_f32_16x16x32_bf16 v[160:163], v[92:95], v[112:115], v[160:163]
    v_cvt_pk_bf16_f32 v49, v138, v139
    v_mul_f32 v140, v140, v204
    v_mfma_f32_16x16x32_bf16 v[164:167], v[88:91], v[100:103], v[164:167]
    ds_read_b64_tr_b16 v[82:83], v5 offset:33280
    v_mul_f32 v141, v141, v205
    v_mfma_f32_16x16x32_bf16 v[164:167], v[92:95], v[116:119], v[164:167]
    v_mul_f32 v142, v142, v206
    v_mul_f32 v143, v143, v207
    v_mfma_f32_16x16x32_bf16 v[168:171], v[88:91], v[104:107], v[168:171]
    ds_read_b64_tr_b16 v[84:85], v5 offset:36864
    v_cvt_pk_bf16_f32 v52, v140, v141
    v_mfma_f32_16x16x32_bf16 v[168:171], v[92:95], v[120:123], v[168:171]
    v_cvt_pk_bf16_f32 v53, v142, v143
    v_mul_f32 v144, v144, v208
    v_mfma_f32_16x16x32_bf16 v[172:175], v[88:91], v[108:111], v[172:175]
    ds_read_b64_tr_b16 v[86:87], v5 offset:37376
    v_mul_f32 v145, v145, v209
    v_mfma_f32_16x16x32_bf16 v[172:175], v[92:95], v[124:127], v[172:175]
    v_mul_f32 v146, v146, v210
    s_waitcnt lgkmcnt(4)
    v_mfma_f32_16x16x32_bf16 v[224:227], v[72:75], v[96:99], v[224:227]
    ds_read_b64_tr_b16 v[88:89], v5 offset:40960
    v_mul_f32 v147, v147, v211
    v_mfma_f32_16x16x32_bf16 v[224:227], v[76:79], v[112:115], v[224:227]
    v_cvt_pk_bf16_f32 v42, v144, v145
    v_cvt_pk_bf16_f32 v43, v146, v147
    v_mfma_f32_16x16x32_bf16 v[228:231], v[72:75], v[100:103], v[228:231]
    ds_read_b64_tr_b16 v[90:91], v5 offset:41472
    buffer_store_dwordx4 v[40:43], v23, s[20:23], s69 offen offset:0 sc1
    v_mfma_f32_16x16x32_bf16 v[228:231], v[76:79], v[116:119], v[228:231]
    v_mul_f32 v148, v148, v212
    v_mul_f32 v149, v149, v213
    v_mfma_f32_16x16x32_bf16 v[232:235], v[72:75], v[104:107], v[232:235]
    ds_read_b64_tr_b16 v[92:93], v5 offset:45056
    v_mul_f32 v150, v150, v214
    v_mfma_f32_16x16x32_bf16 v[232:235], v[76:79], v[120:123], v[232:235]
    v_mul_f32 v151, v151, v215
    v_cvt_pk_bf16_f32 v46, v148, v149
    v_mfma_f32_16x16x32_bf16 v[236:239], v[72:75], v[108:111], v[236:239]
    ds_read_b64_tr_b16 v[94:95], v5 offset:45568
    v_cvt_pk_bf16_f32 v47, v150, v151
    v_mfma_f32_16x16x32_bf16 v[236:239], v[76:79], v[124:127], v[236:239]
    buffer_store_dwordx4 v[44:47], v24, s[20:23], s69 offen offset:0 sc1
    s_waitcnt lgkmcnt(4)
    v_mfma_f32_16x16x32_bf16 v[176:179], v[80:83], v[96:99], v[176:179]
    s_waitcnt vmcnt(13)
    s_barrier
    v_mfma_f32_16x16x32_bf16 v[176:179], v[84:87], v[112:115], v[176:179]
    ds_read_b64_tr_b16 v[72:73], v2 offset:49152
    s_add_u32 m0, s38, 16384
    v_mfma_f32_16x16x32_bf16 v[180:183], v[80:83], v[100:103], v[180:183]
    ds_read_b64_tr_b16 v[74:75], v2 offset:49664
    buffer_load_dwordx4 v14, s[8:11], s44 offen lds
    v_mfma_f32_16x16x32_bf16 v[180:183], v[84:87], v[116:119], v[180:183]
    ds_read_b64_tr_b16 v[76:77], v2 offset:53248
    v_mul_f32 v152, v152, v216
    v_mfma_f32_16x16x32_bf16 v[184:187], v[80:83], v[104:107], v[184:187]
    ds_read_b64_tr_b16 v[78:79], v2 offset:53760
    v_mul_f32 v153, v153, v217
    v_mfma_f32_16x16x32_bf16 v[184:187], v[84:87], v[120:123], v[184:187]
    v_mul_f32 v154, v154, v218
    v_mul_f32 v155, v155, v219
    v_mfma_f32_16x16x32_bf16 v[188:191], v[80:83], v[108:111], v[188:191]
    s_add_u32 m0, s38, 18432
    v_cvt_pk_bf16_f32 v50, v152, v153
    v_mfma_f32_16x16x32_bf16 v[188:191], v[84:87], v[124:127], v[188:191]
    buffer_load_dwordx4 v15, s[8:11], s44 offen lds
    s_waitcnt lgkmcnt(4)
    v_mfma_f32_16x16x32_bf16 v[240:243], v[88:91], v[96:99], v[240:243]
    ds_read_b64_tr_b16 v[80:81], v2 offset:57344
    v_cvt_pk_bf16_f32 v51, v154, v155
    v_mfma_f32_16x16x32_bf16 v[240:243], v[92:95], v[112:115], v[240:243]
    buffer_store_dwordx4 v[48:51], v25, s[20:23], s69 offen offset:0 sc1
    v_mul_f32 v156, v156, v220
    v_mfma_f32_16x16x32_bf16 v[244:247], v[88:91], v[100:103], v[244:247]
    ds_read_b64_tr_b16 v[82:83], v2 offset:57856
    v_mul_f32 v157, v157, v221
    v_mfma_f32_16x16x32_bf16 v[244:247], v[92:95], v[116:119], v[244:247]
    s_add_u32 m0, s38, 20480
    v_mul_f32 v158, v158, v222
    v_mfma_f32_16x16x32_bf16 v[248:251], v[88:91], v[104:107], v[248:251]
    ds_read_b64_tr_b16 v[84:85], v2 offset:61440
    buffer_load_dwordx4 v16, s[8:11], s44 offen lds
    v_mfma_f32_16x16x32_bf16 v[248:251], v[92:95], v[120:123], v[248:251]
    v_mul_f32 v159, v159, v223
    v_cvt_pk_bf16_f32 v54, v156, v157
    v_mfma_f32_16x16x32_bf16 v[252:255], v[88:91], v[108:111], v[252:255]
    ds_read_b64_tr_b16 v[86:87], v2 offset:61952
    v_cvt_pk_bf16_f32 v55, v158, v159
    v_mfma_f32_16x16x32_bf16 v[252:255], v[92:95], v[124:127], v[252:255]
    buffer_store_dwordx4 v[52:55], v26, s[20:23], s69 offen offset:0 sc1
    s_waitcnt lgkmcnt(4)
    v_mfma_f32_16x16x32_bf16 v[128:131], v[72:75], a[0:3], 0
    ds_read_b64_tr_b16 v[88:89], v3 offset:49152
    s_add_u32 m0, s38, 22528
    v_mfma_f32_16x16x32_bf16 v[128:131], v[76:79], a[16:19], v[128:131]
    buffer_load_dwordx4 v17, s[8:11], s44 offen lds
    v_mul_f32 v160, v160, v224
    v_mfma_f32_16x16x32_bf16 v[132:135], v[72:75], a[4:7], 0
    ds_read_b64_tr_b16 v[90:91], v3 offset:49664
    v_mul_f32 v161, v161, v225
    v_mfma_f32_16x16x32_bf16 v[132:135], v[76:79], a[20:23], v[132:135]
    v_mul_f32 v162, v162, v226
    v_mul_f32 v163, v163, v227
    v_mfma_f32_16x16x32_bf16 v[136:139], v[72:75], a[8:11], 0
    ds_read_b64_tr_b16 v[92:93], v3 offset:53248
    v_cvt_pk_bf16_f32 v56, v160, v161
    v_mfma_f32_16x16x32_bf16 v[136:139], v[76:79], a[24:27], v[136:139]
    v_cvt_pk_bf16_f32 v57, v162, v163
    v_mul_f32 v164, v164, v228
    v_mfma_f32_16x16x32_bf16 v[140:143], v[72:75], a[12:15], 0
    ds_read_b64_tr_b16 v[94:95], v3 offset:53760
    v_mul_f32 v165, v165, v229
    v_mfma_f32_16x16x32_bf16 v[140:143], v[76:79], a[28:31], v[140:143]
    v_mul_f32 v166, v166, v230
    s_waitcnt lgkmcnt(4)
    v_mfma_f32_16x16x32_bf16 v[192:195], v[80:83], a[0:3], 0
    ds_read_b64_tr_b16 v[72:73], v3 offset:57344
    v_mul_f32 v167, v167, v231
    v_mfma_f32_16x16x32_bf16 v[192:195], v[84:87], a[16:19], v[192:195]
    v_cvt_pk_bf16_f32 v60, v164, v165
    v_cvt_pk_bf16_f32 v61, v166, v167
    v_mfma_f32_16x16x32_bf16 v[196:199], v[80:83], a[4:7], 0
    ds_read_b64_tr_b16 v[74:75], v3 offset:57856
    v_mul_f32 v168, v168, v232
    v_mfma_f32_16x16x32_bf16 v[196:199], v[84:87], a[20:23], v[196:199]
    v_mul_f32 v169, v169, v233
    v_mul_f32 v170, v170, v234
    v_mfma_f32_16x16x32_bf16 v[200:203], v[80:83], a[8:11], 0
    ds_read_b64_tr_b16 v[76:77], v3 offset:61440
    v_mul_f32 v171, v171, v235
    v_mfma_f32_16x16x32_bf16 v[200:203], v[84:87], a[24:27], v[200:203]
    v_cvt_pk_bf16_f32 v64, v168, v169
    v_cvt_pk_bf16_f32 v65, v170, v171
    v_mfma_f32_16x16x32_bf16 v[204:207], v[80:83], a[12:15], 0
    ds_read_b64_tr_b16 v[78:79], v3 offset:61952
    v_mul_f32 v172, v172, v236
    v_mfma_f32_16x16x32_bf16 v[204:207], v[84:87], a[28:31], v[204:207]
    v_mul_f32 v173, v173, v237
    s_waitcnt lgkmcnt(4)
    v_mfma_f32_16x16x32_bf16 v[144:147], v[88:91], a[0:3], 0
    ds_read_b64_tr_b16 v[80:81], v4 offset:49152
    v_mul_f32 v174, v174, v238
    v_mfma_f32_16x16x32_bf16 v[144:147], v[92:95], a[16:19], v[144:147]
    v_mul_f32 v175, v175, v239
    v_cvt_pk_bf16_f32 v68, v172, v173
    v_mfma_f32_16x16x32_bf16 v[148:151], v[88:91], a[4:7], 0
    ds_read_b64_tr_b16 v[82:83], v4 offset:49664
    v_cvt_pk_bf16_f32 v69, v174, v175
    v_mfma_f32_16x16x32_bf16 v[148:151], v[92:95], a[20:23], v[148:151]
    v_mul_f32 v176, v176, v240
    v_mul_f32 v177, v177, v241
    v_mfma_f32_16x16x32_bf16 v[152:155], v[88:91], a[8:11], 0
    ds_read_b64_tr_b16 v[84:85], v4 offset:53248
    v_mul_f32 v178, v178, v242
    v_mfma_f32_16x16x32_bf16 v[152:155], v[92:95], a[24:27], v[152:155]
    v_mul_f32 v179, v179, v243
    v_cvt_pk_bf16_f32 v58, v176, v177
    v_mfma_f32_16x16x32_bf16 v[156:159], v[88:91], a[12:15], 0
    ds_read_b64_tr_b16 v[86:87], v4 offset:53760
    v_cvt_pk_bf16_f32 v59, v178, v179
    v_mfma_f32_16x16x32_bf16 v[156:159], v[92:95], a[28:31], v[156:159]
    buffer_store_dwordx4 v[56:59], v23, s[20:23], s69 offen offset:1024 sc1
    s_waitcnt lgkmcnt(4)
    v_mfma_f32_16x16x32_bf16 v[208:211], v[72:75], a[0:3], 0
    ds_read_b64_tr_b16 v[88:89], v4 offset:57344
    v_mul_f32 v180, v180, v244
    v_mfma_f32_16x16x32_bf16 v[208:211], v[76:79], a[16:19], v[208:211]
    v_mul_f32 v181, v181, v245
    v_mul_f32 v182, v182, v246
    v_mfma_f32_16x16x32_bf16 v[212:215], v[72:75], a[4:7], 0
    ds_read_b64_tr_b16 v[90:91], v4 offset:57856
    v_mul_f32 v183, v183, v247
    v_mfma_f32_16x16x32_bf16 v[212:215], v[76:79], a[20:23], v[212:215]
    v_cvt_pk_bf16_f32 v62, v180, v181
    v_cvt_pk_bf16_f32 v63, v182, v183
    v_mfma_f32_16x16x32_bf16 v[216:219], v[72:75], a[8:11], 0
    ds_read_b64_tr_b16 v[92:93], v4 offset:61440
    buffer_store_dwordx4 v[60:63], v24, s[20:23], s69 offen offset:1024 sc1
    v_mfma_f32_16x16x32_bf16 v[216:219], v[76:79], a[24:27], v[216:219]
    v_mul_f32 v184, v184, v248
    v_mul_f32 v185, v185, v249
    v_mfma_f32_16x16x32_bf16 v[220:223], v[72:75], a[12:15], 0
    ds_read_b64_tr_b16 v[94:95], v4 offset:61952
    v_mul_f32 v186, v186, v250
    v_mfma_f32_16x16x32_bf16 v[220:223], v[76:79], a[28:31], v[220:223]
    v_mul_f32 v187, v187, v251
    s_waitcnt lgkmcnt(4)
    v_mfma_f32_16x16x32_bf16 v[160:163], v[80:83], a[0:3], 0
    ds_read_b64_tr_b16 v[72:73], v5 offset:49152
    v_cvt_pk_bf16_f32 v66, v184, v185
    v_mfma_f32_16x16x32_bf16 v[160:163], v[84:87], a[16:19], v[160:163]
    v_cvt_pk_bf16_f32 v67, v186, v187
    buffer_store_dwordx4 v[64:67], v25, s[20:23], s69 offen offset:1024 sc1
    v_mfma_f32_16x16x32_bf16 v[164:167], v[80:83], a[4:7], 0
    ds_read_b64_tr_b16 v[74:75], v5 offset:49664
    v_mul_f32 v188, v188, v252
    v_mfma_f32_16x16x32_bf16 v[164:167], v[84:87], a[20:23], v[164:167]
    v_mul_f32 v189, v189, v253
    v_mul_f32 v190, v190, v254
    v_mfma_f32_16x16x32_bf16 v[168:171], v[80:83], a[8:11], 0
    ds_read_b64_tr_b16 v[76:77], v5 offset:53248
    v_mul_f32 v191, v191, v255
    v_mfma_f32_16x16x32_bf16 v[168:171], v[84:87], a[24:27], v[168:171]
    v_cvt_pk_bf16_f32 v70, v188, v189
    v_cvt_pk_bf16_f32 v71, v190, v191
    v_mfma_f32_16x16x32_bf16 v[172:175], v[80:83], a[12:15], 0
    ds_read_b64_tr_b16 v[78:79], v5 offset:53760
    buffer_store_dwordx4 v[68:71], v26, s[20:23], s69 offen offset:1024 sc1
    v_mfma_f32_16x16x32_bf16 v[172:175], v[84:87], a[28:31], v[172:175]
    s_waitcnt lgkmcnt(4)
    v_mfma_f32_16x16x32_bf16 v[224:227], v[88:91], a[0:3], 0
    ds_read_b64_tr_b16 v[80:81], v5 offset:57344
    v_mfma_f32_16x16x32_bf16 v[224:227], v[92:95], a[16:19], v[224:227]
    v_mfma_f32_16x16x32_bf16 v[228:231], v[88:91], a[4:7], 0
    ds_read_b64_tr_b16 v[82:83], v5 offset:57856
    v_mfma_f32_16x16x32_bf16 v[228:231], v[92:95], a[20:23], v[228:231]
    v_mfma_f32_16x16x32_bf16 v[232:235], v[88:91], a[8:11], 0
    ds_read_b64_tr_b16 v[84:85], v5 offset:61440
    v_mfma_f32_16x16x32_bf16 v[232:235], v[92:95], a[24:27], v[232:235]
    v_mfma_f32_16x16x32_bf16 v[236:239], v[88:91], a[12:15], 0
    ds_read_b64_tr_b16 v[86:87], v5 offset:61952
    v_mfma_f32_16x16x32_bf16 v[236:239], v[92:95], a[28:31], v[236:239]
    s_waitcnt lgkmcnt(4)
    v_mfma_f32_16x16x32_bf16 v[176:179], v[72:75], a[0:3], 0
    s_waitcnt vmcnt(20)
    s_barrier
    v_mfma_f32_16x16x32_bf16 v[176:179], v[76:79], a[16:19], v[176:179]
    ds_read_b64_tr_b16 v[88:89], v6 offset:0
    s_add_u32 m0, s38, 32768
    v_mfma_f32_16x16x32_bf16 v[180:183], v[72:75], a[4:7], 0
    ds_read_b64_tr_b16 v[90:91], v6 offset:512
    buffer_load_dwordx4 v14, s[8:11], s45 offen lds
    v_mfma_f32_16x16x32_bf16 v[180:183], v[76:79], a[20:23], v[180:183]
    ds_read_b64_tr_b16 v[92:93], v6 offset:4096
    v_mfma_f32_16x16x32_bf16 v[184:187], v[72:75], a[8:11], 0
    ds_read_b64_tr_b16 v[94:95], v6 offset:4608
    v_mfma_f32_16x16x32_bf16 v[184:187], v[76:79], a[24:27], v[184:187]
    v_mfma_f32_16x16x32_bf16 v[188:191], v[72:75], a[12:15], 0
    s_add_u32 m0, s38, 34816
    v_mfma_f32_16x16x32_bf16 v[188:191], v[76:79], a[28:31], v[188:191]
    buffer_load_dwordx4 v15, s[8:11], s45 offen lds
    s_waitcnt lgkmcnt(4)
    v_mfma_f32_16x16x32_bf16 v[240:243], v[80:83], a[0:3], 0
    ds_read_b64_tr_b16 v[72:73], v6 offset:8192
    v_mfma_f32_16x16x32_bf16 v[240:243], v[84:87], a[16:19], v[240:243]
    v_mfma_f32_16x16x32_bf16 v[244:247], v[80:83], a[4:7], 0
    ds_read_b64_tr_b16 v[74:75], v6 offset:8704
    v_mfma_f32_16x16x32_bf16 v[244:247], v[84:87], a[20:23], v[244:247]
    s_add_u32 m0, s38, 36864
    v_mfma_f32_16x16x32_bf16 v[248:251], v[80:83], a[8:11], 0
    ds_read_b64_tr_b16 v[76:77], v6 offset:12288
    buffer_load_dwordx4 v16, s[8:11], s45 offen lds
    v_mfma_f32_16x16x32_bf16 v[248:251], v[84:87], a[24:27], v[248:251]
    v_mfma_f32_16x16x32_bf16 v[252:255], v[80:83], a[12:15], 0
    ds_read_b64_tr_b16 v[78:79], v6 offset:12800
    v_mfma_f32_16x16x32_bf16 v[252:255], v[84:87], a[28:31], v[252:255]
    s_waitcnt lgkmcnt(4)
    v_mfma_f32_16x16x32_bf16 v[128:131], v[88:91], a[32:35], v[128:131]
    ds_read_b64_tr_b16 v[80:81], v7 offset:0
    s_add_u32 m0, s38, 38912
    v_mfma_f32_16x16x32_bf16 v[128:131], v[92:95], a[48:51], v[128:131]
    buffer_load_dwordx4 v17, s[8:11], s45 offen lds
    v_mfma_f32_16x16x32_bf16 v[132:135], v[88:91], a[36:39], v[132:135]
    ds_read_b64_tr_b16 v[82:83], v7 offset:512
    v_mfma_f32_16x16x32_bf16 v[132:135], v[92:95], a[52:55], v[132:135]
    s_mov_b32 s67, 34676736
    buffer_load_dwordx4 v[30:33], v23, s[20:23], s67 offen sc1
    v_mfma_f32_16x16x32_bf16 v[136:139], v[88:91], a[40:43], v[136:139]
    ds_read_b64_tr_b16 v[84:85], v7 offset:4096
    v_mfma_f32_16x16x32_bf16 v[136:139], v[92:95], a[56:59], v[136:139]
    v_mfma_f32_16x16x32_bf16 v[140:143], v[88:91], a[44:47], v[140:143]
    ds_read_b64_tr_b16 v[86:87], v7 offset:4608
    v_mfma_f32_16x16x32_bf16 v[140:143], v[92:95], a[60:63], v[140:143]
    s_waitcnt lgkmcnt(4)
    v_mfma_f32_16x16x32_bf16 v[192:195], v[72:75], a[32:35], v[192:195]
    ds_read_b64_tr_b16 v[88:89], v7 offset:8192
    v_mfma_f32_16x16x32_bf16 v[192:195], v[76:79], a[48:51], v[192:195]
    v_mfma_f32_16x16x32_bf16 v[196:199], v[72:75], a[36:39], v[196:199]
    ds_read_b64_tr_b16 v[90:91], v7 offset:8704
    v_mfma_f32_16x16x32_bf16 v[196:199], v[76:79], a[52:55], v[196:199]
    v_mfma_f32_16x16x32_bf16 v[200:203], v[72:75], a[40:43], v[200:203]
    ds_read_b64_tr_b16 v[92:93], v7 offset:12288
    v_mfma_f32_16x16x32_bf16 v[200:203], v[76:79], a[56:59], v[200:203]
    v_mfma_f32_16x16x32_bf16 v[204:207], v[72:75], a[44:47], v[204:207]
    ds_read_b64_tr_b16 v[94:95], v7 offset:12800
    v_mfma_f32_16x16x32_bf16 v[204:207], v[76:79], a[60:63], v[204:207]
    s_waitcnt lgkmcnt(4)
    v_mfma_f32_16x16x32_bf16 v[144:147], v[80:83], a[32:35], v[144:147]
    ds_read_b64_tr_b16 v[72:73], v8 offset:0
    v_mfma_f32_16x16x32_bf16 v[144:147], v[84:87], a[48:51], v[144:147]
    v_mfma_f32_16x16x32_bf16 v[148:151], v[80:83], a[36:39], v[148:151]
    ds_read_b64_tr_b16 v[74:75], v8 offset:512
    v_mfma_f32_16x16x32_bf16 v[148:151], v[84:87], a[52:55], v[148:151]
    v_mfma_f32_16x16x32_bf16 v[152:155], v[80:83], a[40:43], v[152:155]
    ds_read_b64_tr_b16 v[76:77], v8 offset:4096
    v_mfma_f32_16x16x32_bf16 v[152:155], v[84:87], a[56:59], v[152:155]
    v_mfma_f32_16x16x32_bf16 v[156:159], v[80:83], a[44:47], v[156:159]
    ds_read_b64_tr_b16 v[78:79], v8 offset:4608
    v_mfma_f32_16x16x32_bf16 v[156:159], v[84:87], a[60:63], v[156:159]
    s_waitcnt lgkmcnt(4)
    v_mfma_f32_16x16x32_bf16 v[208:211], v[88:91], a[32:35], v[208:211]
    ds_read_b64_tr_b16 v[80:81], v8 offset:8192
    v_mfma_f32_16x16x32_bf16 v[208:211], v[92:95], a[48:51], v[208:211]
    v_mfma_f32_16x16x32_bf16 v[212:215], v[88:91], a[36:39], v[212:215]
    ds_read_b64_tr_b16 v[82:83], v8 offset:8704
    v_mfma_f32_16x16x32_bf16 v[212:215], v[92:95], a[52:55], v[212:215]
    v_mfma_f32_16x16x32_bf16 v[216:219], v[88:91], a[40:43], v[216:219]
    ds_read_b64_tr_b16 v[84:85], v8 offset:12288
    v_mfma_f32_16x16x32_bf16 v[216:219], v[92:95], a[56:59], v[216:219]
    v_mfma_f32_16x16x32_bf16 v[220:223], v[88:91], a[44:47], v[220:223]
    ds_read_b64_tr_b16 v[86:87], v8 offset:12800
    v_mfma_f32_16x16x32_bf16 v[220:223], v[92:95], a[60:63], v[220:223]
    s_waitcnt lgkmcnt(4)
    v_mfma_f32_16x16x32_bf16 v[160:163], v[72:75], a[32:35], v[160:163]
    ds_read_b64_tr_b16 v[88:89], v9 offset:0
    v_mov_b32 v68, -1
    v_mfma_f32_16x16x32_bf16 v[160:163], v[76:79], a[48:51], v[160:163]
    v_mov_b32 v69, -1
    v_mov_b32 v70, -1
    v_mfma_f32_16x16x32_bf16 v[164:167], v[72:75], a[36:39], v[164:167]
    ds_read_b64_tr_b16 v[90:91], v9 offset:512
    v_mov_b32 v71, -1
    v_mfma_f32_16x16x32_bf16 v[164:167], v[76:79], a[52:55], v[164:167]
    v_mfma_f32_16x16x32_bf16 v[168:171], v[72:75], a[40:43], v[168:171]
    ds_read_b64_tr_b16 v[92:93], v9 offset:4096
    buffer_store_dwordx4 v[68:71], v23, s[20:23], s15 offen offset:0 sc1
    v_mfma_f32_16x16x32_bf16 v[168:171], v[76:79], a[56:59], v[168:171]
    v_mfma_f32_16x16x32_bf16 v[172:175], v[72:75], a[44:47], v[172:175]
    ds_read_b64_tr_b16 v[94:95], v9 offset:4608
    v_mfma_f32_16x16x32_bf16 v[172:175], v[76:79], a[60:63], v[172:175]
    s_waitcnt lgkmcnt(4)
    v_mfma_f32_16x16x32_bf16 v[224:227], v[80:83], a[32:35], v[224:227]
    ds_read_b64_tr_b16 v[72:73], v9 offset:8192
    v_mfma_f32_16x16x32_bf16 v[224:227], v[84:87], a[48:51], v[224:227]
    v_mfma_f32_16x16x32_bf16 v[228:231], v[80:83], a[36:39], v[228:231]
    ds_read_b64_tr_b16 v[74:75], v9 offset:8704
    buffer_store_dwordx4 v[68:71], v23, s[20:23], s12 offen offset:0 sc1
    v_mfma_f32_16x16x32_bf16 v[228:231], v[84:87], a[52:55], v[228:231]
    v_mfma_f32_16x16x32_bf16 v[232:235], v[80:83], a[40:43], v[232:235]
    ds_read_b64_tr_b16 v[76:77], v9 offset:12288
    v_mfma_f32_16x16x32_bf16 v[232:235], v[84:87], a[56:59], v[232:235]
    v_mfma_f32_16x16x32_bf16 v[236:239], v[80:83], a[44:47], v[236:239]
    ds_read_b64_tr_b16 v[78:79], v9 offset:12800
    v_mfma_f32_16x16x32_bf16 v[236:239], v[84:87], a[60:63], v[236:239]
    s_waitcnt lgkmcnt(4)
    v_mfma_f32_16x16x32_bf16 v[176:179], v[88:91], a[32:35], v[176:179]
    s_waitcnt vmcnt(23)
    s_barrier
    v_mfma_f32_16x16x32_bf16 v[176:179], v[92:95], a[48:51], v[176:179]
    ds_read_b64_tr_b16 v[80:81], v6 offset:16384
    s_add_u32 m0, s38, 49152
    v_mfma_f32_16x16x32_bf16 v[180:183], v[88:91], a[36:39], v[180:183]
    ds_read_b64_tr_b16 v[82:83], v6 offset:16896
    buffer_load_dwordx4 v14, s[8:11], s46 offen lds
    v_mfma_f32_16x16x32_bf16 v[180:183], v[92:95], a[52:55], v[180:183]
    ds_read_b64_tr_b16 v[84:85], v6 offset:20480
    buffer_store_dwordx4 v[68:71], v23, s[20:23], s12 offen offset:1024 sc1
    v_mfma_f32_16x16x32_bf16 v[184:187], v[88:91], a[40:43], v[184:187]
    ds_read_b64_tr_b16 v[86:87], v6 offset:20992
    v_mfma_f32_16x16x32_bf16 v[184:187], v[92:95], a[56:59], v[184:187]
    v_mfma_f32_16x16x32_bf16 v[188:191], v[88:91], a[44:47], v[188:191]
    s_add_u32 m0, s38, 51200
    v_mfma_f32_16x16x32_bf16 v[188:191], v[92:95], a[60:63], v[188:191]
    buffer_load_dwordx4 v15, s[8:11], s46 offen lds
    s_waitcnt lgkmcnt(4)
    v_mfma_f32_16x16x32_bf16 v[240:243], v[72:75], a[32:35], v[240:243]
    ds_read_b64_tr_b16 v[88:89], v6 offset:24576
    v_mfma_f32_16x16x32_bf16 v[240:243], v[76:79], a[48:51], v[240:243]
    buffer_store_dwordx4 v[68:71], v23, s[20:23], s13 offen offset:0 sc1
    v_mfma_f32_16x16x32_bf16 v[244:247], v[72:75], a[36:39], v[244:247]
    ds_read_b64_tr_b16 v[90:91], v6 offset:25088
    v_mfma_f32_16x16x32_bf16 v[244:247], v[76:79], a[52:55], v[244:247]
    s_add_u32 m0, s38, 53248
    v_mfma_f32_16x16x32_bf16 v[248:251], v[72:75], a[40:43], v[248:251]
    ds_read_b64_tr_b16 v[92:93], v6 offset:28672
    buffer_load_dwordx4 v16, s[8:11], s46 offen lds
    v_mfma_f32_16x16x32_bf16 v[248:251], v[76:79], a[56:59], v[248:251]
    v_mfma_f32_16x16x32_bf16 v[252:255], v[72:75], a[44:47], v[252:255]
    ds_read_b64_tr_b16 v[94:95], v6 offset:29184
    v_mfma_f32_16x16x32_bf16 v[252:255], v[76:79], a[60:63], v[252:255]
    buffer_store_dwordx4 v[68:71], v23, s[20:23], s13 offen offset:1024 sc1
    s_waitcnt lgkmcnt(4)
    v_mfma_f32_16x16x32_bf16 v[128:131], v[80:83], a[64:67], v[128:131]
    ds_read_b64_tr_b16 v[72:73], v7 offset:16384
    s_add_u32 m0, s38, 55296
    v_mfma_f32_16x16x32_bf16 v[128:131], v[84:87], a[80:83], v[128:131]
    buffer_load_dwordx4 v17, s[8:11], s46 offen lds
    v_mfma_f32_16x16x32_bf16 v[132:135], v[80:83], a[68:71], v[132:135]
    ds_read_b64_tr_b16 v[74:75], v7 offset:16896
    v_mfma_f32_16x16x32_bf16 v[132:135], v[84:87], a[84:87], v[132:135]
    s_waitcnt vmcnt(14)
    s_mov_b64 exec, 1
    buffer_store_dword v38, off, s[20:23], s90 offset:0 sc1
    s_mov_b64 exec, -1
    v_mfma_f32_16x16x32_bf16 v[136:139], v[80:83], a[72:75], v[136:139]
    ds_read_b64_tr_b16 v[76:77], v7 offset:20480
    v_mfma_f32_16x16x32_bf16 v[136:139], v[84:87], a[88:91], v[136:139]
    buffer_store_dwordx4 v[68:71], v23, s[20:23], s14 offen offset:0 sc1
    v_mfma_f32_16x16x32_bf16 v[140:143], v[80:83], a[76:79], v[140:143]
    ds_read_b64_tr_b16 v[78:79], v7 offset:20992
    v_mfma_f32_16x16x32_bf16 v[140:143], v[84:87], a[92:95], v[140:143]
    s_waitcnt lgkmcnt(4)
    v_mfma_f32_16x16x32_bf16 v[192:195], v[88:91], a[64:67], v[192:195]
    ds_read_b64_tr_b16 v[80:81], v7 offset:24576
    v_mfma_f32_16x16x32_bf16 v[192:195], v[92:95], a[80:83], v[192:195]
    v_mfma_f32_16x16x32_bf16 v[196:199], v[88:91], a[68:71], v[196:199]
    ds_read_b64_tr_b16 v[82:83], v7 offset:25088
    v_mfma_f32_16x16x32_bf16 v[196:199], v[92:95], a[84:87], v[196:199]
    buffer_store_dwordx4 v[68:71], v23, s[20:23], s14 offen offset:1024 sc1
    v_mfma_f32_16x16x32_bf16 v[200:203], v[88:91], a[72:75], v[200:203]
    ds_read_b64_tr_b16 v[84:85], v7 offset:28672
    v_mfma_f32_16x16x32_bf16 v[200:203], v[92:95], a[88:91], v[200:203]
    v_mfma_f32_16x16x32_bf16 v[204:207], v[88:91], a[76:79], v[204:207]
    ds_read_b64_tr_b16 v[86:87], v7 offset:29184
    v_mfma_f32_16x16x32_bf16 v[204:207], v[92:95], a[92:95], v[204:207]
    s_waitcnt lgkmcnt(4)
    v_mfma_f32_16x16x32_bf16 v[144:147], v[72:75], a[64:67], v[144:147]
PG6:
    s_cbranch_execz PG7
    ds_read_b64_tr_b16 v[88:89], v8 offset:16384
    v_mfma_f32_16x16x32_bf16 v[144:147], v[76:79], a[80:83], v[144:147]
    v_mfma_f32_16x16x32_bf16 v[148:151], v[72:75], a[68:71], v[148:151]
    ds_read_b64_tr_b16 v[90:91], v8 offset:16896
    v_mfma_f32_16x16x32_bf16 v[148:151], v[76:79], a[84:87], v[148:151]
    v_mfma_f32_16x16x32_bf16 v[152:155], v[72:75], a[72:75], v[152:155]
    ds_read_b64_tr_b16 v[92:93], v8 offset:20480
    v_mfma_f32_16x16x32_bf16 v[152:155], v[76:79], a[88:91], v[152:155]
    v_mfma_f32_16x16x32_bf16 v[156:159], v[72:75], a[76:79], v[156:159]
    ds_read_b64_tr_b16 v[94:95], v8 offset:20992
    v_mfma_f32_16x16x32_bf16 v[156:159], v[76:79], a[92:95], v[156:159]
    s_waitcnt lgkmcnt(4)
    v_mfma_f32_16x16x32_bf16 v[208:211], v[80:83], a[64:67], v[208:211]
    ds_read_b64_tr_b16 v[72:73], v8 offset:24576
    v_mfma_f32_16x16x32_bf16 v[208:211], v[84:87], a[80:83], v[208:211]
    v_mfma_f32_16x16x32_bf16 v[212:215], v[80:83], a[68:71], v[212:215]
    ds_read_b64_tr_b16 v[74:75], v8 offset:25088
    v_mfma_f32_16x16x32_bf16 v[212:215], v[84:87], a[84:87], v[212:215]
    v_mfma_f32_16x16x32_bf16 v[216:219], v[80:83], a[72:75], v[216:219]
    ds_read_b64_tr_b16 v[76:77], v8 offset:28672
    v_mfma_f32_16x16x32_bf16 v[216:219], v[84:87], a[88:91], v[216:219]
    v_mfma_f32_16x16x32_bf16 v[220:223], v[80:83], a[76:79], v[220:223]
    ds_read_b64_tr_b16 v[78:79], v8 offset:29184
    v_mfma_f32_16x16x32_bf16 v[220:223], v[84:87], a[92:95], v[220:223]
    s_waitcnt lgkmcnt(4)
    v_mfma_f32_16x16x32_bf16 v[160:163], v[88:91], a[64:67], v[160:163]
    ds_read_b64_tr_b16 v[80:81], v9 offset:16384
    v_mfma_f32_16x16x32_bf16 v[160:163], v[92:95], a[80:83], v[160:163]
    v_mfma_f32_16x16x32_bf16 v[164:167], v[88:91], a[68:71], v[164:167]
    ds_read_b64_tr_b16 v[82:83], v9 offset:16896
    v_mfma_f32_16x16x32_bf16 v[164:167], v[92:95], a[84:87], v[164:167]
    s_waitcnt vmcnt(12)
    v_xor_b32 v30, s59, v30
    v_mfma_f32_16x16x32_bf16 v[168:171], v[88:91], a[72:75], v[168:171]
    ds_read_b64_tr_b16 v[84:85], v9 offset:20480
    v_xor_b32 v31, s59, v31
    v_mfma_f32_16x16x32_bf16 v[168:171], v[92:95], a[88:91], v[168:171]
    v_xor_b32 v32, s59, v32
    v_xor_b32 v33, s59, v33
    v_mfma_f32_16x16x32_bf16 v[172:175], v[88:91], a[76:79], v[172:175]
    ds_read_b64_tr_b16 v[86:87], v9 offset:20992
    v_or3_b32 v30, v30, v31, v32
    v_mfma_f32_16x16x32_bf16 v[172:175], v[92:95], a[92:95], v[172:175]
    v_or_b32 v30, v30, v33
    s_waitcnt lgkmcnt(4)
    v_mfma_f32_16x16x32_bf16 v[224:227], v[72:75], a[64:67], v[224:227]
    ds_read_b64_tr_b16 v[88:89], v9 offset:24576
    v_cmp_ne_u32 vcc, 0, v30
    v_mfma_f32_16x16x32_bf16 v[224:227], v[76:79], a[80:83], v[224:227]
    s_cbranch_vccnz SLOW_xt
RET_xt:
    v_mul_u32_u24 v30, 9216, v1
    v_mfma_f32_16x16x32_bf16 v[228:231], v[72:75], a[68:71], v[228:231]
    ds_read_b64_tr_b16 v[90:91], v9 offset:25088
    s_cmp_eq_u32 s2, 0
    s_cselect_b32 s67, 0, 134217728
    v_mfma_f32_16x16x32_bf16 v[228:231], v[76:79], a[84:87], v[228:231]
    s_add_u32 s67, s67, 35127296
    s_mov_b64 exec, 1
    buffer_store_dword v38, off, s[20:23], s67 sc1
    s_mov_b64 exec, -1
    v_mfma_f32_16x16x32_bf16 v[232:235], v[72:75], a[72:75], v[232:235]
    ds_read_b64_tr_b16 v[92:93], v9 offset:28672
    v_mfma_f32_16x16x32_bf16 v[232:235], v[76:79], a[88:91], v[232:235]
    v_mfma_f32_16x16x32_bf16 v[236:239], v[72:75], a[76:79], v[236:239]
    ds_read_b64_tr_b16 v[94:95], v9 offset:29184
    v_mfma_f32_16x16x32_bf16 v[236:239], v[76:79], a[92:95], v[236:239]
    s_waitcnt lgkmcnt(4)
    v_mfma_f32_16x16x32_bf16 v[176:179], v[80:83], a[64:67], v[176:179]
    s_barrier
    v_mfma_f32_16x16x32_bf16 v[176:179], v[84:87], a[80:83], v[176:179]
    ds_read_b64_tr_b16 v[72:73], v2 offset:0
    s_add_u32 m0, s38, 65536
    v_mfma_f32_16x16x32_bf16 v[180:183], v[80:83], a[68:71], v[180:183]
    ds_read_b64_tr_b16 v[74:75], v2 offset:512
    buffer_load_dwordx4 v14, s[8:11], s47 offen lds
    v_mfma_f32_16x16x32_bf16 v[180:183], v[84:87], a[84:87], v[180:183]
    ds_read_b64_tr_b16 v[76:77], v2 offset:4096
    v_mfma_f32_16x16x32_bf16 v[184:187], v[80:83], a[72:75], v[184:187]
    ds_read_b64_tr_b16 v[78:79], v2 offset:4608
    v_mfma_f32_16x16x32_bf16 v[184:187], v[84:87], a[88:91], v[184:187]
    v_mfma_f32_16x16x32_bf16 v[188:191], v[80:83], a[76:79], v[188:191]
    s_add_u32 m0, s38, 67584
    v_mfma_f32_16x16x32_bf16 v[188:191], v[84:87], a[92:95], v[188:191]
    buffer_load_dwordx4 v15, s[8:11], s47 offen lds
    s_waitcnt lgkmcnt(4)
    v_mfma_f32_16x16x32_bf16 v[240:243], v[88:91], a[64:67], v[240:243]
    ds_read_b64_tr_b16 v[80:81], v2 offset:8192
    v_mfma_f32_16x16x32_bf16 v[240:243], v[92:95], a[80:83], v[240:243]
    v_mfma_f32_16x16x32_bf16 v[244:247], v[88:91], a[68:71], v[244:247]
    ds_read_b64_tr_b16 v[82:83], v2 offset:8704
    v_mfma_f32_16x16x32_bf16 v[244:247], v[92:95], a[84:87], v[244:247]
    s_add_u32 m0, s38, 69632
    v_mfma_f32_16x16x32_bf16 v[248:251], v[88:91], a[72:75], v[248:251]
    ds_read_b64_tr_b16 v[84:85], v2 offset:12288
    buffer_load_dwordx4 v16, s[8:11], s47 offen lds
    v_mfma_f32_16x16x32_bf16 v[248:251], v[92:95], a[88:91], v[248:251]
    v_mfma_f32_16x16x32_bf16 v[252:255], v[88:91], a[76:79], v[252:255]
    ds_read_b64_tr_b16 v[86:87], v2 offset:12800
    v_mfma_f32_16x16x32_bf16 v[252:255], v[92:95], a[92:95], v[252:255]
    s_waitcnt lgkmcnt(4)
    v_mfma_f32_16x16x32_bf16 v[128:131], v[72:75], a[96:99], v[128:131]
    ds_read_b64_tr_b16 v[88:89], v3 offset:0
    s_add_u32 m0, s38, 71680
    v_mfma_f32_16x16x32_bf16 v[128:131], v[76:79], a[112:115], v[128:131]
    buffer_load_dwordx4 v17, s[8:11], s47 offen lds
    v_mfma_f32_16x16x32_bf16 v[132:135], v[72:75], a[100:103], v[132:135]
    ds_read_b64_tr_b16 v[90:91], v3 offset:512
    v_mfma_f32_16x16x32_bf16 v[132:135], v[76:79], a[116:119], v[132:135]
    v_mfma_f32_16x16x32_bf16 v[136:139], v[72:75], a[104:107], v[136:139]
    ds_read_b64_tr_b16 v[92:93], v3 offset:4096
    v_mfma_f32_16x16x32_bf16 v[136:139], v[76:79], a[120:123], v[136:139]
    v_mfma_f32_16x16x32_bf16 v[140:143], v[72:75], a[108:111], v[140:143]
    ds_read_b64_tr_b16 v[94:95], v3 offset:4608
    v_mfma_f32_16x16x32_bf16 v[140:143], v[76:79], a[124:127], v[140:143]
    s_waitcnt lgkmcnt(4)
    v_mfma_f32_16x16x32_bf16 v[192:195], v[80:83], a[96:99], v[192:195]
    ds_read_b64_tr_b16 v[72:73], v3 offset:8192
    v_mfma_f32_16x16x32_bf16 v[192:195], v[84:87], a[112:115], v[192:195]
    v_mfma_f32_16x16x32_bf16 v[196:199], v[80:83], a[100:103], v[196:199]
    ds_read_b64_tr_b16 v[74:75], v3 offset:8704
    v_mfma_f32_16x16x32_bf16 v[196:199], v[84:87], a[116:119], v[196:199]
    v_mfma_f32_16x16x32_bf16 v[200:203], v[80:83], a[104:107], v[200:203]
    ds_read_b64_tr_b16 v[76:77], v3 offset:12288
    v_mfma_f32_16x16x32_bf16 v[200:203], v[84:87], a[120:123], v[200:203]
    v_mfma_f32_16x16x32_bf16 v[204:207], v[80:83], a[108:111], v[204:207]
    ds_read_b64_tr_b16 v[78:79], v3 offset:12800
    v_mfma_f32_16x16x32_bf16 v[204:207], v[84:87], a[124:127], v[204:207]
    s_waitcnt lgkmcnt(4)
    v_mfma_f32_16x16x32_bf16 v[144:147], v[88:91], a[96:99], v[144:147]
    ds_read_b64_tr_b16 v[80:81], v4 offset:0
    v_mfma_f32_16x16x32_bf16 v[144:147], v[92:95], a[112:115], v[144:147]
    v_mfma_f32_16x16x32_bf16 v[148:151], v[88:91], a[100:103], v[148:151]
    ds_read_b64_tr_b16 v[82:83], v4 offset:512
    v_mfma_f32_16x16x32_bf16 v[148:151], v[92:95], a[116:119], v[148:151]
    v_mfma_f32_16x16x32_bf16 v[152:155], v[88:91], a[104:107], v[152:155]
    ds_read_b64_tr_b16 v[84:85], v4 offset:4096
    v_mfma_f32_16x16x32_bf16 v[152:155], v[92:95], a[120:123], v[152:155]
    v_mfma_f32_16x16x32_bf16 v[156:159], v[88:91], a[108:111], v[156:159]
    ds_read_b64_tr_b16 v[86:87], v4 offset:4608
    v_mfma_f32_16x16x32_bf16 v[156:159], v[92:95], a[124:127], v[156:159]
    s_waitcnt lgkmcnt(4)
    v_mfma_f32_16x16x32_bf16 v[208:211], v[72:75], a[96:99], v[208:211]
    ds_read_b64_tr_b16 v[88:89], v4 offset:8192
    s_add_u32 s68, s4, 17152
    v_mfma_f32_16x16x32_bf16 v[208:211], v[76:79], a[112:115], v[208:211]
    s_add_u32 s67, s7, 0
    v_mfma_f32_16x16x32_bf16 v[212:215], v[72:75], a[100:103], v[212:215]
    ds_read_b64_tr_b16 v[90:91], v4 offset:8704
    s_min_u32 m0, s68, 162048
    v_mfma_f32_16x16x32_bf16 v[212:215], v[76:79], a[116:119], v[212:215]
    buffer_load_dwordx4 v30, s[20:23], s67 offen sc1 lds
    v_mfma_f32_16x16x32_bf16 v[216:219], v[72:75], a[104:107], v[216:219]
    ds_read_b64_tr_b16 v[92:93], v4 offset:12288
    v_mfma_f32_16x16x32_bf16 v[216:219], v[76:79], a[120:123], v[216:219]
    v_mfma_f32_16x16x32_bf16 v[220:223], v[72:75], a[108:111], v[220:223]
    ds_read_b64_tr_b16 v[94:95], v4 offset:12800
    v_mfma_f32_16x16x32_bf16 v[220:223], v[76:79], a[124:127], v[220:223]
    s_waitcnt lgkmcnt(4)
    v_mfma_f32_16x16x32_bf16 v[160:163], v[80:83], a[96:99], v[160:163]
    ds_read_b64_tr_b16 v[72:73], v5 offset:0
    v_mfma_f32_16x16x32_bf16 v[160:163], v[84:87], a[112:115], v[160:163]
    v_mfma_f32_16x16x32_bf16 v[164:167], v[80:83], a[100:103], v[164:167]
    ds_read_b64_tr_b16 v[74:75], v5 offset:512
    v_mfma_f32_16x16x32_bf16 v[164:167], v[84:87], a[116:119], v[164:167]
    v_mfma_f32_16x16x32_bf16 v[168:171], v[80:83], a[104:107], v[168:171]
    ds_read_b64_tr_b16 v[76:77], v5 offset:4096
    v_mfma_f32_16x16x32_bf16 v[168:171], v[84:87], a[120:123], v[168:171]
    v_mfma_f32_16x16x32_bf16 v[172:175], v[80:83], a[108:111], v[172:175]
    ds_read_b64_tr_b16 v[78:79], v5 offset:4608
    v_mfma_f32_16x16x32_bf16 v[172:175], v[84:87], a[124:127], v[172:175]
    s_waitcnt lgkmcnt(4)
    v_mfma_f32_16x16x32_bf16 v[224:227], v[88:91], a[96:99], v[224:227]
    ds_read_b64_tr_b16 v[80:81], v5 offset:8192
    v_mfma_f32_16x16x32_bf16 v[224:227], v[92:95], a[112:115], v[224:227]
    v_mfma_f32_16x16x32_bf16 v[228:231], v[88:91], a[100:103], v[228:231]
    ds_read_b64_tr_b16 v[82:83], v5 offset:8704
    v_mfma_f32_16x16x32_bf16 v[228:231], v[92:95], a[116:119], v[228:231]
    v_mfma_f32_16x16x32_bf16 v[232:235], v[88:91], a[104:107], v[232:235]
    ds_read_b64_tr_b16 v[84:85], v5 offset:12288
    v_mfma_f32_16x16x32_bf16 v[232:235], v[92:95], a[120:123], v[232:235]
    v_mfma_f32_16x16x32_bf16 v[236:239], v[88:91], a[108:111], v[236:239]
    ds_read_b64_tr_b16 v[86:87], v5 offset:12800
    v_mfma_f32_16x16x32_bf16 v[236:239], v[92:95], a[124:127], v[236:239]
    s_waitcnt lgkmcnt(4)
    v_mfma_f32_16x16x32_bf16 v[176:179], v[72:75], a[96:99], v[176:179]
    s_barrier
    v_mfma_f32_16x16x32_bf16 v[176:179], v[76:79], a[112:115], v[176:179]
    ds_read_b64_tr_b16 v[88:89], v2 offset:16384
    s_add_u32 m0, s38, 81920
    v_mfma_f32_16x16x32_bf16 v[180:183], v[72:75], a[100:103], v[180:183]
    ds_read_b64_tr_b16 v[90:91], v2 offset:16896
    buffer_load_dwordx4 v14, s[8:11], s48 offen lds
    v_mfma_f32_16x16x32_bf16 v[180:183], v[76:79], a[116:119], v[180:183]
    ds_read_b64_tr_b16 v[92:93], v2 offset:20480
    v_mfma_f32_16x16x32_bf16 v[184:187], v[72:75], a[104:107], v[184:187]
    ds_read_b64_tr_b16 v[94:95], v2 offset:20992
    v_mfma_f32_16x16x32_bf16 v[184:187], v[76:79], a[120:123], v[184:187]
    v_mfma_f32_16x16x32_bf16 v[188:191], v[72:75], a[108:111], v[188:191]
    s_add_u32 m0, s38, 83968
    v_mfma_f32_16x16x32_bf16 v[188:191], v[76:79], a[124:127], v[188:191]
    buffer_load_dwordx4 v15, s[8:11], s48 offen lds
    s_waitcnt lgkmcnt(4)
    v_mfma_f32_16x16x32_bf16 v[240:243], v[80:83], a[96:99], v[240:243]
    ds_read_b64_tr_b16 v[72:73], v2 offset:24576
    v_mfma_f32_16x16x32_bf16 v[240:243], v[84:87], a[112:115], v[240:243]
    v_mfma_f32_16x16x32_bf16 v[244:247], v[80:83], a[100:103], v[244:247]
    ds_read_b64_tr_b16 v[74:75], v2 offset:25088
    v_mfma_f32_16x16x32_bf16 v[244:247], v[84:87], a[116:119], v[244:247]
    s_add_u32 m0, s38, 86016
    v_mfma_f32_16x16x32_bf16 v[248:251], v[80:83], a[104:107], v[248:251]
    ds_read_b64_tr_b16 v[76:77], v2 offset:28672
    buffer_load_dwordx4 v16, s[8:11], s48 offen lds
    v_mfma_f32_16x16x32_bf16 v[248:251], v[84:87], a[120:123], v[248:251]
    v_mfma_f32_16x16x32_bf16 v[252:255], v[80:83], a[108:111], v[252:255]
    ds_read_b64_tr_b16 v[78:79], v2 offset:29184
    v_mfma_f32_16x16x32_bf16 v[252:255], v[84:87], a[124:127], v[252:255]
    s_waitcnt lgkmcnt(4)
    v_mfma_f32_16x16x32_bf16 v[128:131], v[88:91], a[128:131], v[128:131]
    ds_read_b64_tr_b16 v[80:81], v3 offset:16384
    s_add_u32 m0, s38, 88064
    v_mfma_f32_16x16x32_bf16 v[128:131], v[92:95], a[144:147], v[128:131]
    buffer_load_dwordx4 v17, s[8:11], s48 offen lds
    v_mfma_f32_16x16x32_bf16 v[132:135], v[88:91], a[132:135], v[132:135]
    ds_read_b64_tr_b16 v[82:83], v3 offset:16896
    v_mfma_f32_16x16x32_bf16 v[132:135], v[92:95], a[148:151], v[132:135]
    v_mfma_f32_16x16x32_bf16 v[136:139], v[88:91], a[136:139], v[136:139]
    ds_read_b64_tr_b16 v[84:85], v3 offset:20480
    v_mfma_f32_16x16x32_bf16 v[136:139], v[92:95], a[152:155], v[136:139]
    v_mfma_f32_16x16x32_bf16 v[140:143], v[88:91], a[140:143], v[140:143]
    ds_read_b64_tr_b16 v[86:87], v3 offset:20992
    v_mfma_f32_16x16x32_bf16 v[140:143], v[92:95], a[156:159], v[140:143]
    s_waitcnt lgkmcnt(4)
    v_mfma_f32_16x16x32_bf16 v[192:195], v[72:75], a[128:131], v[192:195]
    ds_read_b64_tr_b16 v[88:89], v3 offset:24576
    v_mfma_f32_16x16x32_bf16 v[192:195], v[76:79], a[144:147], v[192:195]
    v_mfma_f32_16x16x32_bf16 v[196:199], v[72:75], a[132:135], v[196:199]
    ds_read_b64_tr_b16 v[90:91], v3 offset:25088
    v_mfma_f32_16x16x32_bf16 v[196:199], v[76:79], a[148:151], v[196:199]
    v_mfma_f32_16x16x32_bf16 v[200:203], v[72:75], a[136:139], v[200:203]
    ds_read_b64_tr_b16 v[92:93], v3 offset:28672
    v_mfma_f32_16x16x32_bf16 v[200:203], v[76:79], a[152:155], v[200:203]
    v_mfma_f32_16x16x32_bf16 v[204:207], v[72:75], a[140:143], v[204:207]
    ds_read_b64_tr_b16 v[94:95], v3 offset:29184
    v_mfma_f32_16x16x32_bf16 v[204:207], v[76:79], a[156:159], v[204:207]
    s_waitcnt lgkmcnt(4)
    v_mfma_f32_16x16x32_bf16 v[144:147], v[80:83], a[128:131], v[144:147]
    ds_read_b64_tr_b16 v[72:73], v4 offset:16384
    v_mfma_f32_16x16x32_bf16 v[144:147], v[84:87], a[144:147], v[144:147]
    v_mfma_f32_16x16x32_bf16 v[148:151], v[80:83], a[132:135], v[148:151]
    ds_read_b64_tr_b16 v[74:75], v4 offset:16896
    v_mfma_f32_16x16x32_bf16 v[148:151], v[84:87], a[148:151], v[148:151]
    v_mfma_f32_16x16x32_bf16 v[152:155], v[80:83], a[136:139], v[152:155]
    ds_read_b64_tr_b16 v[76:77], v4 offset:20480
    v_mfma_f32_16x16x32_bf16 v[152:155], v[84:87], a[152:155], v[152:155]
    v_mfma_f32_16x16x32_bf16 v[156:159], v[80:83], a[140:143], v[156:159]
    ds_read_b64_tr_b16 v[78:79], v4 offset:20992
    v_mfma_f32_16x16x32_bf16 v[156:159], v[84:87], a[156:159], v[156:159]
    s_waitcnt lgkmcnt(4)
    v_mfma_f32_16x16x32_bf16 v[208:211], v[88:91], a[128:131], v[208:211]
    ds_read_b64_tr_b16 v[80:81], v4 offset:24576
    s_add_u32 s68, s4, 18176
    v_mfma_f32_16x16x32_bf16 v[208:211], v[92:95], a[144:147], v[208:211]
    s_add_u32 s67, s7, 589824
    v_mfma_f32_16x16x32_bf16 v[212:215], v[88:91], a[132:135], v[212:215]
    ds_read_b64_tr_b16 v[82:83], v4 offset:25088
    s_min_u32 m0, s68, 162048
    v_mfma_f32_16x16x32_bf16 v[212:215], v[92:95], a[148:151], v[212:215]
    buffer_load_dwordx4 v30, s[20:23], s67 offen sc1 lds
    v_mfma_f32_16x16x32_bf16 v[216:219], v[88:91], a[136:139], v[216:219]
    ds_read_b64_tr_b16 v[84:85], v4 offset:28672
    v_mfma_f32_16x16x32_bf16 v[216:219], v[92:95], a[152:155], v[216:219]
    v_mfma_f32_16x16x32_bf16 v[220:223], v[88:91], a[140:143], v[220:223]
    ds_read_b64_tr_b16 v[86:87], v4 offset:29184
    v_mfma_f32_16x16x32_bf16 v[220:223], v[92:95], a[156:159], v[220:223]
    s_waitcnt lgkmcnt(4)
    v_mfma_f32_16x16x32_bf16 v[160:163], v[72:75], a[128:131], v[160:163]
    ds_read_b64_tr_b16 v[88:89], v5 offset:16384
    v_mfma_f32_16x16x32_bf16 v[160:163], v[76:79], a[144:147], v[160:163]
    v_mfma_f32_16x16x32_bf16 v[164:167], v[72:75], a[132:135], v[164:167]
    ds_read_b64_tr_b16 v[90:91], v5 offset:16896
    v_mfma_f32_16x16x32_bf16 v[164:167], v[76:79], a[148:151], v[164:167]
    v_mfma_f32_16x16x32_bf16 v[168:171], v[72:75], a[136:139], v[168:171]
    ds_read_b64_tr_b16 v[92:93], v5 offset:20480
    v_mfma_f32_16x16x32_bf16 v[168:171], v[76:79], a[152:155], v[168:171]
    v_mfma_f32_16x16x32_bf16 v[172:175], v[72:75], a[140:143], v[172:175]
    ds_read_b64_tr_b16 v[94:95], v5 offset:20992
    v_mfma_f32_16x16x32_bf16 v[172:175], v[76:79], a[156:159], v[172:175]
    s_waitcnt lgkmcnt(4)
    v_mfma_f32_16x16x32_bf16 v[224:227], v[80:83], a[128:131], v[224:227]
    ds_read_b64_tr_b16 v[72:73], v5 offset:24576
    v_mfma_f32_16x16x32_bf16 v[224:227], v[84:87], a[144:147], v[224:227]
    v_mfma_f32_16x16x32_bf16 v[228:231], v[80:83], a[132:135], v[228:231]
    ds_read_b64_tr_b16 v[74:75], v5 offset:25088
    v_mfma_f32_16x16x32_bf16 v[228:231], v[84:87], a[148:151], v[228:231]
    v_mfma_f32_16x16x32_bf16 v[232:235], v[80:83], a[136:139], v[232:235]
    ds_read_b64_tr_b16 v[76:77], v5 offset:28672
    v_mfma_f32_16x16x32_bf16 v[232:235], v[84:87], a[152:155], v[232:235]
    v_mfma_f32_16x16x32_bf16 v[236:239], v[80:83], a[140:143], v[236:239]
    ds_read_b64_tr_b16 v[78:79], v5 offset:29184
    v_mfma_f32_16x16x32_bf16 v[236:239], v[84:87], a[156:159], v[236:239]
    s_waitcnt lgkmcnt(4)
    v_mfma_f32_16x16x32_bf16 v[176:179], v[88:91], a[128:131], v[176:179]
    s_barrier
    v_mfma_f32_16x16x32_bf16 v[176:179], v[92:95], a[144:147], v[176:179]
    ds_read_b64_tr_b16 v[80:81], v2 offset:32768
    s_add_u32 m0, s39, 0
    v_mfma_f32_16x16x32_bf16 v[180:183], v[88:91], a[132:135], v[180:183]
    ds_read_b64_tr_b16 v[82:83], v2 offset:33280
    buffer_load_dwordx4 v18, s[8:11], s40 offen lds
    v_mfma_f32_16x16x32_bf16 v[180:183], v[92:95], a[148:151], v[180:183]
    ds_read_b64_tr_b16 v[84:85], v2 offset:36864
    v_mfma_f32_16x16x32_bf16 v[184:187], v[88:91], a[136:139], v[184:187]
    ds_read_b64_tr_b16 v[86:87], v2 offset:37376
    v_mfma_f32_16x16x32_bf16 v[184:187], v[92:95], a[152:155], v[184:187]
    v_mfma_f32_16x16x32_bf16 v[188:191], v[88:91], a[140:143], v[188:191]
    s_add_u32 m0, s39, 4096
    v_mfma_f32_16x16x32_bf16 v[188:191], v[92:95], a[156:159], v[188:191]
    buffer_load_dwordx4 v18, s[8:11], s41 offen lds
    s_waitcnt lgkmcnt(4)
    v_mfma_f32_16x16x32_bf16 v[240:243], v[72:75], a[128:131], v[240:243]
    ds_read_b64_tr_b16 v[88:89], v2 offset:40960
    v_mfma_f32_16x16x32_bf16 v[240:243], v[76:79], a[144:147], v[240:243]
    v_mfma_f32_16x16x32_bf16 v[244:247], v[72:75], a[132:135], v[244:247]
    ds_read_b64_tr_b16 v[90:91], v2 offset:41472
    v_mfma_f32_16x16x32_bf16 v[244:247], v[76:79], a[148:151], v[244:247]
    s_add_u32 m0, s39, 8192
    v_mfma_f32_16x16x32_bf16 v[248:251], v[72:75], a[136:139], v[248:251]
    ds_read_b64_tr_b16 v[92:93], v2 offset:45056
    buffer_load_dwordx4 v18, s[8:11], s42 offen lds
    v_mfma_f32_16x16x32_bf16 v[248:251], v[76:79], a[152:155], v[248:251]
    v_mfma_f32_16x16x32_bf16 v[252:255], v[72:75], a[140:143], v[252:255]
    ds_read_b64_tr_b16 v[94:95], v2 offset:45568
    v_mfma_f32_16x16x32_bf16 v[252:255], v[76:79], a[156:159], v[252:255]
    s_waitcnt lgkmcnt(4)
    v_mfma_f32_16x16x32_bf16 v[128:131], v[80:83], a[160:163], v[128:131]
    ds_read_b64_tr_b16 v[72:73], v3 offset:32768
    s_add_u32 m0, s39, 12288
    v_mfma_f32_16x16x32_bf16 v[128:131], v[84:87], a[176:179], v[128:131]
    buffer_load_dwordx4 v18, s[8:11], s43 offen lds
    v_mfma_f32_16x16x32_bf16 v[132:135], v[80:83], a[164:167], v[132:135]
    ds_read_b64_tr_b16 v[74:75], v3 offset:33280
    v_mfma_f32_16x16x32_bf16 v[132:135], v[84:87], a[180:183], v[132:135]
    v_mfma_f32_16x16x32_bf16 v[136:139], v[80:83], a[168:171], v[136:139]
    ds_read_b64_tr_b16 v[76:77], v3 offset:36864
    v_mfma_f32_16x16x32_bf16 v[136:139], v[84:87], a[184:187], v[136:139]
    v_mfma_f32_16x16x32_bf16 v[140:143], v[80:83], a[172:175], v[140:143]
    ds_read_b64_tr_b16 v[78:79], v3 offset:37376
    v_mfma_f32_16x16x32_bf16 v[140:143], v[84:87], a[188:191], v[140:143]
    s_waitcnt lgkmcnt(4)
    v_mfma_f32_16x16x32_bf16 v[192:195], v[88:91], a[160:163], v[192:195]
    ds_read_b64_tr_b16 v[80:81], v3 offset:40960
    v_mfma_f32_16x16x32_bf16 v[192:195], v[92:95], a[176:179], v[192:195]
    v_mfma_f32_16x16x32_bf16 v[196:199], v[88:91], a[164:167], v[196:199]
    ds_read_b64_tr_b16 v[82:83], v3 offset:41472
    v_mfma_f32_16x16x32_bf16 v[196:199], v[92:95], a[180:183], v[196:199]
    v_mfma_f32_16x16x32_bf16 v[200:203], v[88:91], a[168:171], v[200:203]
    ds_read_b64_tr_b16 v[84:85], v3 offset:45056
    v_mfma_f32_16x16x32_bf16 v[200:203], v[92:95], a[184:187], v[200:203]
    v_mfma_f32_16x16x32_bf16 v[204:207], v[88:91], a[172:175], v[204:207]
    ds_read_b64_tr_b16 v[86:87], v3 offset:45568
    v_mfma_f32_16x16x32_bf16 v[204:207], v[92:95], a[188:191], v[204:207]
    s_waitcnt lgkmcnt(4)
    v_mfma_f32_16x16x32_bf16 v[144:147], v[72:75], a[160:163], v[144:147]
    ds_read_b64_tr_b16 v[88:89], v4 offset:32768
    v_mfma_f32_16x16x32_bf16 v[144:147], v[76:79], a[176:179], v[144:147]
    v_mfma_f32_16x16x32_bf16 v[148:151], v[72:75], a[164:167], v[148:151]
    ds_read_b64_tr_b16 v[90:91], v4 offset:33280
    v_mfma_f32_16x16x32_bf16 v[148:151], v[76:79], a[180:183], v[148:151]
    v_mfma_f32_16x16x32_bf16 v[152:155], v[72:75], a[168:171], v[152:155]
    ds_read_b64_tr_b16 v[92:93], v4 offset:36864
    v_mfma_f32_16x16x32_bf16 v[152:155], v[76:79], a[184:187], v[152:155]
    v_mfma_f32_16x16x32_bf16 v[156:159], v[72:75], a[172:175], v[156:159]
    ds_read_b64_tr_b16 v[94:95], v4 offset:37376
    v_mfma_f32_16x16x32_bf16 v[156:159], v[76:79], a[188:191], v[156:159]
    s_waitcnt lgkmcnt(4)
    v_mfma_f32_16x16x32_bf16 v[208:211], v[80:83], a[160:163], v[208:211]
    ds_read_b64_tr_b16 v[72:73], v4 offset:40960
    s_add_u32 s68, s4, 19200
    v_mfma_f32_16x16x32_bf16 v[208:211], v[84:87], a[176:179], v[208:211]
    s_add_u32 s67, s7, 1179648
    v_mfma_f32_16x16x32_bf16 v[212:215], v[80:83], a[164:167], v[212:215]
    ds_read_b64_tr_b16 v[74:75], v4 offset:41472
    s_min_u32 m0, s68, 162048
    v_mfma_f32_16x16x32_bf16 v[212:215], v[84:87], a[180:183], v[212:215]
    buffer_load_dwordx4 v30, s[20:23], s67 offen sc1 lds
    v_mfma_f32_16x16x32_bf16 v[216:219], v[80:83], a[168:171], v[216:219]
    ds_read_b64_tr_b16 v[76:77], v4 offset:45056
    v_mfma_f32_16x16x32_bf16 v[216:219], v[84:87], a[184:187], v[216:219]
    v_mfma_f32_16x16x32_bf16 v[220:223], v[80:83], a[172:175], v[220:223]
    ds_read_b64_tr_b16 v[78:79], v4 offset:45568
    v_mfma_f32_16x16x32_bf16 v[220:223], v[84:87], a[188:191], v[220:223]
    s_waitcnt lgkmcnt(4)
    v_mfma_f32_16x16x32_bf16 v[160:163], v[88:91], a[160:163], v[160:163]
    ds_read_b64_tr_b16 v[80:81], v5 offset:32768
    v_mfma_f32_16x16x32_bf16 v[160:163], v[92:95], a[176:179], v[160:163]
    v_mfma_f32_16x16x32_bf16 v[164:167], v[88:91], a[164:167], v[164:167]
    ds_read_b64_tr_b16 v[82:83], v5 offset:33280
    v_mfma_f32_16x16x32_bf16 v[164:167], v[92:95], a[180:183], v[164:167]
    v_mfma_f32_16x16x32_bf16 v[168:171], v[88:91], a[168:171], v[168:171]
    ds_read_b64_tr_b16 v[84:85], v5 offset:36864
    v_mfma_f32_16x16x32_bf16 v[168:171], v[92:95], a[184:187], v[168:171]
    v_mfma_f32_16x16x32_bf16 v[172:175], v[88:91], a[172:175], v[172:175]
    ds_read_b64_tr_b16 v[86:87], v5 offset:37376
    v_mfma_f32_16x16x32_bf16 v[172:175], v[92:95], a[188:191], v[172:175]
    s_waitcnt lgkmcnt(4)
    v_mfma_f32_16x16x32_bf16 v[224:227], v[72:75], a[160:163], v[224:227]
    ds_read_b64_tr_b16 v[88:89], v5 offset:40960
    v_mfma_f32_16x16x32_bf16 v[224:227], v[76:79], a[176:179], v[224:227]
    v_mfma_f32_16x16x32_bf16 v[228:231], v[72:75], a[164:167], v[228:231]
    ds_read_b64_tr_b16 v[90:91], v5 offset:41472
    v_mfma_f32_16x16x32_bf16 v[228:231], v[76:79], a[180:183], v[228:231]
    v_mfma_f32_16x16x32_bf16 v[232:235], v[72:75], a[168:171], v[232:235]
    ds_read_b64_tr_b16 v[92:93], v5 offset:45056
    v_mfma_f32_16x16x32_bf16 v[232:235], v[76:79], a[184:187], v[232:235]
    v_mfma_f32_16x16x32_bf16 v[236:239], v[72:75], a[172:175], v[236:239]
    ds_read_b64_tr_b16 v[94:95], v5 offset:45568
    v_mfma_f32_16x16x32_bf16 v[236:239], v[76:79], a[188:191], v[236:239]
    s_waitcnt lgkmcnt(4)
    v_mfma_f32_16x16x32_bf16 v[176:179], v[80:83], a[160:163], v[176:179]
    s_waitcnt vmcnt(19)
    s_barrier
    v_mfma_f32_16x16x32_bf16 v[176:179], v[84:87], a[176:179], v[176:179]
    ds_read_b64_tr_b16 v[72:73], v2 offset:49152
    s_add_u32 m0, s39, 16384
    v_mfma_f32_16x16x32_bf16 v[180:183], v[80:83], a[164:167], v[180:183]
    ds_read_b64_tr_b16 v[74:75], v2 offset:49664
    buffer_load_dwordx4 v18, s[8:11], s44 offen lds
    v_mfma_f32_16x16x32_bf16 v[180:183], v[84:87], a[180:183], v[180:183]
    ds_read_b64_tr_b16 v[76:77], v2 offset:53248
    v_mfma_f32_16x16x32_bf16 v[184:187], v[80:83], a[168:171], v[184:187]
    ds_read_b64_tr_b16 v[78:79], v2 offset:53760
    v_mfma_f32_16x16x32_bf16 v[184:187], v[84:87], a[184:187], v[184:187]
    v_mfma_f32_16x16x32_bf16 v[188:191], v[80:83], a[172:175], v[188:191]
    s_add_u32 m0, s39, 20480
    v_mfma_f32_16x16x32_bf16 v[188:191], v[84:87], a[188:191], v[188:191]
    buffer_load_dwordx4 v18, s[8:11], s45 offen lds
    s_waitcnt lgkmcnt(4)
    v_mfma_f32_16x16x32_bf16 v[240:243], v[88:91], a[160:163], v[240:243]
    ds_read_b64_tr_b16 v[80:81], v2 offset:57344
    v_mfma_f32_16x16x32_bf16 v[240:243], v[92:95], a[176:179], v[240:243]
    v_mfma_f32_16x16x32_bf16 v[244:247], v[88:91], a[164:167], v[244:247]
    ds_read_b64_tr_b16 v[82:83], v2 offset:57856
    v_mfma_f32_16x16x32_bf16 v[244:247], v[92:95], a[180:183], v[244:247]
    s_add_u32 m0, s39, 24576
    v_mfma_f32_16x16x32_bf16 v[248:251], v[88:91], a[168:171], v[248:251]
    ds_read_b64_tr_b16 v[84:85], v2 offset:61440
    buffer_load_dwordx4 v18, s[8:11], s46 offen lds
    v_mfma_f32_16x16x32_bf16 v[248:251], v[92:95], a[184:187], v[248:251]
    v_mfma_f32_16x16x32_bf16 v[252:255], v[88:91], a[172:175], v[252:255]
    ds_read_b64_tr_b16 v[86:87], v2 offset:61952
    v_mfma_f32_16x16x32_bf16 v[252:255], v[92:95], a[188:191], v[252:255]
    s_waitcnt lgkmcnt(4)
    v_mfma_f32_16x16x32_bf16 v[128:131], v[72:75], a[192:195], v[128:131]
    ds_read_b64_tr_b16 v[88:89], v3 offset:49152
    s_add_u32 m0, s39, 28672
    v_mfma_f32_16x16x32_bf16 v[128:131], v[76:79], a[208:211], v[128:131]
    buffer_load_dwordx4 v18, s[8:11], s47 offen lds
    v_mfma_f32_16x16x32_bf16 v[132:135], v[72:75], a[196:199], v[132:135]
    ds_read_b64_tr_b16 v[90:91], v3 offset:49664
    v_mfma_f32_16x16x32_bf16 v[132:135], v[76:79], a[212:215], v[132:135]
    v_mfma_f32_16x16x32_bf16 v[136:139], v[72:75], a[200:203], v[136:139]
    ds_read_b64_tr_b16 v[92:93], v3 offset:53248
    v_mfma_f32_16x16x32_bf16 v[136:139], v[76:79], a[216:219], v[136:139]
    v_mfma_f32_16x16x32_bf16 v[140:143], v[72:75], a[204:207], v[140:143]
    ds_read_b64_tr_b16 v[94:95], v3 offset:53760
    v_mfma_f32_16x16x32_bf16 v[140:143], v[76:79], a[220:223], v[140:143]
    s_waitcnt lgkmcnt(4)
    v_mfma_f32_16x16x32_bf16 v[192:195], v[80:83], a[192:195], v[192:195]
    ds_read_b64_tr_b16 v[72:73], v3 offset:57344
    v_mfma_f32_16x16x32_bf16 v[192:195], v[84:87], a[208:211], v[192:195]
    v_mfma_f32_16x16x32_bf16 v[196:199], v[80:83], a[196:199], v[196:199]
    ds_read_b64_tr_b16 v[74:75], v3 offset:57856
    v_mfma_f32_16x16x32_bf16 v[196:199], v[84:87], a[212:215], v[196:199]
    v_mfma_f32_16x16x32_bf16 v[200:203], v[80:83], a[200:203], v[200:203]
    ds_read_b64_tr_b16 v[76:77], v3 offset:61440
    v_mfma_f32_16x16x32_bf16 v[200:203], v[84:87], a[216:219], v[200:203]
    v_mfma_f32_16x16x32_bf16 v[204:207], v[80:83], a[204:207], v[204:207]
    ds_read_b64_tr_b16 v[78:79], v3 offset:61952
    v_mfma_f32_16x16x32_bf16 v[204:207], v[84:87], a[220:223], v[204:207]
    s_waitcnt lgkmcnt(4)
    v_mfma_f32_16x16x32_bf16 v[144:147], v[88:91], a[192:195], v[144:147]
    ds_read_b64_tr_b16 v[80:81], v4 offset:49152
    v_mfma_f32_16x16x32_bf16 v[144:147], v[92:95], a[208:211], v[144:147]
    v_mfma_f32_16x16x32_bf16 v[148:151], v[88:91], a[196:199], v[148:151]
    ds_read_b64_tr_b16 v[82:83], v4 offset:49664
    v_mfma_f32_16x16x32_bf16 v[148:151], v[92:95], a[212:215], v[148:151]
    v_mfma_f32_16x16x32_bf16 v[152:155], v[88:91], a[200:203], v[152:155]
    ds_read_b64_tr_b16 v[84:85], v4 offset:53248
    v_mfma_f32_16x16x32_bf16 v[152:155], v[92:95], a[216:219], v[152:155]
    v_mfma_f32_16x16x32_bf16 v[156:159], v[88:91], a[204:207], v[156:159]
    ds_read_b64_tr_b16 v[86:87], v4 offset:53760
    v_mfma_f32_16x16x32_bf16 v[156:159], v[92:95], a[220:223], v[156:159]
    s_waitcnt lgkmcnt(4)
    v_mfma_f32_16x16x32_bf16 v[208:211], v[72:75], a[192:195], v[208:211]
    ds_read_b64_tr_b16 v[88:89], v4 offset:57344
    s_add_u32 s68, s4, 20224
    v_mfma_f32_16x16x32_bf16 v[208:211], v[76:79], a[208:211], v[208:211]
    s_add_u32 s67, s7, 1769472
    v_mfma_f32_16x16x32_bf16 v[212:215], v[72:75], a[196:199], v[212:215]
    ds_read_b64_tr_b16 v[90:91], v4 offset:57856
    s_min_u32 m0, s68, 162048
    v_mfma_f32_16x16x32_bf16 v[212:215], v[76:79], a[212:215], v[212:215]
    buffer_load_dwordx4 v30, s[20:23], s67 offen sc1 lds
    v_mfma_f32_16x16x32_bf16 v[216:219], v[72:75], a[200:203], v[216:219]
    ds_read_b64_tr_b16 v[92:93], v4 offset:61440
    v_mfma_f32_16x16x32_bf16 v[216:219], v[76:79], a[216:219], v[216:219]
    v_mfma_f32_16x16x32_bf16 v[220:223], v[72:75], a[204:207], v[220:223]
    ds_read_b64_tr_b16 v[94:95], v4 offset:61952
    v_mfma_f32_16x16x32_bf16 v[220:223], v[76:79], a[220:223], v[220:223]
    s_waitcnt lgkmcnt(4)
    v_mfma_f32_16x16x32_bf16 v[160:163], v[80:83], a[192:195], v[160:163]
    ds_read_b64_tr_b16 v[72:73], v5 offset:49152
    v_mfma_f32_16x16x32_bf16 v[160:163], v[84:87], a[208:211], v[160:163]
    v_mfma_f32_16x16x32_bf16 v[164:167], v[80:83], a[196:199], v[164:167]
    ds_read_b64_tr_b16 v[74:75], v5 offset:49664
    v_mfma_f32_16x16x32_bf16 v[164:167], v[84:87], a[212:215], v[164:167]
    v_mfma_f32_16x16x32_bf16 v[168:171], v[80:83], a[200:203], v[168:171]
    ds_read_b64_tr_b16 v[76:77], v5 offset:53248
    v_mfma_f32_16x16x32_bf16 v[168:171], v[84:87], a[216:219], v[168:171]
    v_mfma_f32_16x16x32_bf16 v[172:175], v[80:83], a[204:207], v[172:175]
    ds_read_b64_tr_b16 v[78:79], v5 offset:53760
    v_mfma_f32_16x16x32_bf16 v[172:175], v[84:87], a[220:223], v[172:175]
    s_waitcnt lgkmcnt(4)
    v_mfma_f32_16x16x32_bf16 v[224:227], v[88:91], a[192:195], v[224:227]
    ds_read_b64_tr_b16 v[80:81], v5 offset:57344
    v_mfma_f32_16x16x32_bf16 v[224:227], v[92:95], a[208:211], v[224:227]
    v_mfma_f32_16x16x32_bf16 v[228:231], v[88:91], a[196:199], v[228:231]
    ds_read_b64_tr_b16 v[82:83], v5 offset:57856
    v_mfma_f32_16x16x32_bf16 v[228:231], v[92:95], a[212:215], v[228:231]
    v_mfma_f32_16x16x32_bf16 v[232:235], v[88:91], a[200:203], v[232:235]
    ds_read_b64_tr_b16 v[84:85], v5 offset:61440
    v_mfma_f32_16x16x32_bf16 v[232:235], v[92:95], a[216:219], v[232:235]
    v_mfma_f32_16x16x32_bf16 v[236:239], v[88:91], a[204:207], v[236:239]
    ds_read_b64_tr_b16 v[86:87], v5 offset:61952
    v_mfma_f32_16x16x32_bf16 v[236:239], v[92:95], a[220:223], v[236:239]
    s_waitcnt lgkmcnt(4)
    v_mfma_f32_16x16x32_bf16 v[176:179], v[72:75], a[192:195], v[176:179]
    s_waitcnt vmcnt(16)
    s_barrier
PG7:
    s_cbranch_execz PG8
    v_mfma_f32_16x16x32_bf16 v[176:179], v[76:79], a[208:211], v[176:179]
    ds_read_b64_tr_b16 v[88:89], v6 offset:0
    s_add_u32 m0, s39, 32768
    v_mfma_f32_16x16x32_bf16 v[180:183], v[72:75], a[196:199], v[180:183]
    ds_read_b64_tr_b16 v[90:91], v6 offset:512
    buffer_load_dwordx4 v18, s[8:11], s48 offen lds
    v_mfma_f32_16x16x32_bf16 v[180:183], v[76:79], a[212:215], v[180:183]
    ds_read_b64_tr_b16 v[92:93], v6 offset:4096
    v_mfma_f32_16x16x32_bf16 v[184:187], v[72:75], a[200:203], v[184:187]
    ds_read_b64_tr_b16 v[94:95], v6 offset:4608
    v_mfma_f32_16x16x32_bf16 v[184:187], v[76:79], a[216:219], v[184:187]
    v_mfma_f32_16x16x32_bf16 v[188:191], v[72:75], a[204:207], v[188:191]
    v_mfma_f32_16x16x32_bf16 v[188:191], v[76:79], a[220:223], v[188:191]
    s_waitcnt lgkmcnt(4)
    v_mfma_f32_16x16x32_bf16 v[240:243], v[80:83], a[192:195], v[240:243]
    ds_read_b64_tr_b16 v[72:73], v6 offset:8192
    v_mfma_f32_16x16x32_bf16 v[240:243], v[84:87], a[208:211], v[240:243]
    v_mfma_f32_16x16x32_bf16 v[244:247], v[80:83], a[196:199], v[244:247]
    ds_read_b64_tr_b16 v[74:75], v6 offset:8704
    v_mfma_f32_16x16x32_bf16 v[244:247], v[84:87], a[212:215], v[244:247]
    v_mfma_f32_16x16x32_bf16 v[248:251], v[80:83], a[200:203], v[248:251]
    ds_read_b64_tr_b16 v[76:77], v6 offset:12288
    v_mfma_f32_16x16x32_bf16 v[248:251], v[84:87], a[216:219], v[248:251]
    v_mfma_f32_16x16x32_bf16 v[252:255], v[80:83], a[204:207], v[252:255]
    ds_read_b64_tr_b16 v[78:79], v6 offset:12800
    v_mfma_f32_16x16x32_bf16 v[252:255], v[84:87], a[220:223], v[252:255]
    s_waitcnt lgkmcnt(4)
    v_mfma_f32_16x16x32_bf16 v[128:131], v[88:91], a[224:227], v[128:131]
    ds_read_b64_tr_b16 v[80:81], v7 offset:0
    v_mfma_f32_16x16x32_bf16 v[128:131], v[92:95], a[240:243], v[128:131]
    v_mfma_f32_16x16x32_bf16 v[132:135], v[88:91], a[228:231], v[132:135]
    ds_read_b64_tr_b16 v[82:83], v7 offset:512
    v_mfma_f32_16x16x32_bf16 v[132:135], v[92:95], a[244:247], v[132:135]
    v_mfma_f32_16x16x32_bf16 v[136:139], v[88:91], a[232:235], v[136:139]
    ds_read_b64_tr_b16 v[84:85], v7 offset:4096
    v_mfma_f32_16x16x32_bf16 v[136:139], v[92:95], a[248:251], v[136:139]
    v_mfma_f32_16x16x32_bf16 v[140:143], v[88:91], a[236:239], v[140:143]
    ds_read_b64_tr_b16 v[86:87], v7 offset:4608
    v_mfma_f32_16x16x32_bf16 v[140:143], v[92:95], a[252:255], v[140:143]
    s_waitcnt lgkmcnt(4)
    v_mfma_f32_16x16x32_bf16 v[192:195], v[72:75], a[224:227], v[192:195]
    ds_read_b64_tr_b16 v[88:89], v7 offset:8192
    v_mfma_f32_16x16x32_bf16 v[192:195], v[76:79], a[240:243], v[192:195]
    v_mfma_f32_16x16x32_bf16 v[196:199], v[72:75], a[228:231], v[196:199]
    ds_read_b64_tr_b16 v[90:91], v7 offset:8704
    v_mfma_f32_16x16x32_bf16 v[196:199], v[76:79], a[244:247], v[196:199]
    v_mfma_f32_16x16x32_bf16 v[200:203], v[72:75], a[232:235], v[200:203]
    ds_read_b64_tr_b16 v[92:93], v7 offset:12288
    v_mfma_f32_16x16x32_bf16 v[200:203], v[76:79], a[248:251], v[200:203]
    v_mfma_f32_16x16x32_bf16 v[204:207], v[72:75], a[236:239], v[204:207]
    ds_read_b64_tr_b16 v[94:95], v7 offset:12800
    v_mfma_f32_16x16x32_bf16 v[204:207], v[76:79], a[252:255], v[204:207]
    s_waitcnt lgkmcnt(4)
    v_mfma_f32_16x16x32_bf16 v[144:147], v[80:83], a[224:227], v[144:147]
    ds_read_b64_tr_b16 v[72:73], v8 offset:0
    v_mfma_f32_16x16x32_bf16 v[144:147], v[84:87], a[240:243], v[144:147]
    v_mfma_f32_16x16x32_bf16 v[148:151], v[80:83], a[228:231], v[148:151]
    ds_read_b64_tr_b16 v[74:75], v8 offset:512
    v_mfma_f32_16x16x32_bf16 v[148:151], v[84:87], a[244:247], v[148:151]
    v_mfma_f32_16x16x32_bf16 v[152:155], v[80:83], a[232:235], v[152:155]
    ds_read_b64_tr_b16 v[76:77], v8 offset:4096
    v_mfma_f32_16x16x32_bf16 v[152:155], v[84:87], a[248:251], v[152:155]
    v_mfma_f32_16x16x32_bf16 v[156:159], v[80:83], a[236:239], v[156:159]
    ds_read_b64_tr_b16 v[78:79], v8 offset:4608
    v_mfma_f32_16x16x32_bf16 v[156:159], v[84:87], a[252:255], v[156:159]
    s_waitcnt lgkmcnt(4)
    v_mfma_f32_16x16x32_bf16 v[208:211], v[88:91], a[224:227], v[208:211]
    ds_read_b64_tr_b16 v[80:81], v8 offset:8192
    v_mfma_f32_16x16x32_bf16 v[208:211], v[92:95], a[240:243], v[208:211]
    v_mfma_f32_16x16x32_bf16 v[212:215], v[88:91], a[228:231], v[212:215]
    ds_read_b64_tr_b16 v[82:83], v8 offset:8704
    v_mfma_f32_16x16x32_bf16 v[212:215], v[92:95], a[244:247], v[212:215]
    v_mfma_f32_16x16x32_bf16 v[216:219], v[88:91], a[232:235], v[216:219]
    ds_read_b64_tr_b16 v[84:85], v8 offset:12288
    v_mfma_f32_16x16x32_bf16 v[216:219], v[92:95], a[248:251], v[216:219]
    v_mfma_f32_16x16x32_bf16 v[220:223], v[88:91], a[236:239], v[220:223]
    ds_read_b64_tr_b16 v[86:87], v8 offset:12800
    v_mfma_f32_16x16x32_bf16 v[220:223], v[92:95], a[252:255], v[220:223]
    s_waitcnt lgkmcnt(4)
    v_mfma_f32_16x16x32_bf16 v[160:163], v[72:75], a[224:227], v[160:163]
    ds_read_b64_tr_b16 v[88:89], v9 offset:0
    v_mfma_f32_16x16x32_bf16 v[160:163], v[76:79], a[240:243], v[160:163]
    v_mfma_f32_16x16x32_bf16 v[164:167], v[72:75], a[228:231], v[164:167]
    ds_read_b64_tr_b16 v[90:91], v9 offset:512
    v_mfma_f32_16x16x32_bf16 v[164:167], v[76:79], a[244:247], v[164:167]
    v_mfma_f32_16x16x32_bf16 v[168:171], v[72:75], a[232:235], v[168:171]
    ds_read_b64_tr_b16 v[92:93], v9 offset:4096
    v_mfma_f32_16x16x32_bf16 v[168:171], v[76:79], a[248:251], v[168:171]
    v_mfma_f32_16x16x32_bf16 v[172:175], v[72:75], a[236:239], v[172:175]
    ds_read_b64_tr_b16 v[94:95], v9 offset:4608
    v_mfma_f32_16x16x32_bf16 v[172:175], v[76:79], a[252:255], v[172:175]
    s_waitcnt lgkmcnt(4)
    v_mfma_f32_16x16x32_bf16 v[224:227], v[80:83], a[224:227], v[224:227]
    ds_read_b64_tr_b16 v[72:73], v9 offset:8192
    v_mfma_f32_16x16x32_bf16 v[224:227], v[84:87], a[240:243], v[224:227]
    v_mfma_f32_16x16x32_bf16 v[228:231], v[80:83], a[228:231], v[228:231]
    ds_read_b64_tr_b16 v[74:75], v9 offset:8704
    v_mfma_f32_16x16x32_bf16 v[228:231], v[84:87], a[244:247], v[228:231]
    v_mfma_f32_16x16x32_bf16 v[232:235], v[80:83], a[232:235], v[232:235]
    ds_read_b64_tr_b16 v[76:77], v9 offset:12288
    v_mfma_f32_16x16x32_bf16 v[232:235], v[84:87], a[248:251], v[232:235]
    v_mfma_f32_16x16x32_bf16 v[236:239], v[80:83], a[236:239], v[236:239]
    ds_read_b64_tr_b16 v[78:79], v9 offset:12800
    v_mfma_f32_16x16x32_bf16 v[236:239], v[84:87], a[252:255], v[236:239]
    s_waitcnt lgkmcnt(4)
    v_mfma_f32_16x16x32_bf16 v[176:179], v[88:91], a[224:227], v[176:179]
    s_waitcnt vmcnt(12)
    s_barrier
    v_mfma_f32_16x16x32_bf16 v[176:179], v[92:95], a[240:243], v[176:179]
    ds_read_b64_tr_b16 v[80:81], v6 offset:16384
    v_mfma_f32_16x16x32_bf16 v[180:183], v[88:91], a[228:231], v[180:183]
    ds_read_b64_tr_b16 v[82:83], v6 offset:16896
    v_mfma_f32_16x16x32_bf16 v[180:183], v[92:95], a[244:247], v[180:183]
    ds_read_b64_tr_b16 v[84:85], v6 offset:20480
    buffer_load_dword v36, v35, s[20:23], 0 offen offset:0 sc1
    v_mfma_f32_16x16x32_bf16 v[184:187], v[88:91], a[232:235], v[184:187]
    ds_read_b64_tr_b16 v[86:87], v6 offset:20992
    v_mfma_f32_16x16x32_bf16 v[184:187], v[92:95], a[248:251], v[184:187]
    v_mfma_f32_16x16x32_bf16 v[188:191], v[88:91], a[236:239], v[188:191]
    v_mfma_f32_16x16x32_bf16 v[188:191], v[92:95], a[252:255], v[188:191]
    s_waitcnt lgkmcnt(4)
    v_mfma_f32_16x16x32_bf16 v[240:243], v[72:75], a[224:227], v[240:243]
    ds_read_b64_tr_b16 v[88:89], v6 offset:24576
    v_mfma_f32_16x16x32_bf16 v[240:243], v[76:79], a[240:243], v[240:243]
    v_mfma_f32_16x16x32_bf16 v[244:247], v[72:75], a[228:231], v[244:247]
    ds_read_b64_tr_b16 v[90:91], v6 offset:25088
    v_mfma_f32_16x16x32_bf16 v[244:247], v[76:79], a[244:247], v[244:247]
    v_mfma_f32_16x16x32_bf16 v[248:251], v[72:75], a[232:235], v[248:251]
    ds_read_b64_tr_b16 v[92:93], v6 offset:28672
    v_mfma_f32_16x16x32_bf16 v[248:251], v[76:79], a[248:251], v[248:251]
    v_mfma_f32_16x16x32_bf16 v[252:255], v[72:75], a[236:239], v[252:255]
    ds_read_b64_tr_b16 v[94:95], v6 offset:29184
    v_mfma_f32_16x16x32_bf16 v[252:255], v[76:79], a[252:255], v[252:255]
    s_waitcnt lgkmcnt(4)
    v_mfma_f32_16x16x32_bf16 v[128:131], v[80:83], v[96:99], v[128:131]
    ds_read_b64_tr_b16 v[72:73], v7 offset:16384
    v_mfma_f32_16x16x32_bf16 v[128:131], v[84:87], v[112:115], v[128:131]
    v_mfma_f32_16x16x32_bf16 v[132:135], v[80:83], v[100:103], v[132:135]
    ds_read_b64_tr_b16 v[74:75], v7 offset:16896
    v_mfma_f32_16x16x32_bf16 v[132:135], v[84:87], v[116:119], v[132:135]
    v_mfma_f32_16x16x32_bf16 v[136:139], v[80:83], v[104:107], v[136:139]
    ds_read_b64_tr_b16 v[76:77], v7 offset:20480
    v_mfma_f32_16x16x32_bf16 v[136:139], v[84:87], v[120:123], v[136:139]
    v_mfma_f32_16x16x32_bf16 v[140:143], v[80:83], v[108:111], v[140:143]
    ds_read_b64_tr_b16 v[78:79], v7 offset:20992
    v_mfma_f32_16x16x32_bf16 v[140:143], v[84:87], v[124:127], v[140:143]
    s_waitcnt lgkmcnt(4)
    v_mfma_f32_16x16x32_bf16 v[192:195], v[88:91], v[96:99], v[192:195]
    ds_read_b64_tr_b16 v[80:81], v7 offset:24576
    v_mfma_f32_16x16x32_bf16 v[192:195], v[92:95], v[112:115], v[192:195]
    v_mfma_f32_16x16x32_bf16 v[196:199], v[88:91], v[100:103], v[196:199]
    ds_read_b64_tr_b16 v[82:83], v7 offset:25088
    v_mfma_f32_16x16x32_bf16 v[196:199], v[92:95], v[116:119], v[196:199]
    v_mfma_f32_16x16x32_bf16 v[200:203], v[88:91], v[104:107], v[200:203]
    ds_read_b64_tr_b16 v[84:85], v7 offset:28672
    v_mfma_f32_16x16x32_bf16 v[200:203], v[92:95], v[120:123], v[200:203]
    v_mfma_f32_16x16x32_bf16 v[204:207], v[88:91], v[108:111], v[204:207]
    ds_read_b64_tr_b16 v[86:87], v7 offset:29184
    v_mfma_f32_16x16x32_bf16 v[204:207], v[92:95], v[124:127], v[204:207]
    s_waitcnt lgkmcnt(4)
    v_mfma_f32_16x16x32_bf16 v[144:147], v[72:75], v[96:99], v[144:147]
    ds_read_b64_tr_b16 v[88:89], v8 offset:16384
    v_mfma_f32_16x16x32_bf16 v[144:147], v[76:79], v[112:115], v[144:147]
    v_mfma_f32_16x16x32_bf16 v[148:151], v[72:75], v[100:103], v[148:151]
    ds_read_b64_tr_b16 v[90:91], v8 offset:16896
    s_xor_b32 s69, s37, 12
    v_mfma_f32_16x16x32_bf16 v[148:151], v[76:79], v[116:119], v[148:151]
    s_lshl_b32 s69, s69, 11
    s_add_u32 s69, s69, s58
    v_mfma_f32_16x16x32_bf16 v[152:155], v[72:75], v[104:107], v[152:155]
    ds_read_b64_tr_b16 v[92:93], v8 offset:20480
    v_mul_f32 v128, v128, v192
    v_mfma_f32_16x16x32_bf16 v[152:155], v[76:79], v[120:123], v[152:155]
    v_mul_f32 v129, v129, v193
    v_mul_f32 v130, v130, v194
    v_mfma_f32_16x16x32_bf16 v[156:159], v[72:75], v[108:111], v[156:159]
    ds_read_b64_tr_b16 v[94:95], v8 offset:20992
    v_mul_f32 v131, v131, v195
    v_mfma_f32_16x16x32_bf16 v[156:159], v[76:79], v[124:127], v[156:159]
    v_cvt_pk_bf16_f32 v40, v128, v129
    s_waitcnt lgkmcnt(4)
    v_mfma_f32_16x16x32_bf16 v[208:211], v[80:83], v[96:99], v[208:211]
    ds_read_b64_tr_b16 v[72:73], v8 offset:24576
    v_cvt_pk_bf16_f32 v41, v130, v131
    v_mfma_f32_16x16x32_bf16 v[208:211], v[84:87], v[112:115], v[208:211]
    v_mul_f32 v132, v132, v196
    v_mul_f32 v133, v133, v197
    v_mfma_f32_16x16x32_bf16 v[212:215], v[80:83], v[100:103], v[212:215]
    ds_read_b64_tr_b16 v[74:75], v8 offset:25088
    v_mul_f32 v134, v134, v198
    v_mfma_f32_16x16x32_bf16 v[212:215], v[84:87], v[116:119], v[212:215]
    v_mul_f32 v135, v135, v199
    v_cvt_pk_bf16_f32 v44, v132, v133
    v_mfma_f32_16x16x32_bf16 v[216:219], v[80:83], v[104:107], v[216:219]
    ds_read_b64_tr_b16 v[76:77], v8 offset:28672
    v_cvt_pk_bf16_f32 v45, v134, v135
    v_mfma_f32_16x16x32_bf16 v[216:219], v[84:87], v[120:123], v[216:219]
    v_mul_f32 v136, v136, v200
    v_mul_f32 v137, v137, v201
    v_mfma_f32_16x16x32_bf16 v[220:223], v[80:83], v[108:111], v[220:223]
    ds_read_b64_tr_b16 v[78:79], v8 offset:29184
    v_mul_f32 v138, v138, v202
    v_mfma_f32_16x16x32_bf16 v[220:223], v[84:87], v[124:127], v[220:223]
    v_mul_f32 v139, v139, v203
    s_waitcnt lgkmcnt(4)
    v_mfma_f32_16x16x32_bf16 v[160:163], v[88:91], v[96:99], v[160:163]
    ds_read_b64_tr_b16 v[80:81], v9 offset:16384
    v_cvt_pk_bf16_f32 v48, v136, v137
    v_mfma_f32_16x16x32_bf16 v[160:163], v[92:95], v[112:115], v[160:163]
    v_cvt_pk_bf16_f32 v49, v138, v139
    v_mul_f32 v140, v140, v204
    v_mfma_f32_16x16x32_bf16 v[164:167], v[88:91], v[100:103], v[164:167]
    ds_read_b64_tr_b16 v[82:83], v9 offset:16896
    v_mul_f32 v141, v141, v205
    v_mfma_f32_16x16x32_bf16 v[164:167], v[92:95], v[116:119], v[164:167]
    v_mul_f32 v142, v142, v206
    v_mul_f32 v143, v143, v207
    v_mfma_f32_16x16x32_bf16 v[168:171], v[88:91], v[104:107], v[168:171]
    ds_read_b64_tr_b16 v[84:85], v9 offset:20480
    v_cvt_pk_bf16_f32 v52, v140, v141
    v_mfma_f32_16x16x32_bf16 v[168:171], v[92:95], v[120:123], v[168:171]
    v_cvt_pk_bf16_f32 v53, v142, v143
    v_mul_f32 v144, v144, v208
    v_mfma_f32_16x16x32_bf16 v[172:175], v[88:91], v[108:111], v[172:175]
    ds_read_b64_tr_b16 v[86:87], v9 offset:20992
    v_mul_f32 v145, v145, v209
    v_mfma_f32_16x16x32_bf16 v[172:175], v[92:95], v[124:127], v[172:175]
    v_mul_f32 v146, v146, v210
    s_waitcnt lgkmcnt(4)
    v_mfma_f32_16x16x32_bf16 v[224:227], v[72:75], v[96:99], v[224:227]
    ds_read_b64_tr_b16 v[88:89], v9 offset:24576
    v_mul_f32 v147, v147, v211
    v_mfma_f32_16x16x32_bf16 v[224:227], v[76:79], v[112:115], v[224:227]
    v_cvt_pk_bf16_f32 v42, v144, v145
    v_cvt_pk_bf16_f32 v43, v146, v147
    v_mfma_f32_16x16x32_bf16 v[228:231], v[72:75], v[100:103], v[228:231]
    ds_read_b64_tr_b16 v[90:91], v9 offset:25088
    buffer_store_dwordx4 v[40:43], v23, s[20:23], s69 offen offset:0 sc1
    v_mfma_f32_16x16x32_bf16 v[228:231], v[76:79], v[116:119], v[228:231]
    v_mul_f32 v148, v148, v212
    v_mul_f32 v149, v149, v213
    v_mfma_f32_16x16x32_bf16 v[232:235], v[72:75], v[104:107], v[232:235]
    ds_read_b64_tr_b16 v[92:93], v9 offset:28672
    v_mul_f32 v150, v150, v214
    v_mfma_f32_16x16x32_bf16 v[232:235], v[76:79], v[120:123], v[232:235]
    v_mul_f32 v151, v151, v215
    v_cvt_pk_bf16_f32 v46, v148, v149
    v_mfma_f32_16x16x32_bf16 v[236:239], v[72:75], v[108:111], v[236:239]
    ds_read_b64_tr_b16 v[94:95], v9 offset:29184
    v_cvt_pk_bf16_f32 v47, v150, v151
    v_mfma_f32_16x16x32_bf16 v[236:239], v[76:79], v[124:127], v[236:239]
    buffer_store_dwordx4 v[44:47], v24, s[20:23], s69 offen offset:0 sc1
    s_waitcnt lgkmcnt(4)
    v_mfma_f32_16x16x32_bf16 v[176:179], v[80:83], v[96:99], v[176:179]
    s_waitcnt vmcnt(10)
    s_barrier
    v_mfma_f32_16x16x32_bf16 v[176:179], v[84:87], v[112:115], v[176:179]
    ds_read_b64_tr_b16 v[72:73], v10 offset:0
    v_mul_f32 v152, v152, v216
    v_mfma_f32_16x16x32_bf16 v[180:183], v[80:83], v[100:103], v[180:183]
    ds_read_b64_tr_b16 v[74:75], v11 offset:0
    v_mul_f32 v153, v153, v217
    v_mfma_f32_16x16x32_bf16 v[180:183], v[84:87], v[116:119], v[180:183]
    ds_read_b64_tr_b16 v[76:77], v10 offset:2048
    v_mul_f32 v154, v154, v218
    v_mfma_f32_16x16x32_bf16 v[184:187], v[80:83], v[104:107], v[184:187]
    ds_read_b64_tr_b16 v[78:79], v11 offset:2048
    v_mul_f32 v155, v155, v219
    v_mfma_f32_16x16x32_bf16 v[184:187], v[84:87], v[120:123], v[184:187]
    v_cvt_pk_bf16_f32 v50, v152, v153
    v_cvt_pk_bf16_f32 v51, v154, v155
    v_mfma_f32_16x16x32_bf16 v[188:191], v[80:83], v[108:111], v[188:191]
    buffer_store_dwordx4 v[48:51], v25, s[20:23], s69 offen offset:0 sc1
    v_mul_f32 v156, v156, v220
    v_mfma_f32_16x16x32_bf16 v[188:191], v[84:87], v[124:127], v[188:191]
    v_mul_f32 v157, v157, v221
    s_waitcnt lgkmcnt(4)
    v_mfma_f32_16x16x32_bf16 v[240:243], v[88:91], v[96:99], v[240:243]
    ds_read_b64_tr_b16 v[80:81], v10 offset:1024
    v_mul_f32 v158, v158, v222
    v_mfma_f32_16x16x32_bf16 v[240:243], v[92:95], v[112:115], v[240:243]
    v_mul_f32 v159, v159, v223
    v_cvt_pk_bf16_f32 v54, v156, v157
    v_mfma_f32_16x16x32_bf16 v[244:247], v[88:91], v[100:103], v[244:247]
    ds_read_b64_tr_b16 v[82:83], v11 offset:1024
    v_cvt_pk_bf16_f32 v55, v158, v159
    v_mfma_f32_16x16x32_bf16 v[244:247], v[92:95], v[116:119], v[244:247]
    buffer_store_dwordx4 v[52:55], v26, s[20:23], s69 offen offset:0 sc1
    v_mul_f32 v160, v160, v224
    v_mfma_f32_16x16x32_bf16 v[248:251], v[88:91], v[104:107], v[248:251]
    ds_read_b64_tr_b16 v[84:85], v10 offset:3072
    v_mul_f32 v161, v161, v225
    v_mfma_f32_16x16x32_bf16 v[248:251], v[92:95], v[120:123], v[248:251]
    v_mul_f32 v162, v162, v226
    v_mul_f32 v163, v163, v227
    v_mfma_f32_16x16x32_bf16 v[252:255], v[88:91], v[108:111], v[252:255]
    ds_read_b64_tr_b16 v[86:87], v11 offset:3072
    v_cvt_pk_bf16_f32 v56, v160, v161
    v_mfma_f32_16x16x32_bf16 v[252:255], v[92:95], v[124:127], v[252:255]
    v_cvt_pk_bf16_f32 v57, v162, v163
    s_waitcnt lgkmcnt(4)
    v_mfma_f32_16x16x32_bf16 v[128:131], v[72:75], a[0:3], 0
    ds_read_b64_tr_b16 v[88:89], v10 offset:4096
    v_mul_f32 v164, v164, v228
    v_mfma_f32_16x16x32_bf16 v[128:131], v[76:79], a[16:19], v[128:131]
    v_mul_f32 v165, v165, v229
    v_mul_f32 v166, v166, v230
    v_mfma_f32_16x16x32_bf16 v[132:135], v[72:75], a[4:7], 0
    ds_read_b64_tr_b16 v[90:91], v11 offset:4096
    v_mul_f32 v167, v167, v231
    v_mfma_f32_16x16x32_bf16 v[132:135], v[76:79], a[20:23], v[132:135]
    v_cvt_pk_bf16_f32 v60, v164, v165
    v_cvt_pk_bf16_f32 v61, v166, v167
    v_mfma_f32_16x16x32_bf16 v[136:139], v[72:75], a[8:11], 0
    ds_read_b64_tr_b16 v[92:93], v10 offset:6144
    v_mul_f32 v168, v168, v232
    v_mfma_f32_16x16x32_bf16 v[136:139], v[76:79], a[24:27], v[136:139]
    v_mul_f32 v169, v169, v233
    v_mul_f32 v170, v170, v234
    v_mfma_f32_16x16x32_bf16 v[140:143], v[72:75], a[12:15], 0
    ds_read_b64_tr_b16 v[94:95], v11 offset:6144
    v_mul_f32 v171, v171, v235
    v_mfma_f32_16x16x32_bf16 v[140:143], v[76:79], a[28:31], v[140:143]
    v_cvt_pk_bf16_f32 v64, v168, v169
    s_waitcnt lgkmcnt(4)
    v_mfma_f32_16x16x32_bf16 v[192:195], v[80:83], a[0:3], 0
    ds_read_b64_tr_b16 v[72:73], v10 offset:5120
    v_cvt_pk_bf16_f32 v65, v170, v171
    v_mfma_f32_16x16x32_bf16 v[192:195], v[84:87], a[16:19], v[192:195]
    v_mul_f32 v172, v172, v236
    v_mul_f32 v173, v173, v237
    v_mfma_f32_16x16x32_bf16 v[196:199], v[80:83], a[4:7], 0
    ds_read_b64_tr_b16 v[74:75], v11 offset:5120
    v_mul_f32 v174, v174, v238
    v_mfma_f32_16x16x32_bf16 v[196:199], v[84:87], a[20:23], v[196:199]
    v_mul_f32 v175, v175, v239
    v_cvt_pk_bf16_f32 v68, v172, v173
    v_mfma_f32_16x16x32_bf16 v[200:203], v[80:83], a[8:11], 0
    ds_read_b64_tr_b16 v[76:77], v10 offset:7168
    v_cvt_pk_bf16_f32 v69, v174, v175
    v_mfma_f32_16x16x32_bf16 v[200:203], v[84:87], a[24:27], v[200:203]
    v_mul_f32 v176, v176, v240
    v_mul_f32 v177, v177, v241
    v_mfma_f32_16x16x32_bf16 v[204:207], v[80:83], a[12:15], 0
    ds_read_b64_tr_b16 v[78:79], v11 offset:7168
    v_mul_f32 v178, v178, v242
    v_mfma_f32_16x16x32_bf16 v[204:207], v[84:87], a[28:31], v[204:207]
    v_mul_f32 v179, v179, v243
    s_waitcnt lgkmcnt(4)
    v_mfma_f32_16x16x32_bf16 v[128:131], v[88:91], a[32:35], v[128:131]
    ds_read_b64_tr_b16 v[80:81], v10 offset:8192
    v_cvt_pk_bf16_f32 v58, v176, v177
    v_mfma_f32_16x16x32_bf16 v[128:131], v[92:95], a[48:51], v[128:131]
    v_cvt_pk_bf16_f32 v59, v178, v179
    buffer_store_dwordx4 v[56:59], v23, s[20:23], s69 offen offset:1024 sc1
    v_mfma_f32_16x16x32_bf16 v[132:135], v[88:91], a[36:39], v[132:135]
    ds_read_b64_tr_b16 v[82:83], v11 offset:8192
    v_mul_f32 v180, v180, v244
    v_mfma_f32_16x16x32_bf16 v[132:135], v[92:95], a[52:55], v[132:135]
    v_mul_f32 v181, v181, v245
    v_mul_f32 v182, v182, v246
    v_mfma_f32_16x16x32_bf16 v[136:139], v[88:91], a[40:43], v[136:139]
    ds_read_b64_tr_b16 v[84:85], v10 offset:10240
    v_mul_f32 v183, v183, v247
    v_mfma_f32_16x16x32_bf16 v[136:139], v[92:95], a[56:59], v[136:139]
    v_cvt_pk_bf16_f32 v62, v180, v181
    v_cvt_pk_bf16_f32 v63, v182, v183
    v_mfma_f32_16x16x32_bf16 v[140:143], v[88:91], a[44:47], v[140:143]
    ds_read_b64_tr_b16 v[86:87], v11 offset:10240
    buffer_store_dwordx4 v[60:63], v24, s[20:23], s69 offen offset:1024 sc1
    v_mfma_f32_16x16x32_bf16 v[140:143], v[92:95], a[60:63], v[140:143]
    v_mul_f32 v184, v184, v248
    s_waitcnt lgkmcnt(4)
    v_mfma_f32_16x16x32_bf16 v[192:195], v[72:75], a[32:35], v[192:195]
    ds_read_b64_tr_b16 v[88:89], v10 offset:9216
    v_mul_f32 v185, v185, v249
    v_mfma_f32_16x16x32_bf16 v[192:195], v[76:79], a[48:51], v[192:195]
    v_mul_f32 v186, v186, v250
    v_mul_f32 v187, v187, v251
    v_mfma_f32_16x16x32_bf16 v[196:199], v[72:75], a[36:39], v[196:199]
    ds_read_b64_tr_b16 v[90:91], v11 offset:9216
    v_cvt_pk_bf16_f32 v66, v184, v185
    v_mfma_f32_16x16x32_bf16 v[196:199], v[76:79], a[52:55], v[196:199]
    v_cvt_pk_bf16_f32 v67, v186, v187
    buffer_store_dwordx4 v[64:67], v25, s[20:23], s69 offen offset:1024 sc1
    v_mfma_f32_16x16x32_bf16 v[200:203], v[72:75], a[40:43], v[200:203]
    ds_read_b64_tr_b16 v[92:93], v10 offset:11264
    v_mul_f32 v188, v188, v252
    v_mfma_f32_16x16x32_bf16 v[200:203], v[76:79], a[56:59], v[200:203]
    v_mul_f32 v189, v189, v253
    v_mul_f32 v190, v190, v254
    v_mfma_f32_16x16x32_bf16 v[204:207], v[72:75], a[44:47], v[204:207]
    ds_read_b64_tr_b16 v[94:95], v11 offset:11264
    v_mul_f32 v191, v191, v255
    v_mfma_f32_16x16x32_bf16 v[204:207], v[76:79], a[60:63], v[204:207]
    v_cvt_pk_bf16_f32 v70, v188, v189
    s_waitcnt lgkmcnt(4)
    v_mfma_f32_16x16x32_bf16 v[128:131], v[80:83], a[64:67], v[128:131]
    ds_read_b64_tr_b16 v[72:73], v10 offset:12288
    v_cvt_pk_bf16_f32 v71, v190, v191
    v_mfma_f32_16x16x32_bf16 v[128:131], v[84:87], a[80:83], v[128:131]
    buffer_store_dwordx4 v[68:71], v26, s[20:23], s69 offen offset:1024 sc1
    s_waitcnt vmcnt(8)
    v_mfma_f32_16x16x32_bf16 v[132:135], v[80:83], a[68:71], v[132:135]
    ds_read_b64_tr_b16 v[74:75], v11 offset:12288
    v_cmp_ne_u32 vcc, s59, v36
    v_mfma_f32_16x16x32_bf16 v[132:135], v[84:87], a[84:87], v[132:135]
    s_cbranch_vccnz SLOW_h0
RET_h0:
    s_add_u32 m0, s88, 40960
    v_mfma_f32_16x16x32_bf16 v[136:139], v[80:83], a[72:75], v[136:139]
    ds_read_b64_tr_b16 v[76:77], v10 offset:14336
    v_add_u32 v35, s91, v37
    v_mfma_f32_16x16x32_bf16 v[136:139], v[84:87], a[88:91], v[136:139]
    v_add_u32 v35, 256, v35
    v_cmp_gt_u32 vcc, 48, v1
    s_nop 1
    v_cndmask_b32 v35, v39, v35, vcc
    v_mfma_f32_16x16x32_bf16 v[140:143], v[80:83], a[76:79], v[140:143]
    ds_read_b64_tr_b16 v[78:79], v11 offset:14336
    buffer_load_dwordx4 v23, s[20:23], s70 offen offset:0 sc1 lds
    v_mfma_f32_16x16x32_bf16 v[140:143], v[84:87], a[92:95], v[140:143]
    s_waitcnt lgkmcnt(4)
    v_mfma_f32_16x16x32_bf16 v[192:195], v[88:91], a[64:67], v[192:195]
    ds_read_b64_tr_b16 v[80:81], v10 offset:13312
    v_mfma_f32_16x16x32_bf16 v[192:195], v[92:95], a[80:83], v[192:195]
    v_mfma_f32_16x16x32_bf16 v[196:199], v[88:91], a[68:71], v[196:199]
    ds_read_b64_tr_b16 v[82:83], v11 offset:13312
    buffer_load_dwordx4 v23, s[20:23], s70 offen offset:1024 sc1 lds
    v_mfma_f32_16x16x32_bf16 v[196:199], v[92:95], a[84:87], v[196:199]
    v_mfma_f32_16x16x32_bf16 v[200:203], v[88:91], a[72:75], v[200:203]
    ds_read_b64_tr_b16 v[84:85], v10 offset:15360
    v_mfma_f32_16x16x32_bf16 v[200:203], v[92:95], a[88:91], v[200:203]
    v_mfma_f32_16x16x32_bf16 v[204:207], v[88:91], a[76:79], v[204:207]
    ds_read_b64_tr_b16 v[86:87], v11 offset:15360
    buffer_load_dwordx4 v23, s[20:23], s70 offen offset:2048 sc1 lds
    v_mfma_f32_16x16x32_bf16 v[204:207], v[92:95], a[92:95], v[204:207]
    s_waitcnt lgkmcnt(4)
    v_mfma_f32_16x16x32_bf16 v[128:131], v[72:75], a[96:99], v[128:131]
    s_barrier
    v_mfma_f32_16x16x32_bf16 v[128:131], v[76:79], a[112:115], v[128:131]
    ds_read_b64_tr_b16 v[88:89], v10 offset:16384
    v_mfma_f32_16x16x32_bf16 v[132:135], v[72:75], a[100:103], v[132:135]
    ds_read_b64_tr_b16 v[90:91], v11 offset:16384
    buffer_load_dwordx4 v23, s[20:23], s70 offen offset:3072 sc1 lds
    v_mfma_f32_16x16x32_bf16 v[132:135], v[76:79], a[116:119], v[132:135]
    ds_read_b64_tr_b16 v[92:93], v10 offset:18432
    v_mfma_f32_16x16x32_bf16 v[136:139], v[72:75], a[104:107], v[136:139]
    ds_read_b64_tr_b16 v[94:95], v11 offset:18432
    v_mfma_f32_16x16x32_bf16 v[136:139], v[76:79], a[120:123], v[136:139]
    v_mfma_f32_16x16x32_bf16 v[140:143], v[72:75], a[108:111], v[140:143]
    s_add_u32 m0, s88, 45056
    v_mfma_f32_16x16x32_bf16 v[140:143], v[76:79], a[124:127], v[140:143]
    buffer_load_dwordx4 v34, s[20:23], s70 offen offset:0 sc1 lds
    s_waitcnt lgkmcnt(4)
    v_mfma_f32_16x16x32_bf16 v[192:195], v[80:83], a[96:99], v[192:195]
    ds_read_b64_tr_b16 v[72:73], v10 offset:17408
    v_mfma_f32_16x16x32_bf16 v[192:195], v[84:87], a[112:115], v[192:195]
    v_mfma_f32_16x16x32_bf16 v[196:199], v[80:83], a[100:103], v[196:199]
    ds_read_b64_tr_b16 v[74:75], v11 offset:17408
    v_mfma_f32_16x16x32_bf16 v[196:199], v[84:87], a[116:119], v[196:199]
    buffer_load_dwordx4 v34, s[20:23], s70 offen offset:1024 sc1 lds
    v_mfma_f32_16x16x32_bf16 v[200:203], v[80:83], a[104:107], v[200:203]
    ds_read_b64_tr_b16 v[76:77], v10 offset:19456
    v_mfma_f32_16x16x32_bf16 v[200:203], v[84:87], a[120:123], v[200:203]
    v_mfma_f32_16x16x32_bf16 v[204:207], v[80:83], a[108:111], v[204:207]
    ds_read_b64_tr_b16 v[78:79], v11 offset:19456
    v_mfma_f32_16x16x32_bf16 v[204:207], v[84:87], a[124:127], v[204:207]
    buffer_load_dwordx4 v34, s[20:23], s70 offen offset:2048 sc1 lds
    s_waitcnt lgkmcnt(4)
    v_mfma_f32_16x16x32_bf16 v[128:131], v[88:91], a[128:131], v[128:131]
    ds_read_b64_tr_b16 v[80:81], v10 offset:20480
    v_mfma_f32_16x16x32_bf16 v[128:131], v[92:95], a[144:147], v[128:131]
    v_mfma_f32_16x16x32_bf16 v[132:135], v[88:91], a[132:135], v[132:135]
    ds_read_b64_tr_b16 v[82:83], v11 offset:20480
    v_mfma_f32_16x16x32_bf16 v[132:135], v[92:95], a[148:151], v[132:135]
    buffer_load_dwordx4 a[0:3], v23, s[20:23], s79 offen offset:0 sc1
    v_mfma_f32_16x16x32_bf16 v[136:139], v[88:91], a[136:139], v[136:139]
    ds_read_b64_tr_b16 v[84:85], v10 offset:22528
    v_mfma_f32_16x16x32_bf16 v[136:139], v[92:95], a[152:155], v[136:139]
    v_mfma_f32_16x16x32_bf16 v[140:143], v[88:91], a[140:143], v[140:143]
    ds_read_b64_tr_b16 v[86:87], v11 offset:22528
    v_mfma_f32_16x16x32_bf16 v[140:143], v[92:95], a[156:159], v[140:143]
    buffer_load_dwordx4 a[4:7], v24, s[20:23], s79 offen offset:0 sc1
    s_waitcnt lgkmcnt(4)
    v_mfma_f32_16x16x32_bf16 v[192:195], v[72:75], a[128:131], v[192:195]
    ds_read_b64_tr_b16 v[88:89], v10 offset:21504
    v_mfma_f32_16x16x32_bf16 v[192:195], v[76:79], a[144:147], v[192:195]
    v_mfma_f32_16x16x32_bf16 v[196:199], v[72:75], a[132:135], v[196:199]
    ds_read_b64_tr_b16 v[90:91], v11 offset:21504
    v_mfma_f32_16x16x32_bf16 v[196:199], v[76:79], a[148:151], v[196:199]
    buffer_load_dwordx4 a[8:11], v23, s[20:23], s79 offen offset:1024 sc1
    v_mfma_f32_16x16x32_bf16 v[200:203], v[72:75], a[136:139], v[200:203]
    ds_read_b64_tr_b16 v[92:93], v10 offset:23552
    v_mfma_f32_16x16x32_bf16 v[200:203], v[76:79], a[152:155], v[200:203]
    v_mfma_f32_16x16x32_bf16 v[204:207], v[72:75], a[140:143], v[204:207]
    ds_read_b64_tr_b16 v[94:95], v11 offset:23552
    v_mfma_f32_16x16x32_bf16 v[204:207], v[76:79], a[156:159], v[204:207]
    buffer_load_dwordx4 a[12:15], v24, s[20:23], s79 offen offset:1024 sc1
    s_waitcnt lgkmcnt(4)
    v_mfma_f32_16x16x32_bf16 v[128:131], v[80:83], a[160:163], v[128:131]
    ds_read_b64_tr_b16 v[72:73], v10 offset:24576
    v_mfma_f32_16x16x32_bf16 v[128:131], v[84:87], a[176:179], v[128:131]
    v_mfma_f32_16x16x32_bf16 v[132:135], v[80:83], a[164:167], v[132:135]
    ds_read_b64_tr_b16 v[74:75], v11 offset:24576
    v_mfma_f32_16x16x32_bf16 v[132:135], v[84:87], a[180:183], v[132:135]
    buffer_load_dwordx4 a[16:19], v23, s[20:23], s79 offen offset:2048 sc1
    v_mfma_f32_16x16x32_bf16 v[136:139], v[80:83], a[168:171], v[136:139]
    ds_read_b64_tr_b16 v[76:77], v10 offset:26624
    v_mfma_f32_16x16x32_bf16 v[136:139], v[84:87], a[184:187], v[136:139]
    v_mfma_f32_16x16x32_bf16 v[140:143], v[80:83], a[172:175], v[140:143]
    ds_read_b64_tr_b16 v[78:79], v11 offset:26624
    v_mfma_f32_16x16x32_bf16 v[140:143], v[84:87], a[188:191], v[140:143]
    buffer_load_dwordx4 a[20:23], v24, s[20:23], s79 offen offset:2048 sc1
    s_waitcnt lgkmcnt(4)
    v_mfma_f32_16x16x32_bf16 v[192:195], v[88:91], a[160:163], v[192:195]
    ds_read_b64_tr_b16 v[80:81], v10 offset:25600
    v_mfma_f32_16x16x32_bf16 v[192:195], v[92:95], a[176:179], v[192:195]
    v_mfma_f32_16x16x32_bf16 v[196:199], v[88:91], a[164:167], v[196:199]
    ds_read_b64_tr_b16 v[82:83], v11 offset:25600
    v_mfma_f32_16x16x32_bf16 v[196:199], v[92:95], a[180:183], v[196:199]
    buffer_load_dwordx4 a[24:27], v23, s[20:23], s79 offen offset:3072 sc1
    v_mfma_f32_16x16x32_bf16 v[200:203], v[88:91], a[168:171], v[200:203]
    ds_read_b64_tr_b16 v[84:85], v10 offset:27648
    v_mfma_f32_16x16x32_bf16 v[200:203], v[92:95], a[184:187], v[200:203]
    v_mfma_f32_16x16x32_bf16 v[204:207], v[88:91], a[172:175], v[204:207]
    ds_read_b64_tr_b16 v[86:87], v11 offset:27648
    v_mfma_f32_16x16x32_bf16 v[204:207], v[92:95], a[188:191], v[204:207]
    buffer_load_dwordx4 a[28:31], v24, s[20:23], s79 offen offset:3072 sc1
    s_waitcnt lgkmcnt(4)
    v_mfma_f32_16x16x32_bf16 v[128:131], v[72:75], a[192:195], v[128:131]
    ds_read_b64_tr_b16 v[88:89], v10 offset:28672
    v_mfma_f32_16x16x32_bf16 v[128:131], v[76:79], a[208:211], v[128:131]
    v_mfma_f32_16x16x32_bf16 v[132:135], v[72:75], a[196:199], v[132:135]
    ds_read_b64_tr_b16 v[90:91], v11 offset:28672
    v_mfma_f32_16x16x32_bf16 v[132:135], v[76:79], a[212:215], v[132:135]
    buffer_load_dwordx4 a[32:35], v23, s[20:23], s80 offen offset:0 sc1
    s_waitcnt vmcnt(16)
    s_mov_b64 exec, 1
    buffer_store_dword v38, off, s[20:23], s90 offset:128 sc1
    s_mov_b64 exec, -1
    v_mfma_f32_16x16x32_bf16 v[136:139], v[72:75], a[200:203], v[136:139]
    ds_read_b64_tr_b16 v[92:93], v10 offset:30720
    v_mfma_f32_16x16x32_bf16 v[136:139], v[76:79], a[216:219], v[136:139]
    v_mfma_f32_16x16x32_bf16 v[140:143], v[72:75], a[204:207], v[140:143]
    ds_read_b64_tr_b16 v[94:95], v11 offset:30720
    v_mfma_f32_16x16x32_bf16 v[140:143], v[76:79], a[220:223], v[140:143]
    buffer_load_dwordx4 a[36:39], v24, s[20:23], s80 offen offset:0 sc1
    s_waitcnt lgkmcnt(4)
    v_mfma_f32_16x16x32_bf16 v[192:195], v[80:83], a[192:195], v[192:195]
    ds_read_b64_tr_b16 v[72:73], v10 offset:29696
    v_mfma_f32_16x16x32_bf16 v[192:195], v[84:87], a[208:211], v[192:195]
    ds_read_b128 v[160:163], v28 offset:448
    ds_read_b64_tr_b16 v[224:225], v27 offset:8
    v_mfma_f32_16x16x32_bf16 v[196:199], v[80:83], a[196:199], v[196:199]
    ds_read_b64_tr_b16 v[74:75], v11 offset:29696
    ds_read_b64_tr_b16 v[226:227], v27 offset:0
    v_mfma_f32_16x16x32_bf16 v[196:199], v[84:87], a[212:215], v[196:199]
    buffer_load_dwordx4 a[40:43], v23, s[20:23], s80 offen offset:1024 sc1
    ds_read_b128 v[164:167], v28 offset:960
    v_mfma_f32_16x16x32_bf16 v[200:203], v[80:83], a[200:203], v[200:203]
    ds_read_b64_tr_b16 v[76:77], v10 offset:31744
    ds_read_b64_tr_b16 v[228:229], v27 offset:520
    v_mfma_f32_16x16x32_bf16 v[200:203], v[84:87], a[216:219], v[200:203]
    ds_read_b64_tr_b16 v[230:231], v27 offset:512
    ds_read_b128 v[168:171], v28 offset:1472
    v_mfma_f32_16x16x32_bf16 v[204:207], v[80:83], a[204:207], v[204:207]
    ds_read_b64_tr_b16 v[78:79], v11 offset:31744
    ds_read_b64_tr_b16 v[232:233], v27 offset:1032
PG8:
    s_cbranch_execz PG9
    v_mfma_f32_16x16x32_bf16 v[204:207], v[84:87], a[220:223], v[204:207]
    buffer_load_dwordx4 a[44:47], v24, s[20:23], s80 offen offset:1024 sc1
    s_waitcnt lgkmcnt(12)
    v_mfma_f32_16x16x32_bf16 v[128:131], v[88:91], a[224:227], v[128:131]
    s_barrier
    v_mfma_f32_16x16x32_bf16 v[128:131], v[92:95], a[240:243], v[128:131]
    ds_read_b64_tr_b16 v[80:81], v10 offset:32768
    ds_read_b64_tr_b16 v[234:235], v27 offset:1024
    v_mfma_f32_16x16x32_bf16 v[132:135], v[88:91], a[228:231], v[132:135]
    ds_read_b64_tr_b16 v[82:83], v11 offset:32768
    ds_read_b128 v[172:175], v28 offset:1984
    v_mfma_f32_16x16x32_bf16 v[132:135], v[92:95], a[244:247], v[132:135]
    ds_read_b64_tr_b16 v[84:85], v10 offset:34816
    buffer_load_dwordx4 a[48:51], v23, s[20:23], s80 offen offset:2048 sc1
    v_mfma_f32_16x16x32_bf16 v[136:139], v[88:91], a[232:235], v[136:139]
    ds_read_b64_tr_b16 v[86:87], v11 offset:34816
    ds_read_b64_tr_b16 v[236:237], v27 offset:1544
    v_mfma_f32_16x16x32_bf16 v[136:139], v[92:95], a[248:251], v[136:139]
    ds_read_b64_tr_b16 v[238:239], v27 offset:1536
    ds_read_b128 v[176:179], v28 offset:2496
    v_mfma_f32_16x16x32_bf16 v[140:143], v[88:91], a[236:239], v[140:143]
    ds_read_b64_tr_b16 v[240:241], v27 offset:2056
    ds_read_b64_tr_b16 v[242:243], v27 offset:2048
    v_mfma_f32_16x16x32_bf16 v[140:143], v[92:95], a[252:255], v[140:143]
    buffer_load_dwordx4 a[52:55], v24, s[20:23], s80 offen offset:2048 sc1
    s_waitcnt lgkmcnt(12)
    v_mfma_f32_16x16x32_bf16 v[192:195], v[72:75], a[224:227], v[192:195]
    ds_read_b64_tr_b16 v[88:89], v10 offset:33792
    ds_read_b128 v[180:183], v28 offset:3008
    v_mfma_f32_16x16x32_bf16 v[192:195], v[76:79], a[240:243], v[192:195]
    ds_read_b64_tr_b16 v[244:245], v27 offset:2568
    ds_read_b64_tr_b16 v[246:247], v27 offset:2560
    v_mfma_f32_16x16x32_bf16 v[196:199], v[72:75], a[228:231], v[196:199]
    ds_read_b64_tr_b16 v[90:91], v11 offset:33792
    ds_read_b128 v[184:187], v28 offset:3520
    v_mfma_f32_16x16x32_bf16 v[196:199], v[76:79], a[244:247], v[196:199]
    buffer_load_dwordx4 a[56:59], v23, s[20:23], s80 offen offset:3072 sc1
    ds_read_b64_tr_b16 v[248:249], v27 offset:3080
    v_mfma_f32_16x16x32_bf16 v[200:203], v[72:75], a[232:235], v[200:203]
    ds_read_b64_tr_b16 v[92:93], v10 offset:35840
    ds_read_b64_tr_b16 v[250:251], v27 offset:3072
    v_mfma_f32_16x16x32_bf16 v[200:203], v[76:79], a[248:251], v[200:203]
    ds_read_b128 v[188:191], v28 offset:4032
    ds_read_b64_tr_b16 v[252:253], v27 offset:3592
    v_mfma_f32_16x16x32_bf16 v[204:207], v[72:75], a[236:239], v[204:207]
    ds_read_b64_tr_b16 v[94:95], v11 offset:35840
    ds_read_b64_tr_b16 v[254:255], v27 offset:3584
    v_mfma_f32_16x16x32_bf16 v[204:207], v[76:79], a[252:255], v[204:207]
    buffer_load_dwordx4 a[60:63], v24, s[20:23], s80 offen offset:3072 sc1
    s_waitcnt lgkmcnt(15)
    v_mfma_f32_16x16x32_bf16 v[128:131], v[80:83], v[96:99], v[128:131]
    v_mfma_f32_16x16x32_bf16 v[128:131], v[84:87], v[112:115], v[128:131]
    v_mfma_f32_16x16x32_bf16 v[132:135], v[80:83], v[100:103], v[132:135]
    v_mfma_f32_16x16x32_bf16 v[132:135], v[84:87], v[116:119], v[132:135]
    v_mfma_f32_16x16x32_bf16 v[136:139], v[80:83], v[104:107], v[136:139]
    v_mfma_f32_16x16x32_bf16 v[136:139], v[84:87], v[120:123], v[136:139]
    v_mfma_f32_16x16x32_bf16 v[140:143], v[80:83], v[108:111], v[140:143]
    v_mfma_f32_16x16x32_bf16 v[140:143], v[84:87], v[124:127], v[140:143]
    s_waitcnt lgkmcnt(1)
    v_mfma_f32_16x16x32_bf16 v[192:195], v[88:91], v[96:99], v[192:195]
    v_mfma_f32_16x16x32_bf16 v[192:195], v[92:95], v[112:115], v[192:195]
    v_mfma_f32_16x16x32_bf16 v[196:199], v[88:91], v[100:103], v[196:199]
    v_mfma_f32_16x16x32_bf16 v[196:199], v[92:95], v[116:119], v[196:199]
    v_mfma_f32_16x16x32_bf16 v[200:203], v[88:91], v[104:107], v[200:203]
    v_mfma_f32_16x16x32_bf16 v[200:203], v[92:95], v[120:123], v[200:203]
    v_mfma_f32_16x16x32_bf16 v[204:207], v[88:91], v[108:111], v[204:207]
    v_mfma_f32_16x16x32_bf16 v[204:207], v[92:95], v[124:127], v[204:207]
    s_barrier
    s_lshr_b32 s60, s37, 1
    s_lshl_b32 s60, s60, 10
    s_add_u32 s60, s60, s58
    s_and_b32 s61, s37, 1
    s_mul_i32 s61, s61, 147456
    s_add_u32 s60, s60, s61
    s_add_u32 s69, s60, 32768
    s_nop 1
    v_mul_f32 v128, v128, v192
    v_mul_f32 v129, v129, v193
    v_mul_f32 v130, v130, v194
    v_mul_f32 v131, v131, v195
    v_cvt_pk_bf16_f32 v40, v128, v129
    v_cvt_pk_bf16_f32 v41, v130, v131
    v_mul_f32 v132, v132, v196
    v_mul_f32 v133, v133, v197
    v_mul_f32 v134, v134, v198
    v_mul_f32 v135, v135, v199
    v_cvt_pk_bf16_f32 v42, v132, v133
    v_cvt_pk_bf16_f32 v43, v134, v135
    buffer_store_dwordx4 v[40:43], v23, s[20:23], s69 offen sc1
    v_mul_f32 v136, v136, v200
    v_mul_f32 v137, v137, v201
    v_mul_f32 v138, v138, v202
    v_mul_f32 v139, v139, v203
    v_cvt_pk_bf16_f32 v44, v136, v137
    v_cvt_pk_bf16_f32 v45, v138, v139
    v_mul_f32 v140, v140, v204
    v_mul_f32 v141, v141, v205
    v_mul_f32 v142, v142, v206
    v_mul_f32 v143, v143, v207
    v_cvt_pk_bf16_f32 v46, v140, v141
    v_cvt_pk_bf16_f32 v47, v142, v143
    buffer_store_dwordx4 v[44:47], v25, s[20:23], s69 offen sc1
    s_cmp_eq_u32 s0, 0
    s_cbranch_scc1 NOCONV
    s_waitcnt lgkmcnt(0)
    v_mfma_f32_16x16x32_bf16 v[128:131], v[224:227], v[160:163], 0
    v_lshrrev_b32 v30, 2, v1
    v_and_b32 v31, 3, v1
    v_mfma_f32_16x16x32_bf16 v[132:135], v[224:227], v[164:167], 0
    ds_read_b128 v[64:67], v28 offset:384
    v_lshlrev_b32 v31, 3, v31
    v_mfma_f32_16x16x32_bf16 v[132:135], v[228:231], v[160:163], v[132:135]
    ds_read_b64_tr_b16 v[192:193], v27 offset:72
    v_lshl_add_u32 v30, v30, 6, v31
    v_mfma_f32_16x16x32_bf16 v[136:139], v[224:227], v[168:171], 0
    ds_read_b64_tr_b16 v[194:195], v27 offset:64
    v_bfe_u32 v31, v1, 4, 1
    v_mfma_f32_16x16x32_bf16 v[136:139], v[228:231], v[164:167], v[136:139]
    ds_read_b128 v[68:71], v28 offset:896
    v_lshl_add_u32 v30, v31, 5, v30
    v_mfma_f32_16x16x32_bf16 v[136:139], v[232:235], v[160:163], v[136:139]
    ds_read_b64_tr_b16 v[196:197], v27 offset:584
    v_xor_b32 v31, 32, v30
    v_mfma_f32_16x16x32_bf16 v[140:143], v[224:227], v[172:175], 0
    ds_read_b64_tr_b16 v[198:199], v27 offset:576
    v_lshlrev_b32 v32, 3, v1
    v_mfma_f32_16x16x32_bf16 v[140:143], v[228:231], v[168:171], v[140:143]
    ds_read_b128 v[72:75], v28 offset:1408
    v_add_u32 v2, 12288, v30
    v_mfma_f32_16x16x32_bf16 v[140:143], v[232:235], v[164:167], v[140:143]
    ds_read_b64_tr_b16 v[200:201], v27 offset:1096
    v_add_u32 v3, 12288, v31
    v_mfma_f32_16x16x32_bf16 v[140:143], v[236:239], v[160:163], v[140:143]
    ds_read_b64_tr_b16 v[202:203], v27 offset:1088
    v_add_u32 v8, 12288, v32
    v_mfma_f32_16x16x32_bf16 v[144:147], v[224:227], v[176:179], 0
    ds_read_b128 v[76:79], v28 offset:1920
    v_add_u32 v4, 69632, v30
    v_mfma_f32_16x16x32_bf16 v[144:147], v[228:231], v[172:175], v[144:147]
    ds_read_b64_tr_b16 v[204:205], v27 offset:1608
    v_add_u32 v5, 69632, v31
    v_mfma_f32_16x16x32_bf16 v[144:147], v[232:235], v[168:171], v[144:147]
    ds_read_b64_tr_b16 v[206:207], v27 offset:1600
    v_add_u32 v9, 69632, v32
    v_mfma_f32_16x16x32_bf16 v[144:147], v[236:239], v[164:167], v[144:147]
    ds_read_b128 v[80:83], v28 offset:2432
    v_add_u32 v6, 126976, v30
    v_mfma_f32_16x16x32_bf16 v[144:147], v[240:243], v[160:163], v[144:147]
    ds_read_b64_tr_b16 v[208:209], v27 offset:2120
    v_add_u32 v7, 126976, v31
    v_mfma_f32_16x16x32_bf16 v[148:151], v[224:227], v[180:183], 0
    ds_read_b64_tr_b16 v[210:211], v27 offset:2112
    v_add_u32 v16, 126976, v32
    v_mfma_f32_16x16x32_bf16 v[148:151], v[228:231], v[176:179], v[148:151]
    ds_read_b128 v[84:87], v28 offset:2944
    v_mfma_f32_16x16x32_bf16 v[148:151], v[232:235], v[172:175], v[148:151]
    ds_read_b64_tr_b16 v[212:213], v27 offset:2632
    v_mfma_f32_16x16x32_bf16 v[148:151], v[236:239], v[168:171], v[148:151]
    ds_read_b64_tr_b16 v[214:215], v27 offset:2624
    v_mfma_f32_16x16x32_bf16 v[148:151], v[240:243], v[164:167], v[148:151]
    ds_read_b128 v[88:91], v28 offset:3456
    v_mfma_f32_16x16x32_bf16 v[148:151], v[244:247], v[160:163], v[148:151]
    ds_read_b64_tr_b16 v[216:217], v27 offset:3144
    v_mfma_f32_16x16x32_bf16 v[152:155], v[224:227], v[184:187], 0
    ds_read_b64_tr_b16 v[218:219], v27 offset:3136
    v_mfma_f32_16x16x32_bf16 v[152:155], v[228:231], v[180:183], v[152:155]
    ds_read_b128 v[92:95], v28 offset:3968
    v_mfma_f32_16x16x32_bf16 v[152:155], v[232:235], v[176:179], v[152:155]
    ds_read_b64_tr_b16 v[220:221], v27 offset:3656
    v_mfma_f32_16x16x32_bf16 v[152:155], v[236:239], v[172:175], v[152:155]
    ds_read_b64_tr_b16 v[222:223], v27 offset:3648
    v_mfma_f32_16x16x32_bf16 v[152:155], v[240:243], v[168:171], v[152:155]
    v_mfma_f32_16x16x32_bf16 v[152:155], v[244:247], v[164:167], v[152:155]
    v_mfma_f32_16x16x32_bf16 v[152:155], v[248:251], v[160:163], v[152:155]
    v_mfma_f32_16x16x32_bf16 v[156:159], v[224:227], v[188:191], 0
    v_mfma_f32_16x16x32_bf16 v[156:159], v[228:231], v[184:187], v[156:159]
    v_mfma_f32_16x16x32_bf16 v[156:159], v[232:235], v[180:183], v[156:159]
    v_mfma_f32_16x16x32_bf16 v[156:159], v[236:239], v[176:179], v[156:159]
    v_mfma_f32_16x16x32_bf16 v[156:159], v[240:243], v[172:175], v[156:159]
    v_mfma_f32_16x16x32_bf16 v[156:159], v[244:247], v[168:171], v[156:159]
    v_mfma_f32_16x16x32_bf16 v[156:159], v[248:251], v[164:167], v[156:159]
    v_mfma_f32_16x16x32_bf16 v[156:159], v[252:255], v[160:163], v[156:159]
    s_waitcnt lgkmcnt(0)
    v_mfma_f32_16x16x32_bf16 v[128:131], v[192:195], v[64:67], v[128:131]
    v_mfma_f32_16x16x32_bf16 v[132:135], v[192:195], v[68:71], v[132:135]
    ds_read_b128 v[160:163], v28 offset:320
    v_mfma_f32_16x16x32_bf16 v[132:135], v[196:199], v[64:67], v[132:135]
    ds_read_b64_tr_b16 v[224:225], v27 offset:136
    v_mfma_f32_16x16x32_bf16 v[136:139], v[192:195], v[72:75], v[136:139]
    ds_read_b64_tr_b16 v[226:227], v27 offset:128
    v_mfma_f32_16x16x32_bf16 v[136:139], v[196:199], v[68:71], v[136:139]
    ds_read_b128 v[164:167], v28 offset:832
    v_mfma_f32_16x16x32_bf16 v[136:139], v[200:203], v[64:67], v[136:139]
    ds_read_b64_tr_b16 v[228:229], v27 offset:648
    v_mfma_f32_16x16x32_bf16 v[140:143], v[192:195], v[76:79], v[140:143]
    ds_read_b64_tr_b16 v[230:231], v27 offset:640
    v_mfma_f32_16x16x32_bf16 v[140:143], v[196:199], v[72:75], v[140:143]
    ds_read_b128 v[168:171], v28 offset:1344
    v_mfma_f32_16x16x32_bf16 v[140:143], v[200:203], v[68:71], v[140:143]
    ds_read_b64_tr_b16 v[232:233], v27 offset:1160
    v_mfma_f32_16x16x32_bf16 v[140:143], v[204:207], v[64:67], v[140:143]
    ds_read_b64_tr_b16 v[234:235], v27 offset:1152
    v_mfma_f32_16x16x32_bf16 v[144:147], v[192:195], v[80:83], v[144:147]
    ds_read_b128 v[172:175], v28 offset:1856
    v_mfma_f32_16x16x32_bf16 v[144:147], v[196:199], v[76:79], v[144:147]
    ds_read_b64_tr_b16 v[236:237], v27 offset:1672
    v_mfma_f32_16x16x32_bf16 v[144:147], v[200:203], v[72:75], v[144:147]
    ds_read_b64_tr_b16 v[238:239], v27 offset:1664
    v_mfma_f32_16x16x32_bf16 v[144:147], v[204:207], v[68:71], v[144:147]
    ds_read_b128 v[176:179], v28 offset:2368
    v_mfma_f32_16x16x32_bf16 v[144:147], v[208:211], v[64:67], v[144:147]
    ds_read_b64_tr_b16 v[240:241], v27 offset:2184
    v_mfma_f32_16x16x32_bf16 v[148:151], v[192:195], v[84:87], v[148:151]
    ds_read_b64_tr_b16 v[242:243], v27 offset:2176
    v_mfma_f32_16x16x32_bf16 v[148:151], v[196:199], v[80:83], v[148:151]
    ds_read_b128 v[180:183], v28 offset:2880
    v_mfma_f32_16x16x32_bf16 v[148:151], v[200:203], v[76:79], v[148:151]
    ds_read_b64_tr_b16 v[244:245], v27 offset:2696
    v_mfma_f32_16x16x32_bf16 v[148:151], v[204:207], v[72:75], v[148:151]
    ds_read_b64_tr_b16 v[246:247], v27 offset:2688
    v_mfma_f32_16x16x32_bf16 v[148:151], v[208:211], v[68:71], v[148:151]
    ds_read_b128 v[184:187], v28 offset:3392
    v_mfma_f32_16x16x32_bf16 v[148:151], v[212:215], v[64:67], v[148:151]
    ds_read_b64_tr_b16 v[248:249], v27 offset:3208
    v_mfma_f32_16x16x32_bf16 v[152:155], v[192:195], v[88:91], v[152:155]
    ds_read_b64_tr_b16 v[250:251], v27 offset:3200
    v_mfma_f32_16x16x32_bf16 v[152:155], v[196:199], v[84:87], v[152:155]
    ds_read_b128 v[188:191], v28 offset:3904
    v_mfma_f32_16x16x32_bf16 v[152:155], v[200:203], v[80:83], v[152:155]
    ds_read_b64_tr_b16 v[252:253], v27 offset:3720
    v_mfma_f32_16x16x32_bf16 v[152:155], v[204:207], v[76:79], v[152:155]
    ds_read_b64_tr_b16 v[254:255], v27 offset:3712
    v_mfma_f32_16x16x32_bf16 v[152:155], v[208:211], v[72:75], v[152:155]
    v_mfma_f32_16x16x32_bf16 v[152:155], v[212:215], v[68:71], v[152:155]
    v_mfma_f32_16x16x32_bf16 v[152:155], v[216:219], v[64:67], v[152:155]
    v_mfma_f32_16x16x32_bf16 v[156:159], v[192:195], v[92:95], v[156:159]
    v_mfma_f32_16x16x32_bf16 v[156:159], v[196:199], v[88:91], v[156:159]
    v_mfma_f32_16x16x32_bf16 v[156:159], v[200:203], v[84:87], v[156:159]
    v_mfma_f32_16x16x32_bf16 v[156:159], v[204:207], v[80:83], v[156:159]
    v_mfma_f32_16x16x32_bf16 v[156:159], v[208:211], v[76:79], v[156:159]
    v_mfma_f32_16x16x32_bf16 v[156:159], v[212:215], v[72:75], v[156:159]
    v_mfma_f32_16x16x32_bf16 v[156:159], v[216:219], v[68:71], v[156:159]
    v_mfma_f32_16x16x32_bf16 v[156:159], v[220:223], v[64:67], v[156:159]
    s_waitcnt lgkmcnt(0)
    v_mfma_f32_16x16x32_bf16 v[128:131], v[224:227], v[160:163], v[128:131]
    v_mfma_f32_16x16x32_bf16 v[132:135], v[224:227], v[164:167], v[132:135]
    ds_read_b128 v[64:67], v28 offset:256
    v_mfma_f32_16x16x32_bf16 v[132:135], v[228:231], v[160:163], v[132:135]
    ds_read_b64_tr_b16 v[192:193], v27 offset:200
    v_mfma_f32_16x16x32_bf16 v[136:139], v[224:227], v[168:171], v[136:139]
    ds_read_b64_tr_b16 v[194:195], v27 offset:192
    v_mfma_f32_16x16x32_bf16 v[136:139], v[228:231], v[164:167], v[136:139]
    ds_read_b128 v[68:71], v28 offset:768
    v_mfma_f32_16x16x32_bf16 v[136:139], v[232:235], v[160:163], v[136:139]
    ds_read_b64_tr_b16 v[196:197], v27 offset:712
    v_mfma_f32_16x16x32_bf16 v[140:143], v[224:227], v[172:175], v[140:143]
    ds_read_b64_tr_b16 v[198:199], v27 offset:704
    v_mfma_f32_16x16x32_bf16 v[140:143], v[228:231], v[168:171], v[140:143]
    ds_read_b128 v[72:75], v28 offset:1280
    v_mfma_f32_16x16x32_bf16 v[140:143], v[232:235], v[164:167], v[140:143]
    ds_read_b64_tr_b16 v[200:201], v27 offset:1224
    buffer_load_dword v36, v37, s[20:23], s91 offen offset:128 sc1
    v_mfma_f32_16x16x32_bf16 v[140:143], v[236:239], v[160:163], v[140:143]
    ds_read_b64_tr_b16 v[202:203], v27 offset:1216
    v_mfma_f32_16x16x32_bf16 v[144:147], v[224:227], v[176:179], v[144:147]
    ds_read_b128 v[76:79], v28 offset:1792
    v_mfma_f32_16x16x32_bf16 v[144:147], v[228:231], v[172:175], v[144:147]
    ds_read_b64_tr_b16 v[204:205], v27 offset:1736
    v_mfma_f32_16x16x32_bf16 v[144:147], v[232:235], v[168:171], v[144:147]
    ds_read_b64_tr_b16 v[206:207], v27 offset:1728
    v_mfma_f32_16x16x32_bf16 v[144:147], v[236:239], v[164:167], v[144:147]
    ds_read_b128 v[80:83], v28 offset:2304
    v_mfma_f32_16x16x32_bf16 v[144:147], v[240:243], v[160:163], v[144:147]
    ds_read_b64_tr_b16 v[208:209], v27 offset:2248
    v_mfma_f32_16x16x32_bf16 v[148:151], v[224:227], v[180:183], v[148:151]
    ds_read_b64_tr_b16 v[210:211], v27 offset:2240
    v_mfma_f32_16x16x32_bf16 v[148:151], v[228:231], v[176:179], v[148:151]
    ds_read_b128 v[84:87], v28 offset:2816
    v_mfma_f32_16x16x32_bf16 v[148:151], v[232:235], v[172:175], v[148:151]
    ds_read_b64_tr_b16 v[212:213], v27 offset:2760
    v_mfma_f32_16x16x32_bf16 v[148:151], v[236:239], v[168:171], v[148:151]
    ds_read_b64_tr_b16 v[214:215], v27 offset:2752
    v_mfma_f32_16x16x32_bf16 v[148:151], v[240:243], v[164:167], v[148:151]
    ds_read_b128 v[88:91], v28 offset:3328
    v_mfma_f32_16x16x32_bf16 v[148:151], v[244:247], v[160:163], v[148:151]
    ds_read_b64_tr_b16 v[216:217], v27 offset:3272
    v_mfma_f32_16x16x32_bf16 v[152:155], v[224:227], v[184:187], v[152:155]
    ds_read_b64_tr_b16 v[218:219], v27 offset:3264
    v_mfma_f32_16x16x32_bf16 v[152:155], v[228:231], v[180:183], v[152:155]
    ds_read_b128 v[92:95], v28 offset:3840
    v_mfma_f32_16x16x32_bf16 v[152:155], v[232:235], v[176:179], v[152:155]
    ds_read_b64_tr_b16 v[220:221], v27 offset:3784
    v_mfma_f32_16x16x32_bf16 v[152:155], v[236:239], v[172:175], v[152:155]
    ds_read_b64_tr_b16 v[222:223], v27 offset:3776
    v_mfma_f32_16x16x32_bf16 v[152:155], v[240:243], v[168:171], v[152:155]
    v_mfma_f32_16x16x32_bf16 v[152:155], v[244:247], v[164:167], v[152:155]
    v_mfma_f32_16x16x32_bf16 v[152:155], v[248:251], v[160:163], v[152:155]
    v_mfma_f32_16x16x32_bf16 v[156:159], v[224:227], v[188:191], v[156:159]
    v_mfma_f32_16x16x32_bf16 v[156:159], v[228:231], v[184:187], v[156:159]
    v_mfma_f32_16x16x32_bf16 v[156:159], v[232:235], v[180:183], v[156:159]
    v_mfma_f32_16x16x32_bf16 v[156:159], v[236:239], v[176:179], v[156:159]
    v_mfma_f32_16x16x32_bf16 v[156:159], v[240:243], v[172:175], v[156:159]
    v_mfma_f32_16x16x32_bf16 v[156:159], v[244:247], v[168:171], v[156:159]
    v_mfma_f32_16x16x32_bf16 v[156:159], v[248:251], v[164:167], v[156:159]
    v_mfma_f32_16x16x32_bf16 v[156:159], v[252:255], v[160:163], v[156:159]
    s_waitcnt lgkmcnt(0)
    v_mfma_f32_16x16x32_bf16 v[128:131], v[192:195], v[64:67], v[128:131]
    v_mfma_f32_16x16x32_bf16 v[132:135], v[192:195], v[68:71], v[132:135]
    ds_read_b128 v[160:163], v28 offset:192
    v_mfma_f32_16x16x32_bf16 v[132:135], v[196:199], v[64:67], v[132:135]
    ds_read_b64_tr_b16 v[224:225], v27 offset:264
    s_waitcnt vmcnt(1)
    s_mov_b64 exec, 1
    buffer_store_dword v38, off, s[20:23], s90 offset:256 sc1
    s_mov_b64 exec, -1
    v_mfma_f32_16x16x32_bf16 v[136:139], v[192:195], v[72:75], v[136:139]
    ds_read_b64_tr_b16 v[226:227], v27 offset:256
    v_mfma_f32_16x16x32_bf16 v[136:139], v[196:199], v[68:71], v[136:139]
    ds_read_b128 v[164:167], v28 offset:704
    v_mfma_f32_16x16x32_bf16 v[136:139], v[200:203], v[64:67], v[136:139]
    ds_read_b64_tr_b16 v[228:229], v27 offset:776
    v_mfma_f32_16x16x32_bf16 v[140:143], v[192:195], v[76:79], v[140:143]
    ds_read_b64_tr_b16 v[230:231], v27 offset:768
    v_mfma_f32_16x16x32_bf16 v[140:143], v[196:199], v[72:75], v[140:143]
    ds_read_b128 v[168:171], v28 offset:1216
    v_mfma_f32_16x16x32_bf16 v[140:143], v[200:203], v[68:71], v[140:143]
    ds_read_b64_tr_b16 v[232:233], v27 offset:1288
    v_mfma_f32_16x16x32_bf16 v[140:143], v[204:207], v[64:67], v[140:143]
    ds_read_b64_tr_b16 v[234:235], v27 offset:1280
    v_mfma_f32_16x16x32_bf16 v[144:147], v[192:195], v[80:83], v[144:147]
    ds_read_b128 v[172:175], v28 offset:1728
    v_mfma_f32_16x16x32_bf16 v[144:147], v[196:199], v[76:79], v[144:147]
    ds_read_b64_tr_b16 v[236:237], v27 offset:1800
    v_mfma_f32_16x16x32_bf16 v[144:147], v[200:203], v[72:75], v[144:147]
    ds_read_b64_tr_b16 v[238:239], v27 offset:1792
    buffer_load_dwordx4 a[64:67], v23, s[20:23], s81 offen offset:0 sc1
    v_mfma_f32_16x16x32_bf16 v[144:147], v[204:207], v[68:71], v[144:147]
    ds_read_b128 v[176:179], v28 offset:2240
    v_mfma_f32_16x16x32_bf16 v[144:147], v[208:211], v[64:67], v[144:147]
    ds_read_b64_tr_b16 v[240:241], v27 offset:2312
    v_mfma_f32_16x16x32_bf16 v[148:151], v[192:195], v[84:87], v[148:151]
    ds_read_b64_tr_b16 v[242:243], v27 offset:2304
    v_mfma_f32_16x16x32_bf16 v[148:151], v[196:199], v[80:83], v[148:151]
    ds_read_b128 v[180:183], v28 offset:2752
    buffer_load_dwordx4 a[68:71], v24, s[20:23], s81 offen offset:0 sc1
    v_mfma_f32_16x16x32_bf16 v[148:151], v[200:203], v[76:79], v[148:151]
    ds_read_b64_tr_b16 v[244:245], v27 offset:2824
    v_mfma_f32_16x16x32_bf16 v[148:151], v[204:207], v[72:75], v[148:151]
    ds_read_b64_tr_b16 v[246:247], v27 offset:2816
    v_mfma_f32_16x16x32_bf16 v[148:151], v[208:211], v[68:71], v[148:151]
    ds_read_b128 v[184:187], v28 offset:3264
    v_mfma_f32_16x16x32_bf16 v[148:151], v[212:215], v[64:67], v[148:151]
    ds_read_b64_tr_b16 v[248:249], v27 offset:3336
    buffer_load_dwordx4 a[72:75], v23, s[20:23], s81 offen offset:1024 sc1
    v_mfma_f32_16x16x32_bf16 v[152:155], v[192:195], v[88:91], v[152:155]
    ds_read_b64_tr_b16 v[250:251], v27 offset:3328
    v_mfma_f32_16x16x32_bf16 v[152:155], v[196:199], v[84:87], v[152:155]
    ds_read_b128 v[188:191], v28 offset:3776
    v_mfma_f32_16x16x32_bf16 v[152:155], v[200:203], v[80:83], v[152:155]
    ds_read_b64_tr_b16 v[252:253], v27 offset:3848
    v_mfma_f32_16x16x32_bf16 v[152:155], v[204:207], v[76:79], v[152:155]
    ds_read_b64_tr_b16 v[254:255], v27 offset:3840
    buffer_load_dwordx4 a[76:79], v24, s[20:23], s81 offen offset:1024 sc1
    v_mfma_f32_16x16x32_bf16 v[152:155], v[208:211], v[72:75], v[152:155]
    v_mfma_f32_16x16x32_bf16 v[152:155], v[212:215], v[68:71], v[152:155]
    v_mfma_f32_16x16x32_bf16 v[152:155], v[216:219], v[64:67], v[152:155]
    v_mfma_f32_16x16x32_bf16 v[156:159], v[192:195], v[92:95], v[156:159]
    buffer_load_dwordx4 a[80:83], v23, s[20:23], s81 offen offset:2048 sc1
    v_mfma_f32_16x16x32_bf16 v[156:159], v[196:199], v[88:91], v[156:159]
    v_mfma_f32_16x16x32_bf16 v[156:159], v[200:203], v[84:87], v[156:159]
    v_mfma_f32_16x16x32_bf16 v[156:159], v[204:207], v[80:83], v[156:159]
    v_mfma_f32_16x16x32_bf16 v[156:159], v[208:211], v[76:79], v[156:159]
    buffer_load_dwordx4 a[84:87], v24, s[20:23], s81 offen offset:2048 sc1
    v_mfma_f32_16x16x32_bf16 v[156:159], v[212:215], v[72:75], v[156:159]
    v_mfma_f32_16x16x32_bf16 v[156:159], v[216:219], v[68:71], v[156:159]
    v_mfma_f32_16x16x32_bf16 v[156:159], v[220:223], v[64:67], v[156:159]
    s_waitcnt lgkmcnt(0)
    v_mfma_f32_16x16x32_bf16 v[128:131], v[224:227], v[160:163], v[128:131]
    buffer_load_dwordx4 a[88:91], v23, s[20:23], s81 offen offset:3072 sc1
    v_mfma_f32_16x16x32_bf16 v[132:135], v[224:227], v[164:167], v[132:135]
    ds_read_b128 v[64:67], v28 offset:128
    v_mfma_f32_16x16x32_bf16 v[132:135], v[228:231], v[160:163], v[132:135]
    ds_read_b64_tr_b16 v[192:193], v27 offset:328
    v_mfma_f32_16x16x32_bf16 v[136:139], v[224:227], v[168:171], v[136:139]
    ds_read_b64_tr_b16 v[194:195], v27 offset:320
    v_mfma_f32_16x16x32_bf16 v[136:139], v[228:231], v[164:167], v[136:139]
    ds_read_b128 v[68:71], v28 offset:640
    buffer_load_dwordx4 a[92:95], v24, s[20:23], s81 offen offset:3072 sc1
    v_mfma_f32_16x16x32_bf16 v[136:139], v[232:235], v[160:163], v[136:139]
    ds_read_b64_tr_b16 v[196:197], v27 offset:840
    v_mfma_f32_16x16x32_bf16 v[140:143], v[224:227], v[172:175], v[140:143]
    ds_read_b64_tr_b16 v[198:199], v27 offset:832
    v_mfma_f32_16x16x32_bf16 v[140:143], v[228:231], v[168:171], v[140:143]
    ds_read_b128 v[72:75], v28 offset:1152
    v_mfma_f32_16x16x32_bf16 v[140:143], v[232:235], v[164:167], v[140:143]
    ds_read_b64_tr_b16 v[200:201], v27 offset:1352
    buffer_load_dwordx4 a[96:99], v23, s[20:23], s82 offen offset:0 sc1
    v_mfma_f32_16x16x32_bf16 v[140:143], v[236:239], v[160:163], v[140:143]
    ds_read_b64_tr_b16 v[202:203], v27 offset:1344
    v_mfma_f32_16x16x32_bf16 v[144:147], v[224:227], v[176:179], v[144:147]
    ds_read_b128 v[76:79], v28 offset:1664
    v_mfma_f32_16x16x32_bf16 v[144:147], v[228:231], v[172:175], v[144:147]
    ds_read_b64_tr_b16 v[204:205], v27 offset:1864
    v_mfma_f32_16x16x32_bf16 v[144:147], v[232:235], v[168:171], v[144:147]
    ds_read_b64_tr_b16 v[206:207], v27 offset:1856
    buffer_load_dwordx4 a[100:103], v24, s[20:23], s82 offen offset:0 sc1
    v_mfma_f32_16x16x32_bf16 v[144:147], v[236:239], v[164:167], v[144:147]
    ds_read_b128 v[80:83], v28 offset:2176
    v_mfma_f32_16x16x32_bf16 v[144:147], v[240:243], v[160:163], v[144:147]
    ds_read_b64_tr_b16 v[208:209], v27 offset:2376
    v_mfma_f32_16x16x32_bf16 v[148:151], v[224:227], v[180:183], v[148:151]
    ds_read_b64_tr_b16 v[210:211], v27 offset:2368
    v_mfma_f32_16x16x32_bf16 v[148:151], v[228:231], v[176:179], v[148:151]
    ds_read_b128 v[84:87], v28 offset:2688
    buffer_load_dwordx4 a[104:107], v23, s[20:23], s82 offen offset:1024 sc1
    v_mfma_f32_16x16x32_bf16 v[148:151], v[232:235], v[172:175], v[148:151]
    ds_read_b64_tr_b16 v[212:213], v27 offset:2888
    v_mfma_f32_16x16x32_bf16 v[148:151], v[236:239], v[168:171], v[148:151]
    ds_read_b64_tr_b16 v[214:215], v27 offset:2880
    v_mfma_f32_16x16x32_bf16 v[148:151], v[240:243], v[164:167], v[148:151]
    ds_read_b128 v[88:91], v28 offset:3200
    v_mfma_f32_16x16x32_bf16 v[148:151], v[244:247], v[160:163], v[148:151]
    ds_read_b64_tr_b16 v[216:217], v27 offset:3400
    buffer_load_dwordx4 a[108:111], v24, s[20:23], s82 offen offset:1024 sc1
    v_mfma_f32_16x16x32_bf16 v[152:155], v[224:227], v[184:187], v[152:155]
    ds_read_b64_tr_b16 v[218:219], v27 offset:3392
    v_mfma_f32_16x16x32_bf16 v[152:155], v[228:231], v[180:183], v[152:155]
    ds_read_b128 v[92:95], v28 offset:3712
    v_mfma_f32_16x16x32_bf16 v[152:155], v[232:235], v[176:179], v[152:155]
    ds_read_b64_tr_b16 v[220:221], v27 offset:3912
    v_mfma_f32_16x16x32_bf16 v[152:155], v[236:239], v[172:175], v[152:155]
    ds_read_b64_tr_b16 v[222:223], v27 offset:3904
    buffer_load_dwordx4 a[112:115], v23, s[20:23], s82 offen offset:2048 sc1
    v_mfma_f32_16x16x32_bf16 v[152:155], v[240:243], v[168:171], v[152:155]
    v_mfma_f32_16x16x32_bf16 v[152:155], v[244:247], v[164:167], v[152:155]
    v_mfma_f32_16x16x32_bf16 v[152:155], v[248:251], v[160:163], v[152:155]
    v_mfma_f32_16x16x32_bf16 v[156:159], v[224:227], v[188:191], v[156:159]
    buffer_load_dwordx4 a[116:119], v24, s[20:23], s82 offen offset:2048 sc1
    v_mfma_f32_16x16x32_bf16 v[156:159], v[228:231], v[184:187], v[156:159]
    v_mfma_f32_16x16x32_bf16 v[156:159], v[232:235], v[180:183], v[156:159]
    v_mfma_f32_16x16x32_bf16 v[156:159], v[236:239], v[176:179], v[156:159]
    v_mfma_f32_16x16x32_bf16 v[156:159], v[240:243], v[172:175], v[156:159]
    buffer_load_dwordx4 a[120:123], v23, s[20:23], s82 offen offset:3072 sc1
    v_mfma_f32_16x16x32_bf16 v[156:159], v[244:247], v[168:171], v[156:159]
    v_mfma_f32_16x16x32_bf16 v[156:159], v[248:251], v[164:167], v[156:159]
    v_mfma_f32_16x16x32_bf16 v[156:159], v[252:255], v[160:163], v[156:159]
    s_waitcnt lgkmcnt(0)
    v_mfma_f32_16x16x32_bf16 v[128:131], v[192:195], v[64:67], v[128:131]
    buffer_load_dwordx4 a[124:127], v24, s[20:23], s82 offen offset:3072 sc1
    v_mfma_f32_16x16x32_bf16 v[132:135], v[192:195], v[68:71], v[132:135]
    ds_read_b128 v[160:163], v28 offset:64
    v_mfma_f32_16x16x32_bf16 v[132:135], v[196:199], v[64:67], v[132:135]
    ds_read_b64_tr_b16 v[224:225], v27 offset:392
    v_mfma_f32_16x16x32_bf16 v[136:139], v[192:195], v[72:75], v[136:139]
    ds_read_b64_tr_b16 v[226:227], v27 offset:384
    v_mfma_f32_16x16x32_bf16 v[136:139], v[196:199], v[68:71], v[136:139]
    ds_read_b128 v[164:167], v28 offset:576
    s_waitcnt vmcnt(17)
    v_mfma_f32_16x16x32_bf16 v[136:139], v[200:203], v[64:67], v[136:139]
    ds_read_b64_tr_b16 v[228:229], v27 offset:904
    v_cmp_ne_u32 vcc, s59, v36
    v_mfma_f32_16x16x32_bf16 v[140:143], v[192:195], v[76:79], v[140:143]
    ds_read_b64_tr_b16 v[230:231], v27 offset:896
    s_cbranch_vccnz SLOW_h1a
RET_h1a:
    v_mfma_f32_16x16x32_bf16 v[140:143], v[196:199], v[72:75], v[140:143]
    ds_read_b128 v[168:171], v28 offset:1088
    buffer_load_dwordx4 a[128:131], v23, s[20:23], s83 offen offset:0 sc1
    v_mfma_f32_16x16x32_bf16 v[140:143], v[200:203], v[68:71], v[140:143]
    ds_read_b64_tr_b16 v[232:233], v27 offset:1416
    v_mfma_f32_16x16x32_bf16 v[140:143], v[204:207], v[64:67], v[140:143]
    ds_read_b64_tr_b16 v[234:235], v27 offset:1408
    v_mfma_f32_16x16x32_bf16 v[144:147], v[192:195], v[80:83], v[144:147]
    ds_read_b128 v[172:175], v28 offset:1600
    v_mfma_f32_16x16x32_bf16 v[144:147], v[196:199], v[76:79], v[144:147]
    ds_read_b64_tr_b16 v[236:237], v27 offset:1928
    buffer_load_dwordx4 a[132:135], v24, s[20:23], s83 offen offset:0 sc1
    v_mfma_f32_16x16x32_bf16 v[144:147], v[200:203], v[72:75], v[144:147]
    ds_read_b64_tr_b16 v[238:239], v27 offset:1920
    v_mfma_f32_16x16x32_bf16 v[144:147], v[204:207], v[68:71], v[144:147]
    ds_read_b128 v[176:179], v28 offset:2112
    v_mfma_f32_16x16x32_bf16 v[144:147], v[208:211], v[64:67], v[144:147]
    ds_read_b64_tr_b16 v[240:241], v27 offset:2440
    v_mfma_f32_16x16x32_bf16 v[148:151], v[192:195], v[84:87], v[148:151]
    ds_read_b64_tr_b16 v[242:243], v27 offset:2432
    buffer_load_dwordx4 a[136:139], v23, s[20:23], s83 offen offset:1024 sc1
    v_mfma_f32_16x16x32_bf16 v[148:151], v[196:199], v[80:83], v[148:151]
    ds_read_b128 v[180:183], v28 offset:2624
    v_mfma_f32_16x16x32_bf16 v[148:151], v[200:203], v[76:79], v[148:151]
    ds_read_b64_tr_b16 v[244:245], v27 offset:2952
    v_mfma_f32_16x16x32_bf16 v[148:151], v[204:207], v[72:75], v[148:151]
    ds_read_b64_tr_b16 v[246:247], v27 offset:2944
    v_mfma_f32_16x16x32_bf16 v[148:151], v[208:211], v[68:71], v[148:151]
    ds_read_b128 v[184:187], v28 offset:3136
    buffer_load_dwordx4 a[140:143], v24, s[20:23], s83 offen offset:1024 sc1
    v_mfma_f32_16x16x32_bf16 v[148:151], v[212:215], v[64:67], v[148:151]
    ds_read_b64_tr_b16 v[248:249], v27 offset:3464
    v_mfma_f32_16x16x32_bf16 v[152:155], v[192:195], v[88:91], v[152:155]
    ds_read_b64_tr_b16 v[250:251], v27 offset:3456
    v_mfma_f32_16x16x32_bf16 v[152:155], v[196:199], v[84:87], v[152:155]
    ds_read_b128 v[188:191], v28 offset:3648
    v_mfma_f32_16x16x32_bf16 v[152:155], v[200:203], v[80:83], v[152:155]
    ds_read_b64_tr_b16 v[252:253], v27 offset:3976
    buffer_load_dwordx4 a[144:147], v23, s[20:23], s83 offen offset:2048 sc1
    v_mfma_f32_16x16x32_bf16 v[152:155], v[204:207], v[76:79], v[152:155]
    ds_read_b64_tr_b16 v[254:255], v27 offset:3968
    v_mfma_f32_16x16x32_bf16 v[152:155], v[208:211], v[72:75], v[152:155]
    v_mfma_f32_16x16x32_bf16 v[152:155], v[212:215], v[68:71], v[152:155]
    v_mfma_f32_16x16x32_bf16 v[152:155], v[216:219], v[64:67], v[152:155]
    buffer_load_dwordx4 a[148:151], v24, s[20:23], s83 offen offset:2048 sc1
    v_mfma_f32_16x16x32_bf16 v[156:159], v[192:195], v[92:95], v[156:159]
    v_mfma_f32_16x16x32_bf16 v[156:159], v[196:199], v[88:91], v[156:159]
    v_mfma_f32_16x16x32_bf16 v[156:159], v[200:203], v[84:87], v[156:159]
    v_mfma_f32_16x16x32_bf16 v[156:159], v[204:207], v[80:83], v[156:159]
    buffer_load_dwordx4 a[152:155], v23, s[20:23], s83 offen offset:3072 sc1
    v_mfma_f32_16x16x32_bf16 v[156:159], v[208:211], v[76:79], v[156:159]
    v_mfma_f32_16x16x32_bf16 v[156:159], v[212:215], v[72:75], v[156:159]
    v_mfma_f32_16x16x32_bf16 v[156:159], v[216:219], v[68:71], v[156:159]
    v_mfma_f32_16x16x32_bf16 v[156:159], v[220:223], v[64:67], v[156:159]
    buffer_load_dwordx4 a[156:159], v24, s[20:23], s83 offen offset:3072 sc1
    s_waitcnt lgkmcnt(0)
    v_mfma_f32_16x16x32_bf16 v[128:131], v[224:227], v[160:163], v[128:131]
    v_mfma_f32_16x16x32_bf16 v[132:135], v[224:227], v[164:167], v[132:135]
    ds_read_b128 v[64:67], v28 offset:0
    v_mfma_f32_16x16x32_bf16 v[132:135], v[228:231], v[160:163], v[132:135]
    ds_read_b64_tr_b16 v[192:193], v27 offset:456
    v_mfma_f32_16x16x32_bf16 v[136:139], v[224:227], v[168:171], v[136:139]
    ds_read_b64_tr_b16 v[194:195], v27 offset:448
    buffer_load_dwordx4 a[160:163], v23, s[20:23], s84 offen offset:0 sc1
    v_mfma_f32_16x16x32_bf16 v[136:139], v[228:231], v[164:167], v[136:139]
    ds_read_b128 v[68:71], v28 offset:512
    v_mfma_f32_16x16x32_bf16 v[136:139], v[232:235], v[160:163], v[136:139]
    ds_read_b64_tr_b16 v[196:197], v27 offset:968
    v_mfma_f32_16x16x32_bf16 v[140:143], v[224:227], v[172:175], v[140:143]
    ds_read_b64_tr_b16 v[198:199], v27 offset:960
    v_mfma_f32_16x16x32_bf16 v[140:143], v[228:231], v[168:171], v[140:143]
    ds_read_b128 v[72:75], v28 offset:1024
PG9:
    s_cbranch_execz RT_B
    buffer_load_dwordx4 a[164:167], v24, s[20:23], s84 offen offset:0 sc1
    v_mfma_f32_16x16x32_bf16 v[140:143], v[232:235], v[164:167], v[140:143]
    ds_read_b64_tr_b16 v[200:201], v27 offset:1480
    v_mfma_f32_16x16x32_bf16 v[140:143], v[236:239], v[160:163], v[140:143]
    ds_read_b64_tr_b16 v[202:203], v27 offset:1472
    v_mfma_f32_16x16x32_bf16 v[144:147], v[224:227], v[176:179], v[144:147]
    ds_read_b128 v[76:79], v28 offset:1536
    v_mfma_f32_16x16x32_bf16 v[144:147], v[228:231], v[172:175], v[144:147]
    ds_read_b64_tr_b16 v[204:205], v27 offset:1992
    buffer_load_dwordx4 a[168:171], v23, s[20:23], s84 offen offset:1024 sc1
    v_mfma_f32_16x16x32_bf16 v[144:147], v[232:235], v[168:171], v[144:147]
    ds_read_b64_tr_b16 v[206:207], v27 offset:1984
    v_mfma_f32_16x16x32_bf16 v[144:147], v[236:239], v[164:167], v[144:147]
    ds_read_b128 v[80:83], v28 offset:2048
    v_mfma_f32_16x16x32_bf16 v[144:147], v[240:243], v[160:163], v[144:147]
    ds_read_b64_tr_b16 v[208:209], v27 offset:2504
    v_mfma_f32_16x16x32_bf16 v[148:151], v[224:227], v[180:183], v[148:151]
    ds_read_b64_tr_b16 v[210:211], v27 offset:2496
    buffer_load_dwordx4 a[172:175], v24, s[20:23], s84 offen offset:1024 sc1
    v_mfma_f32_16x16x32_bf16 v[148:151], v[228:231], v[176:179], v[148:151]
    ds_read_b128 v[84:87], v28 offset:2560
    v_mfma_f32_16x16x32_bf16 v[148:151], v[232:235], v[172:175], v[148:151]
    ds_read_b64_tr_b16 v[212:213], v27 offset:3016
    v_mfma_f32_16x16x32_bf16 v[148:151], v[236:239], v[168:171], v[148:151]
    ds_read_b64_tr_b16 v[214:215], v27 offset:3008
    v_mfma_f32_16x16x32_bf16 v[148:151], v[240:243], v[164:167], v[148:151]
    ds_read_b128 v[88:91], v28 offset:3072
    buffer_load_dwordx4 a[176:179], v23, s[20:23], s84 offen offset:2048 sc1
    v_mfma_f32_16x16x32_bf16 v[148:151], v[244:247], v[160:163], v[148:151]
    ds_read_b64_tr_b16 v[216:217], v27 offset:3528
    v_mfma_f32_16x16x32_bf16 v[152:155], v[224:227], v[184:187], v[152:155]
    ds_read_b64_tr_b16 v[218:219], v27 offset:3520
    v_mfma_f32_16x16x32_bf16 v[152:155], v[228:231], v[180:183], v[152:155]
    ds_read_b128 v[92:95], v28 offset:3584
    v_mfma_f32_16x16x32_bf16 v[152:155], v[232:235], v[176:179], v[152:155]
    ds_read_b64_tr_b16 v[220:221], v27 offset:4040
    buffer_load_dwordx4 a[180:183], v24, s[20:23], s84 offen offset:2048 sc1
    v_mfma_f32_16x16x32_bf16 v[152:155], v[236:239], v[172:175], v[152:155]
    ds_read_b64_tr_b16 v[222:223], v27 offset:4032
    v_mfma_f32_16x16x32_bf16 v[152:155], v[240:243], v[168:171], v[152:155]
    v_mfma_f32_16x16x32_bf16 v[152:155], v[244:247], v[164:167], v[152:155]
    v_mfma_f32_16x16x32_bf16 v[152:155], v[248:251], v[160:163], v[152:155]
    buffer_load_dwordx4 a[184:187], v23, s[20:23], s84 offen offset:3072 sc1
    v_mfma_f32_16x16x32_bf16 v[156:159], v[224:227], v[188:191], v[156:159]
    v_mfma_f32_16x16x32_bf16 v[156:159], v[228:231], v[184:187], v[156:159]
    v_mfma_f32_16x16x32_bf16 v[156:159], v[232:235], v[180:183], v[156:159]
    v_mfma_f32_16x16x32_bf16 v[156:159], v[236:239], v[176:179], v[156:159]
    buffer_load_dwordx4 a[188:191], v24, s[20:23], s84 offen offset:3072 sc1
    v_mfma_f32_16x16x32_bf16 v[156:159], v[240:243], v[172:175], v[156:159]
    v_mfma_f32_16x16x32_bf16 v[156:159], v[244:247], v[168:171], v[156:159]
    v_mfma_f32_16x16x32_bf16 v[156:159], v[248:251], v[164:167], v[156:159]
    v_mfma_f32_16x16x32_bf16 v[156:159], v[252:255], v[160:163], v[156:159]
    buffer_load_dwordx4 a[192:195], v23, s[20:23], s85 offen offset:0 sc1
    s_waitcnt lgkmcnt(0)
    v_mfma_f32_16x16x32_bf16 v[128:131], v[192:195], v[64:67], v[128:131]
    v_mfma_f32_16x16x32_bf16 v[132:135], v[192:195], v[68:71], v[132:135]
    v_mfma_f32_16x16x32_bf16 v[132:135], v[196:199], v[64:67], v[132:135]
    v_mfma_f32_16x16x32_bf16 v[136:139], v[192:195], v[72:75], v[136:139]
    buffer_load_dwordx4 a[196:199], v24, s[20:23], s85 offen offset:0 sc1
    v_mfma_f32_16x16x32_bf16 v[136:139], v[196:199], v[68:71], v[136:139]
    v_mfma_f32_16x16x32_bf16 v[136:139], v[200:203], v[64:67], v[136:139]
    v_mfma_f32_16x16x32_bf16 v[140:143], v[192:195], v[76:79], v[140:143]
    s_nop 0
    v_cvt_pk_bf16_f32 v48, v128, v129
    v_cvt_pk_bf16_f32 v49, v130, v131
    v_mfma_f32_16x16x32_bf16 v[140:143], v[196:199], v[72:75], v[140:143]
    buffer_load_dwordx4 a[200:203], v23, s[20:23], s85 offen offset:1024 sc1
    v_cvt_pk_bf16_f32 v50, v132, v133
    v_mfma_f32_16x16x32_bf16 v[140:143], v[200:203], v[68:71], v[140:143]
    v_cvt_pk_bf16_f32 v51, v134, v135
    v_permlane16_swap_b32 v48, v50
    v_mfma_f32_16x16x32_bf16 v[140:143], v[204:207], v[64:67], v[140:143]
    v_permlane16_swap_b32 v49, v51
    buffer_store_dwordx4 v[48:51], v29, s[20:23], s5 offen offset:0 sc1
    v_mfma_f32_16x16x32_bf16 v[144:147], v[192:195], v[80:83], v[144:147]
    v_mfma_f32_16x16x32_bf16 v[144:147], v[196:199], v[76:79], v[144:147]
    buffer_load_dwordx4 a[204:207], v24, s[20:23], s85 offen offset:1024 sc1
    v_mfma_f32_16x16x32_bf16 v[144:147], v[200:203], v[72:75], v[144:147]
    v_mfma_f32_16x16x32_bf16 v[144:147], v[204:207], v[68:71], v[144:147]
    v_cvt_pk_bf16_f32 v52, v136, v137
    v_cvt_pk_bf16_f32 v53, v138, v139
    v_mfma_f32_16x16x32_bf16 v[144:147], v[208:211], v[64:67], v[144:147]
    v_cvt_pk_bf16_f32 v54, v140, v141
    v_cvt_pk_bf16_f32 v55, v142, v143
    v_mfma_f32_16x16x32_bf16 v[148:151], v[192:195], v[84:87], v[148:151]
    buffer_load_dwordx4 a[208:211], v23, s[20:23], s85 offen offset:2048 sc1
    v_permlane16_swap_b32 v52, v54
    v_mfma_f32_16x16x32_bf16 v[148:151], v[196:199], v[80:83], v[148:151]
    v_permlane16_swap_b32 v53, v55
    buffer_store_dwordx4 v[52:55], v29, s[20:23], s5 offen offset:1024 sc1
    v_mfma_f32_16x16x32_bf16 v[148:151], v[200:203], v[76:79], v[148:151]
    v_mfma_f32_16x16x32_bf16 v[148:151], v[204:207], v[72:75], v[148:151]
    v_mfma_f32_16x16x32_bf16 v[148:151], v[208:211], v[68:71], v[148:151]
    buffer_load_dwordx4 a[212:215], v24, s[20:23], s85 offen offset:2048 sc1
    v_mfma_f32_16x16x32_bf16 v[148:151], v[212:215], v[64:67], v[148:151]
    v_mfma_f32_16x16x32_bf16 v[152:155], v[192:195], v[88:91], v[152:155]
    v_mfma_f32_16x16x32_bf16 v[152:155], v[196:199], v[84:87], v[152:155]
    v_mfma_f32_16x16x32_bf16 v[152:155], v[200:203], v[80:83], v[152:155]
    buffer_load_dwordx4 a[216:219], v23, s[20:23], s85 offen offset:3072 sc1
    v_mfma_f32_16x16x32_bf16 v[152:155], v[204:207], v[76:79], v[152:155]
    v_cvt_pk_bf16_f32 v56, v144, v145
    v_cvt_pk_bf16_f32 v57, v146, v147
    v_mfma_f32_16x16x32_bf16 v[152:155], v[208:211], v[72:75], v[152:155]
    v_cvt_pk_bf16_f32 v58, v148, v149
    v_cvt_pk_bf16_f32 v59, v150, v151
    v_mfma_f32_16x16x32_bf16 v[152:155], v[212:215], v[68:71], v[152:155]
    v_permlane16_swap_b32 v56, v58
    v_permlane16_swap_b32 v57, v59
    v_mfma_f32_16x16x32_bf16 v[152:155], v[216:219], v[64:67], v[152:155]
    buffer_load_dwordx4 a[220:223], v24, s[20:23], s85 offen offset:3072 sc1
    buffer_store_dwordx4 v[56:59], v29, s[20:23], s5 offen offset:2048 sc1
    v_mfma_f32_16x16x32_bf16 v[156:159], v[192:195], v[92:95], v[156:159]
    v_mfma_f32_16x16x32_bf16 v[156:159], v[196:199], v[88:91], v[156:159]
    v_mfma_f32_16x16x32_bf16 v[156:159], v[200:203], v[84:87], v[156:159]
    v_mfma_f32_16x16x32_bf16 v[156:159], v[204:207], v[80:83], v[156:159]
    v_mfma_f32_16x16x32_bf16 v[156:159], v[208:211], v[76:79], v[156:159]
    v_mfma_f32_16x16x32_bf16 v[156:159], v[212:215], v[72:75], v[156:159]
    v_mfma_f32_16x16x32_bf16 v[156:159], v[216:219], v[68:71], v[156:159]
    v_mfma_f32_16x16x32_bf16 v[156:159], v[220:223], v[64:67], v[156:159]
    v_cvt_pk_bf16_f32 v60, v152, v153
    v_cvt_pk_bf16_f32 v61, v154, v155
    s_nop 5
    v_cvt_pk_bf16_f32 v62, v156, v157
    v_cvt_pk_bf16_f32 v63, v158, v159
    s_nop 0
    v_permlane16_swap_b32 v60, v62
    v_permlane16_swap_b32 v61, v63
    buffer_store_dwordx4 v[60:63], v29, s[20:23], s5 offen offset:3072 sc1
    s_waitcnt vmcnt(28)
    s_branch CONVDONE
NOCONV:
    v_lshrrev_b32 v30, 2, v1
    v_and_b32 v31, 3, v1
    v_lshlrev_b32 v31, 3, v31
    v_lshl_add_u32 v30, v30, 6, v31
    v_bfe_u32 v31, v1, 4, 1
    v_lshl_add_u32 v30, v31, 5, v30
    v_xor_b32 v31, 32, v30
    v_lshlrev_b32 v32, 3, v1
    v_add_u32 v2, 12288, v30
    v_add_u32 v3, 12288, v31
    v_add_u32 v8, 12288, v32
    v_add_u32 v4, 69632, v30
    v_add_u32 v5, 69632, v31
    v_add_u32 v9, 69632, v32
    v_add_u32 v6, 126976, v30
    v_add_u32 v7, 126976, v31
    v_add_u32 v16, 126976, v32
    buffer_load_dwordx4 a[64:67], v23, s[20:23], s81 offen offset:0 sc1
    buffer_load_dwordx4 a[68:71], v24, s[20:23], s81 offen offset:0 sc1
    buffer_load_dwordx4 a[72:75], v23, s[20:23], s81 offen offset:1024 sc1
    buffer_load_dwordx4 a[76:79], v24, s[20:23], s81 offen offset:1024 sc1
    buffer_load_dwordx4 a[80:83], v23, s[20:23], s81 offen offset:2048 sc1
    buffer_load_dwordx4 a[84:87], v24, s[20:23], s81 offen offset:2048 sc1
    buffer_load_dwordx4 a[88:91], v23, s[20:23], s81 offen offset:3072 sc1
    buffer_load_dwordx4 a[92:95], v24, s[20:23], s81 offen offset:3072 sc1
    buffer_load_dwordx4 a[96:99], v23, s[20:23], s82 offen offset:0 sc1
    buffer_load_dwordx4 a[100:103], v24, s[20:23], s82 offen offset:0 sc1
    buffer_load_dwordx4 a[104:107], v23, s[20:23], s82 offen offset:1024 sc1
    buffer_load_dwordx4 a[108:111], v24, s[20:23], s82 offen offset:1024 sc1
    buffer_load_dwordx4 a[112:115], v23, s[20:23], s82 offen offset:2048 sc1
    buffer_load_dwordx4 a[116:119], v24, s[20:23], s82 offen offset:2048 sc1
    buffer_load_dwordx4 a[120:123], v23, s[20:23], s82 offen offset:3072 sc1
    buffer_load_dwordx4 a[124:127], v24, s[20:23], s82 offen offset:3072 sc1
    buffer_load_dword v36, v37, s[20:23], s91 offen offset:128 sc1
    s_waitcnt vmcnt(17)
    s_mov_b64 exec, 1
    buffer_store_dword v38, off, s[20:23], s90 offset:256 sc1
    s_mov_b64 exec, -1
    s_cmp_eq_u32 s3, 2
    s_cbranch_scc1 NODMA
    s_sub_u32 s60, s71, 27648
    s_mov_b32 m0, 69632
    s_nop 0
    buffer_load_dwordx4 v23, s[20:23], s60 offen offset:0 sc1 lds
    buffer_load_dwordx4 v23, s[20:23], s60 offen offset:1024 sc1 lds
    buffer_load_dwordx4 v23, s[20:23], s60 offen offset:2048 sc1 lds
    buffer_load_dwordx4 v23, s[20:23], s60 offen offset:3072 sc1 lds
    s_mov_b32 m0, 73728
    s_nop 0
    buffer_load_dwordx4 v34, s[20:23], s60 offen offset:0 sc1 lds
    buffer_load_dwordx4 v34, s[20:23], s60 offen offset:1024 sc1 lds
    buffer_load_dwordx4 v34, s[20:23], s60 offen offset:2048 sc1 lds
    s_sub_u32 s60, s71, 18432
    s_mov_b32 m0, 76800
    s_nop 0
    buffer_load_dwordx4 v23, s[20:23], s60 offen offset:0 sc1 lds
    buffer_load_dwordx4 v23, s[20:23], s60 offen offset:1024 sc1 lds
    buffer_load_dwordx4 v23, s[20:23], s60 offen offset:2048 sc1 lds
    buffer_load_dwordx4 v23, s[20:23], s60 offen offset:3072 sc1 lds
    s_mov_b32 m0, 80896
    s_nop 0
    buffer_load_dwordx4 v34, s[20:23], s60 offen offset:0 sc1 lds
    buffer_load_dwordx4 v34, s[20:23], s60 offen offset:1024 sc1 lds
    buffer_load_dwordx4 v34, s[20:23], s60 offen offset:2048 sc1 lds
    s_sub_u32 s60, s71, 9216
    s_mov_b32 m0, 83968
    s_nop 0
    buffer_load_dwordx4 v23, s[20:23], s60 offen offset:0 sc1 lds
    buffer_load_dwordx4 v23, s[20:23], s60 offen offset:1024 sc1 lds
    buffer_load_dwordx4 v23, s[20:23], s60 offen offset:2048 sc1 lds
    buffer_load_dwordx4 v23, s[20:23], s60 offen offset:3072 sc1 lds
    s_mov_b32 m0, 88064
    s_nop 0
    buffer_load_dwordx4 v34, s[20:23], s60 offen offset:0 sc1 lds
    buffer_load_dwordx4 v34, s[20:23], s60 offen offset:1024 sc1 lds
    buffer_load_dwordx4 v34, s[20:23], s60 offen offset:2048 sc1 lds
    s_sub_u32 s60, s71, 0
    s_mov_b32 m0, 91136
    s_nop 0
    buffer_load_dwordx4 v23, s[20:23], s60 offen offset:0 sc1 lds
    buffer_load_dwordx4 v23, s[20:23], s60 offen offset:1024 sc1 lds
    buffer_load_dwordx4 v23, s[20:23], s60 offen offset:2048 sc1 lds
    buffer_load_dwordx4 v23, s[20:23], s60 offen offset:3072 sc1 lds
    s_mov_b32 m0, 95232
    s_nop 0
    buffer_load_dwordx4 v34, s[20:23], s60 offen offset:0 sc1 lds
    buffer_load_dwordx4 v34, s[20:23], s60 offen offset:1024 sc1 lds
    buffer_load_dwordx4 v34, s[20:23], s60 offen offset:2048 sc1 lds
    s_waitcnt vmcnt(29)
    s_sub_u32 s60, s72, 27648
    s_mov_b32 m0, 12288
    s_nop 0
    buffer_load_dwordx4 v23, s[20:23], s60 offen offset:0 sc1 lds
    buffer_load_dwordx4 v23, s[20:23], s60 offen offset:1024 sc1 lds
    buffer_load_dwordx4 v23, s[20:23], s60 offen offset:2048 sc1 lds
    buffer_load_dwordx4 v23, s[20:23], s60 offen offset:3072 sc1 lds
    s_mov_b32 m0, 16384
    s_nop 0
    buffer_load_dwordx4 v34, s[20:23], s60 offen offset:0 sc1 lds
    buffer_load_dwordx4 v34, s[20:23], s60 offen offset:1024 sc1 lds
    buffer_load_dwordx4 v34, s[20:23], s60 offen offset:2048 sc1 lds
    s_sub_u32 s60, s72, 18432
    s_mov_b32 m0, 19456
    s_nop 0
    buffer_load_dwordx4 v23, s[20:23], s60 offen offset:0 sc1 lds
    buffer_load_dwordx4 v23, s[20:23], s60 offen offset:1024 sc1 lds
    buffer_load_dwordx4 v23, s[20:23], s60 offen offset:2048 sc1 lds
    buffer_load_dwordx4 v23, s[20:23], s60 offen offset:3072 sc1 lds
    s_mov_b32 m0, 23552
    s_nop 0
    buffer_load_dwordx4 v34, s[20:23], s60 offen offset:0 sc1 lds
    buffer_load_dwordx4 v34, s[20:23], s60 offen offset:1024 sc1 lds
    buffer_load_dwordx4 v34, s[20:23], s60 offen offset:2048 sc1 lds
    s_sub_u32 s60, s72, 9216
    s_mov_b32 m0, 26624
    s_nop 0
    buffer_load_dwordx4 v23, s[20:23], s60 offen offset:0 sc1 lds
    buffer_load_dwordx4 v23, s[20:23], s60 offen offset:1024 sc1 lds
    buffer_load_dwordx4 v23, s[20:23], s60 offen offset:2048 sc1 lds
    buffer_load_dwordx4 v23, s[20:23], s60 offen offset:3072 sc1 lds
    s_mov_b32 m0, 30720
    s_nop 0
    buffer_load_dwordx4 v34, s[20:23], s60 offen offset:0 sc1 lds
    buffer_load_dwordx4 v34, s[20:23], s60 offen offset:1024 sc1 lds
    buffer_load_dwordx4 v34, s[20:23], s60 offen offset:2048 sc1 lds
    s_sub_u32 s60, s72, 0
    s_mov_b32 m0, 33792
    s_nop 0
    buffer_load_dwordx4 v23, s[20:23], s60 offen offset:0 sc1 lds
    buffer_load_dwordx4 v23, s[20:23], s60 offen offset:1024 sc1 lds
    buffer_load_dwordx4 v23, s[20:23], s60 offen offset:2048 sc1 lds
    buffer_load_dwordx4 v23, s[20:23], s60 offen offset:3072 sc1 lds
    s_mov_b32 m0, 37888
    s_nop 0
    buffer_load_dwordx4 v34, s[20:23], s60 offen offset:0 sc1 lds
    buffer_load_dwordx4 v34, s[20:23], s60 offen offset:1024 sc1 lds
    buffer_load_dwordx4 v34, s[20:23], s60 offen offset:2048 sc1 lds
    s_waitcnt vmcnt(28)
NODMA:
    s_waitcnt vmcnt(1)
    v_cmp_ne_u32 vcc, s59, v36
    s_cbranch_vccnz SLOW_h1b
RET_h1b:
    buffer_load_dwordx4 a[128:131], v23, s[20:23], s83 offen offset:0 sc1
    buffer_load_dwordx4 a[132:135], v24, s[20:23], s83 offen offset:0 sc1
    buffer_load_dwordx4 a[136:139], v23, s[20:23], s83 offen offset:1024 sc1
    buffer_load_dwordx4 a[140:143], v24, s[20:23], s83 offen offset:1024 sc1
    buffer_load_dwordx4 a[144:147], v23, s[20:23], s83 offen offset:2048 sc1
    buffer_load_dwordx4 a[148:151], v24, s[20:23], s83 offen offset:2048 sc1
    buffer_load_dwordx4 a[152:155], v23, s[20:23], s83 offen offset:3072 sc1
    buffer_load_dwordx4 a[156:159], v24, s[20:23], s83 offen offset:3072 sc1
    buffer_load_dwordx4 a[160:163], v23, s[20:23], s84 offen offset:0 sc1
    buffer_load_dwordx4 a[164:167], v24, s[20:23], s84 offen offset:0 sc1
    buffer_load_dwordx4 a[168:171], v23, s[20:23], s84 offen offset:1024 sc1
    buffer_load_dwordx4 a[172:175], v24, s[20:23], s84 offen offset:1024 sc1
    buffer_load_dwordx4 a[176:179], v23, s[20:23], s84 offen offset:2048 sc1
    buffer_load_dwordx4 a[180:183], v24, s[20:23], s84 offen offset:2048 sc1
    buffer_load_dwordx4 a[184:187], v23, s[20:23], s84 offen offset:3072 sc1
    buffer_load_dwordx4 a[188:191], v24, s[20:23], s84 offen offset:3072 sc1
    buffer_load_dwordx4 a[192:195], v23, s[20:23], s85 offen offset:0 sc1
    buffer_load_dwordx4 a[196:199], v24, s[20:23], s85 offen offset:0 sc1
    buffer_load_dwordx4 a[200:203], v23, s[20:23], s85 offen offset:1024 sc1
    buffer_load_dwordx4 a[204:207], v24, s[20:23], s85 offen offset:1024 sc1
    buffer_load_dwordx4 a[208:211], v23, s[20:23], s85 offen offset:2048 sc1
    buffer_load_dwordx4 a[212:215], v24, s[20:23], s85 offen offset:2048 sc1
    buffer_load_dwordx4 a[216:219], v23, s[20:23], s85 offen offset:3072 sc1
    buffer_load_dwordx4 a[220:223], v24, s[20:23], s85 offen offset:3072 sc1
    s_mov_b64 exec, 0
    s_branch CH_C
RT_C:
    s_mov_b64 exec, -1
    s_waitcnt vmcnt(0)
    s_waitcnt lgkmcnt(0)
CONVDONE:
    s_barrier
    ds_read_b64_tr_b16 v[200:201], v8 offset:28672
    ds_read_b64_tr_b16 v[202:203], v8 offset:29184
    ds_read_b64_tr_b16 v[204:205], v8 offset:35840
    ds_read_b64_tr_b16 v[206:207], v8 offset:36352
    ds_read_b64_tr_b16 v[208:209], v8 offset:43008
    ds_read_b64_tr_b16 v[210:211], v8 offset:43520
    ds_read_b64_tr_b16 v[212:213], v8 offset:50176
    ds_read_b64_tr_b16 v[214:215], v8 offset:50688
    ds_read_b64_tr_b16 v[216:217], v2 offset:29696
    ds_read_b64_tr_b16 v[218:219], v2 offset:30720
    ds_read_b64_tr_b16 v[220:221], v2 offset:36864
    ds_read_b64_tr_b16 v[222:223], v2 offset:37888
    ds_read_b64_tr_b16 v[224:225], v2 offset:44032
    ds_read_b64_tr_b16 v[226:227], v2 offset:45056
    ds_read_b64_tr_b16 v[228:229], v2 offset:51200
    ds_read_b64_tr_b16 v[230:231], v2 offset:52224
    s_waitcnt lgkmcnt(8)
    v_mfma_f32_16x16x32_bf16 v[128:131], v[200:203], a[0:3], 0
    ds_read_b64_tr_b16 v[232:233], v3 offset:29696
    s_add_u32 m0, s88, 98304
    v_mfma_f32_16x16x32_bf16 v[132:135], v[200:203], a[4:7], 0
    ds_read_b64_tr_b16 v[234:235], v3 offset:30720
    buffer_load_dwordx4 v23, s[20:23], s73 offen offset:0 sc1 lds
    v_mfma_f32_16x16x32_bf16 v[128:131], v[204:207], a[8:11], v[128:131]
    ds_read_b64_tr_b16 v[236:237], v3 offset:36864
    v_and_b32 v68, 15, v1
    v_mfma_f32_16x16x32_bf16 v[132:135], v[204:207], a[12:15], v[132:135]
    ds_read_b64_tr_b16 v[238:239], v3 offset:37888
    v_lshrrev_b32 v69, 4, v1
    v_mfma_f32_16x16x32_bf16 v[128:131], v[208:211], a[16:19], v[128:131]
    ds_read_b64_tr_b16 v[240:241], v3 offset:44032
    v_mul_u32_u24 v70, 1152, v68
    v_mfma_f32_16x16x32_bf16 v[132:135], v[208:211], a[20:23], v[132:135]
    ds_read_b64_tr_b16 v[242:243], v3 offset:45056
    v_lshl_add_u32 v17, v69, 4, v70
    v_mfma_f32_16x16x32_bf16 v[128:131], v[212:215], a[24:27], v[128:131]
    ds_read_b64_tr_b16 v[244:245], v3 offset:51200
    buffer_load_dwordx4 v23, s[20:23], s73 offen offset:1024 sc1 lds
    v_mfma_f32_16x16x32_bf16 v[132:135], v[212:215], a[28:31], v[132:135]
    ds_read_b64_tr_b16 v[246:247], v3 offset:52224
    s_waitcnt lgkmcnt(8)
    v_mfma_f32_16x16x32_bf16 v[136:139], v[216:219], a[0:3], 0
    ds_read_b64_tr_b16 v[200:201], v2 offset:31744
    v_lshlrev_b32 v22, 12, v68
    v_mfma_f32_16x16x32_bf16 v[140:143], v[216:219], a[4:7], 0
    ds_read_b64_tr_b16 v[202:203], v2 offset:32768
    v_lshl_add_u32 v22, v69, 4, v22
    v_mfma_f32_16x16x32_bf16 v[136:139], v[220:223], a[8:11], v[136:139]
    ds_read_b64_tr_b16 v[204:205], v2 offset:38912
    v_and_b32 v68, 1, v69
    v_mfma_f32_16x16x32_bf16 v[140:143], v[220:223], a[12:15], v[140:143]
    ds_read_b64_tr_b16 v[206:207], v2 offset:39936
    buffer_load_dwordx4 v23, s[20:23], s73 offen offset:2048 sc1 lds
    v_mfma_f32_16x16x32_bf16 v[136:139], v[224:227], a[16:19], v[136:139]
    ds_read_b64_tr_b16 v[208:209], v2 offset:46080
    v_lshrrev_b32 v71, 1, v69
    v_mfma_f32_16x16x32_bf16 v[140:143], v[224:227], a[20:23], v[140:143]
    ds_read_b64_tr_b16 v[210:211], v2 offset:47104
    v_lshl_add_u32 v21, v71, 4, v70
    v_mfma_f32_16x16x32_bf16 v[136:139], v[228:231], a[24:27], v[136:139]
    ds_read_b64_tr_b16 v[212:213], v2 offset:53248
    v_lshl_add_u32 v18, v68, 5, v21
    v_mfma_f32_16x16x32_bf16 v[140:143], v[228:231], a[28:31], v[140:143]
    ds_read_b64_tr_b16 v[214:215], v2 offset:54272
    s_waitcnt lgkmcnt(8)
    v_mfma_f32_16x16x32_bf16 v[144:147], v[232:235], a[0:3], 0
    ds_read_b64_tr_b16 v[216:217], v3 offset:31744
    buffer_load_dwordx4 v23, s[20:23], s73 offen offset:3072 sc1 lds
    v_mfma_f32_16x16x32_bf16 v[148:151], v[232:235], a[4:7], 0
    ds_read_b64_tr_b16 v[218:219], v3 offset:32768
    v_lshl_add_u32 v20, v68, 4, v70
    v_mfma_f32_16x16x32_bf16 v[144:147], v[236:239], a[8:11], v[144:147]
    ds_read_b64_tr_b16 v[220:221], v3 offset:38912
    v_mul_u32_u24 v68, 18432, v68
    v_mfma_f32_16x16x32_bf16 v[148:151], v[236:239], a[12:15], v[148:151]
    ds_read_b64_tr_b16 v[222:223], v3 offset:39936
    v_mul_u32_u24 v71, 18432, v71
    v_mfma_f32_16x16x32_bf16 v[144:147], v[240:243], a[16:19], v[144:147]
    ds_read_b64_tr_b16 v[224:225], v3 offset:46080
    v_add_u32 v21, v21, v68
    v_mfma_f32_16x16x32_bf16 v[148:151], v[240:243], a[20:23], v[148:151]
    ds_read_b64_tr_b16 v[226:227], v3 offset:47104
    s_add_u32 m0, s88, 102400
    v_mfma_f32_16x16x32_bf16 v[144:147], v[244:247], a[24:27], v[144:147]
    ds_read_b64_tr_b16 v[228:229], v3 offset:53248
    buffer_load_dwordx4 v34, s[20:23], s73 offen offset:0 sc1 lds
    v_mfma_f32_16x16x32_bf16 v[148:151], v[244:247], a[28:31], v[148:151]
    ds_read_b64_tr_b16 v[230:231], v3 offset:54272
    s_waitcnt lgkmcnt(8)
    v_mfma_f32_16x16x32_bf16 v[152:155], v[200:203], a[0:3], 0
    ds_read_b64_tr_b16 v[232:233], v2 offset:33792
    buffer_load_dword v36, v35, s[20:23], 0 offen offset:0 sc1
    v_mfma_f32_16x16x32_bf16 v[156:159], v[200:203], a[4:7], 0
    ds_read_b64_tr_b16 v[234:235], v2 offset:34816
    v_add_u32 v20, v20, v71
    v_mfma_f32_16x16x32_bf16 v[152:155], v[204:207], a[8:11], v[152:155]
    ds_read_b64_tr_b16 v[236:237], v2 offset:40960
    v_and_b32 v68, 1, v1
    v_mfma_f32_16x16x32_bf16 v[156:159], v[204:207], a[12:15], v[156:159]
    ds_read_b64_tr_b16 v[238:239], v2 offset:41984
    buffer_load_dwordx4 v34, s[20:23], s73 offen offset:1024 sc1 lds
    v_mfma_f32_16x16x32_bf16 v[152:155], v[208:211], a[16:19], v[152:155]
    ds_read_b64_tr_b16 v[240:241], v2 offset:48128
    v_lshlrev_b32 v68, 4, v68
    v_mfma_f32_16x16x32_bf16 v[156:159], v[208:211], a[20:23], v[156:159]
    ds_read_b64_tr_b16 v[242:243], v2 offset:49152
    v_mov_b32 v70, 0x3f80
    v_mfma_f32_16x16x32_bf16 v[152:155], v[212:215], a[24:27], v[152:155]
    ds_read_b64_tr_b16 v[244:245], v2 offset:55296
    v_lshlrev_b32 v68, v68, v70
    v_mfma_f32_16x16x32_bf16 v[156:159], v[212:215], a[28:31], v[156:159]
    ds_read_b64_tr_b16 v[246:247], v2 offset:56320
    s_waitcnt lgkmcnt(8)
    v_mfma_f32_16x16x32_bf16 v[160:163], v[216:219], a[0:3], 0
    ds_read_b64_tr_b16 v[200:201], v3 offset:33792
    buffer_load_dwordx4 v34, s[20:23], s73 offen offset:2048 sc1 lds
    v_mfma_f32_16x16x32_bf16 v[164:167], v[216:219], a[4:7], 0
    ds_read_b64_tr_b16 v[202:203], v3 offset:34816
    v_bfe_u32 v70, v1, 1, 3
    v_mfma_f32_16x16x32_bf16 v[160:163], v[220:223], a[8:11], v[160:163]
    ds_read_b64_tr_b16 v[204:205], v3 offset:40960
    v_lshlrev_b32 v71, 1, v69
    v_mfma_f32_16x16x32_bf16 v[164:167], v[220:223], a[12:15], v[164:167]
    ds_read_b64_tr_b16 v[206:207], v3 offset:41984
    v_sub_u32 v70, v70, v71
    v_mfma_f32_16x16x32_bf16 v[160:163], v[224:227], a[16:19], v[160:163]
    ds_read_b64_tr_b16 v[208:209], v3 offset:48128
    v_sub_u32 v71, v70, v71
    v_mfma_f32_16x16x32_bf16 v[164:167], v[224:227], a[20:23], v[164:167]
    ds_read_b64_tr_b16 v[210:211], v3 offset:49152
    buffer_load_dwordx4 a[224:227], v23, s[20:23], s86 offen offset:0 sc1
    v_mfma_f32_16x16x32_bf16 v[160:163], v[228:231], a[24:27], v[160:163]
    ds_read_b64_tr_b16 v[212:213], v3 offset:55296
    v_mov_b32 v10, 0
    v_mfma_f32_16x16x32_bf16 v[164:167], v[228:231], a[28:31], v[164:167]
    ds_read_b64_tr_b16 v[214:215], v3 offset:56320
    s_waitcnt lgkmcnt(8)
    v_mfma_f32_16x16x32_bf16 v[168:171], v[232:235], a[0:3], 0
    s_barrier
    v_mfma_f32_16x16x32_bf16 v[172:175], v[232:235], a[4:7], 0
    ds_read_b64_tr_b16 v[216:217], v9 offset:0
    ds_read_b64_tr_b16 v[218:219], v9 offset:512
    v_mfma_f32_16x16x32_bf16 v[168:171], v[236:239], a[8:11], v[168:171]
    ds_read_b64_tr_b16 v[220:221], v9 offset:7168
    s_add_u32 m0, s88, 126976
    v_mfma_f32_16x16x32_bf16 v[172:175], v[236:239], a[12:15], v[172:175]
    ds_read_b64_tr_b16 v[222:223], v9 offset:7680
    buffer_load_dwordx4 v23, s[20:23], s74 offen offset:0 sc1 lds
    v_mfma_f32_16x16x32_bf16 v[168:171], v[240:243], a[16:19], v[168:171]
    ds_read_b64_tr_b16 v[224:225], v9 offset:14336
    buffer_load_dwordx4 a[228:231], v24, s[20:23], s86 offen offset:0 sc1
    v_mfma_f32_16x16x32_bf16 v[172:175], v[240:243], a[20:23], v[172:175]
    ds_read_b64_tr_b16 v[226:227], v9 offset:14848
    v_mov_b32 v11, 0
    v_mfma_f32_16x16x32_bf16 v[168:171], v[244:247], a[24:27], v[168:171]
    ds_read_b64_tr_b16 v[228:229], v9 offset:21504
    v_mov_b32 v14, 0
    v_mfma_f32_16x16x32_bf16 v[172:175], v[244:247], a[28:31], v[172:175]
    ds_read_b64_tr_b16 v[230:231], v9 offset:22016
    s_waitcnt lgkmcnt(8)
    v_mfma_f32_16x16x32_bf16 v[176:179], v[200:203], a[0:3], 0
    ds_read_b64_tr_b16 v[232:233], v4 offset:1024
    buffer_load_dwordx4 v23, s[20:23], s74 offen offset:1024 sc1 lds
    v_mfma_f32_16x16x32_bf16 v[180:183], v[200:203], a[4:7], 0
    ds_read_b64_tr_b16 v[234:235], v4 offset:2048
    buffer_load_dwordx4 a[232:235], v23, s[20:23], s86 offen offset:1024 sc1
    v_mfma_f32_16x16x32_bf16 v[176:179], v[204:207], a[8:11], v[176:179]
    ds_read_b64_tr_b16 v[236:237], v4 offset:8192
    v_mov_b32 v15, 0
    v_mfma_f32_16x16x32_bf16 v[180:183], v[204:207], a[12:15], v[180:183]
    ds_read_b64_tr_b16 v[238:239], v4 offset:9216
    v_cmp_eq_i32 vcc, 0, v70
    s_nop 1
    v_cndmask_b32 v12, 0, v68, vcc
    v_mfma_f32_16x16x32_bf16 v[176:179], v[208:211], a[16:19], v[176:179]
    ds_read_b64_tr_b16 v[240:241], v4 offset:15360
    v_cmp_eq_i32 vcc, 1, v70
    s_nop 1
    v_cndmask_b32 v13, 0, v68, vcc
    v_mfma_f32_16x16x32_bf16 v[180:183], v[208:211], a[20:23], v[180:183]
    ds_read_b64_tr_b16 v[242:243], v4 offset:16384
    buffer_load_dwordx4 v23, s[20:23], s74 offen offset:2048 sc1 lds
    v_mfma_f32_16x16x32_bf16 v[176:179], v[212:215], a[24:27], v[176:179]
    ds_read_b64_tr_b16 v[244:245], v4 offset:22528
    buffer_load_dwordx4 a[236:239], v24, s[20:23], s86 offen offset:1024 sc1
    v_mfma_f32_16x16x32_bf16 v[180:183], v[212:215], a[28:31], v[180:183]
    ds_read_b64_tr_b16 v[246:247], v4 offset:23552
    s_waitcnt lgkmcnt(8)
    v_mfma_f32_16x16x32_bf16 v[128:131], v[216:219], a[32:35], v[128:131]
    ds_read_b64_tr_b16 v[200:201], v5 offset:1024
    v_cmp_eq_i32 vcc, 0, v71
    s_nop 1
    v_cndmask_b32 v248, 0, v68, vcc
    v_mfma_f32_16x16x32_bf16 v[132:135], v[216:219], a[36:39], v[132:135]
    ds_read_b64_tr_b16 v[202:203], v5 offset:2048
    v_cmp_eq_i32 vcc, 1, v71
    s_nop 1
    v_cndmask_b32 v249, 0, v68, vcc
    v_mfma_f32_16x16x32_bf16 v[128:131], v[220:223], a[40:43], v[128:131]
    ds_read_b64_tr_b16 v[204:205], v5 offset:8192
    buffer_load_dwordx4 v23, s[20:23], s74 offen offset:3072 sc1 lds
    v_mfma_f32_16x16x32_bf16 v[132:135], v[220:223], a[44:47], v[132:135]
    ds_read_b64_tr_b16 v[206:207], v5 offset:9216
    v_cmp_eq_i32 vcc, 2, v71
    s_nop 1
    v_cndmask_b32 v250, 0, v68, vcc
    v_mfma_f32_16x16x32_bf16 v[128:131], v[224:227], a[48:51], v[128:131]
    ds_read_b64_tr_b16 v[208:209], v5 offset:15360
    v_cmp_eq_i32 vcc, 3, v71
    s_nop 1
    v_cndmask_b32 v251, 0, v68, vcc
    v_mfma_f32_16x16x32_bf16 v[132:135], v[224:227], a[52:55], v[132:135]
    ds_read_b64_tr_b16 v[210:211], v5 offset:16384
    v_cmp_eq_i32 vcc, -8, v71
    s_nop 1
    v_cndmask_b32 v252, 0, v68, vcc
    v_mfma_f32_16x16x32_bf16 v[128:131], v[228:231], a[56:59], v[128:131]
    ds_read_b64_tr_b16 v[212:213], v5 offset:22528
    v_cmp_eq_i32 vcc, -7, v71
    s_nop 1
    v_cndmask_b32 v253, 0, v68, vcc
    v_mfma_f32_16x16x32_bf16 v[132:135], v[228:231], a[60:63], v[132:135]
    ds_read_b64_tr_b16 v[214:215], v5 offset:23552
    s_waitcnt lgkmcnt(8)
    v_mfma_f32_16x16x32_bf16 v[136:139], v[232:235], a[32:35], v[136:139]
    ds_read_b64_tr_b16 v[216:217], v4 offset:3072
    s_add_u32 m0, s88, 131072
    v_mfma_f32_16x16x32_bf16 v[140:143], v[232:235], a[36:39], v[140:143]
    ds_read_b64_tr_b16 v[218:219], v4 offset:4096
    buffer_load_dwordx4 v34, s[20:23], s74 offen offset:0 sc1 lds
    v_mfma_f32_16x16x32_bf16 v[136:139], v[236:239], a[40:43], v[136:139]
    ds_read_b64_tr_b16 v[220:221], v4 offset:10240
    v_cmp_eq_i32 vcc, -6, v71
    s_nop 1
    v_cndmask_b32 v254, 0, v68, vcc
    v_mfma_f32_16x16x32_bf16 v[140:143], v[236:239], a[44:47], v[140:143]
    ds_read_b64_tr_b16 v[222:223], v4 offset:11264
    v_cmp_eq_i32 vcc, -5, v71
    s_nop 1
    v_cndmask_b32 v255, 0, v68, vcc
    v_mfma_f32_16x16x32_bf16 v[136:139], v[240:243], a[48:51], v[136:139]
    ds_read_b64_tr_b16 v[224:225], v4 offset:17408
    s_mul_i32 s62, s96, 1152
    v_mfma_f32_16x16x32_bf16 v[140:143], v[240:243], a[52:55], v[140:143]
    ds_read_b64_tr_b16 v[226:227], v4 offset:18432
    s_lshl_b32 s66, s93, 2
    v_mfma_f32_16x16x32_bf16 v[136:139], v[244:247], a[56:59], v[136:139]
    ds_read_b64_tr_b16 v[228:229], v4 offset:24576
    buffer_load_dwordx4 v34, s[20:23], s74 offen offset:1024 sc1 lds
    v_mfma_f32_16x16x32_bf16 v[140:143], v[244:247], a[60:63], v[140:143]
    ds_read_b64_tr_b16 v[230:231], v4 offset:25600
    s_waitcnt lgkmcnt(8)
    v_mfma_f32_16x16x32_bf16 v[144:147], v[200:203], a[32:35], v[144:147]
    ds_read_b64_tr_b16 v[232:233], v5 offset:3072
    s_add_u32 s66, s66, s35
    v_mfma_f32_16x16x32_bf16 v[148:151], v[200:203], a[36:39], v[148:151]
    ds_read_b64_tr_b16 v[234:235], v5 offset:4096
    s_lshl_b32 s60, s66, 6
    v_mfma_f32_16x16x32_bf16 v[144:147], v[204:207], a[40:43], v[144:147]
    ds_read_b64_tr_b16 v[236:237], v5 offset:10240
    s_add_u32 s60, s60, s62
    v_mfma_f32_16x16x32_bf16 v[148:151], v[204:207], a[44:47], v[148:151]
    ds_read_b64_tr_b16 v[238:239], v5 offset:11264
    buffer_load_dwordx4 v34, s[20:23], s74 offen offset:2048 sc1 lds
    v_mfma_f32_16x16x32_bf16 v[144:147], v[208:211], a[48:51], v[144:147]
    ds_read_b64_tr_b16 v[240:241], v5 offset:17408
    s_add_u32 s61, s60, 18432
    v_mfma_f32_16x16x32_bf16 v[148:151], v[208:211], a[52:55], v[148:151]
CH_C:
PG10:
    s_cbranch_execz PG11
    ds_read_b64_tr_b16 v[242:243], v5 offset:18432
    s_lshl_b32 s65, s93, 5
    v_mfma_f32_16x16x32_bf16 v[144:147], v[212:215], a[56:59], v[144:147]
    ds_read_b64_tr_b16 v[244:245], v5 offset:24576
    buffer_load_dwordx4 a[240:243], v23, s[20:23], s86 offen offset:2048 sc1
    v_mfma_f32_16x16x32_bf16 v[148:151], v[212:215], a[60:63], v[148:151]
    ds_read_b64_tr_b16 v[246:247], v5 offset:25600
    s_waitcnt lgkmcnt(8)
    v_mfma_f32_16x16x32_bf16 v[152:155], v[216:219], a[32:35], v[152:155]
    ds_read_b64_tr_b16 v[200:201], v4 offset:5120
    s_add_u32 s62, s62, s65
    v_mfma_f32_16x16x32_bf16 v[156:159], v[216:219], a[36:39], v[156:159]
    ds_read_b64_tr_b16 v[202:203], v4 offset:6144
    s_add_u32 s62, s62, 1024
    v_mfma_f32_16x16x32_bf16 v[152:155], v[220:223], a[40:43], v[152:155]
    ds_read_b64_tr_b16 v[204:205], v4 offset:12288
    buffer_load_dwordx4 a[244:247], v24, s[20:23], s86 offen offset:2048 sc1
    v_mfma_f32_16x16x32_bf16 v[156:159], v[220:223], a[44:47], v[156:159]
    ds_read_b64_tr_b16 v[206:207], v4 offset:13312
    s_lshl_b32 s65, s96, 1
    v_mfma_f32_16x16x32_bf16 v[152:155], v[224:227], a[48:51], v[152:155]
    ds_read_b64_tr_b16 v[208:209], v4 offset:19456
    s_add_u32 s65, s65, 4718592
    v_mfma_f32_16x16x32_bf16 v[156:159], v[224:227], a[52:55], v[156:159]
    ds_read_b64_tr_b16 v[210:211], v4 offset:20480
    s_lshl_b32 s63, s66, 17
    v_mfma_f32_16x16x32_bf16 v[152:155], v[228:231], a[56:59], v[152:155]
    ds_read_b64_tr_b16 v[212:213], v4 offset:26624
    buffer_load_dwordx4 a[248:251], v23, s[20:23], s86 offen offset:3072 sc1
    v_mfma_f32_16x16x32_bf16 v[156:159], v[228:231], a[60:63], v[156:159]
    ds_read_b64_tr_b16 v[214:215], v4 offset:27648
    s_waitcnt lgkmcnt(8)
    v_mfma_f32_16x16x32_bf16 v[160:163], v[232:235], a[32:35], v[160:163]
    ds_read_b64_tr_b16 v[216:217], v5 offset:5120
    s_waitcnt vmcnt(16)
    v_mfma_f32_16x16x32_bf16 v[164:167], v[232:235], a[36:39], v[164:167]
    ds_read_b64_tr_b16 v[218:219], v5 offset:6144
    v_cmp_ne_u32 vcc, s59, v36
    v_mfma_f32_16x16x32_bf16 v[160:163], v[236:239], a[40:43], v[160:163]
    ds_read_b64_tr_b16 v[220:221], v5 offset:12288
    s_cbranch_vccnz SLOW_h2
RET_h2:
    v_mfma_f32_16x16x32_bf16 v[164:167], v[236:239], a[44:47], v[164:167]
    ds_read_b64_tr_b16 v[222:223], v5 offset:13312
    buffer_load_dwordx4 a[252:255], v24, s[20:23], s86 offen offset:3072 sc1
    v_mfma_f32_16x16x32_bf16 v[160:163], v[240:243], a[48:51], v[160:163]
    ds_read_b64_tr_b16 v[224:225], v5 offset:19456
    s_add_u32 s63, s63, s65
    v_mfma_f32_16x16x32_bf16 v[164:167], v[240:243], a[52:55], v[164:167]
    ds_read_b64_tr_b16 v[226:227], v5 offset:20480
    s_add_u32 s64, s63, 65536
    v_mfma_f32_16x16x32_bf16 v[160:163], v[244:247], a[56:59], v[160:163]
    ds_read_b64_tr_b16 v[228:229], v5 offset:26624
    s_lshl_b32 s66, s93, 16
    v_mfma_f32_16x16x32_bf16 v[164:167], v[244:247], a[60:63], v[164:167]
    ds_read_b64_tr_b16 v[230:231], v5 offset:27648
    s_waitcnt lgkmcnt(8)
    v_mfma_f32_16x16x32_bf16 v[168:171], v[200:203], a[32:35], v[168:171]
    s_barrier
    v_mfma_f32_16x16x32_bf16 v[172:175], v[200:203], a[36:39], v[172:175]
    ds_read_b64_tr_b16 v[232:233], v8 offset:0
    ds_read_b64_tr_b16 v[234:235], v8 offset:512
    v_mfma_f32_16x16x32_bf16 v[168:171], v[204:207], a[40:43], v[168:171]
    ds_read_b64_tr_b16 v[236:237], v8 offset:7168
    s_add_u32 m0, s88, 40960
    v_mfma_f32_16x16x32_bf16 v[172:175], v[204:207], a[44:47], v[172:175]
    ds_read_b64_tr_b16 v[238:239], v8 offset:7680
    buffer_load_dwordx4 v23, s[20:23], s75 offen offset:0 sc1 lds
    v_mfma_f32_16x16x32_bf16 v[168:171], v[208:211], a[48:51], v[168:171]
    ds_read_b64_tr_b16 v[240:241], v8 offset:14336
    s_add_u32 s65, s65, s66
    v_mfma_f32_16x16x32_bf16 v[172:175], v[208:211], a[52:55], v[172:175]
    ds_read_b64_tr_b16 v[242:243], v8 offset:14848
    s_add_u32 s65, s65, 2097152
    v_mfma_f32_16x16x32_bf16 v[168:171], v[212:215], a[56:59], v[168:171]
    ds_read_b64_tr_b16 v[244:245], v8 offset:21504
    s_add_u32 s66, s95, 4096
    v_mfma_f32_16x16x32_bf16 v[172:175], v[212:215], a[60:63], v[172:175]
    ds_read_b64_tr_b16 v[246:247], v8 offset:22016
    s_waitcnt lgkmcnt(8)
    v_mfma_f32_16x16x32_bf16 v[176:179], v[216:219], a[32:35], v[176:179]
    ds_read_b64_tr_b16 v[200:201], v2 offset:1024
    buffer_load_dwordx4 v23, s[20:23], s75 offen offset:1024 sc1 lds
    v_mfma_f32_16x16x32_bf16 v[180:183], v[216:219], a[36:39], v[180:183]
    ds_read_b64_tr_b16 v[202:203], v2 offset:2048
    s_xor_b32 s67, s35, 1
    v_mfma_f32_16x16x32_bf16 v[176:179], v[220:223], a[40:43], v[176:179]
    ds_read_b64_tr_b16 v[204:205], v2 offset:8192
    s_lshl_b32 s67, s67, 10
    v_mfma_f32_16x16x32_bf16 v[180:183], v[220:223], a[44:47], v[180:183]
    ds_read_b64_tr_b16 v[206:207], v2 offset:9216
    s_add_u32 s67, s67, s97
    v_mfma_f32_16x16x32_bf16 v[176:179], v[224:227], a[48:51], v[176:179]
    ds_read_b64_tr_b16 v[208:209], v2 offset:15360
    s_cmp_eq_u32 s3, s35
    s_cselect_b32 s67, s67, 134217728
    v_mfma_f32_16x16x32_bf16 v[180:183], v[224:227], a[52:55], v[180:183]
    ds_read_b64_tr_b16 v[210:211], v2 offset:16384
    buffer_load_dwordx4 v23, s[20:23], s75 offen offset:2048 sc1 lds
    v_mfma_f32_16x16x32_bf16 v[176:179], v[228:231], a[56:59], v[176:179]
    ds_read_b64_tr_b16 v[212:213], v2 offset:22528
    s_xor_b32 s68, s35, 2
    v_mfma_f32_16x16x32_bf16 v[180:183], v[228:231], a[60:63], v[180:183]
    ds_read_b64_tr_b16 v[214:215], v2 offset:23552
    s_waitcnt lgkmcnt(8)
    v_mfma_f32_16x16x32_bf16 v[128:131], v[232:235], a[64:67], v[128:131]
    ds_read_b64_tr_b16 v[216:217], v3 offset:1024
    s_lshl_b32 s68, s68, 10
    v_mfma_f32_16x16x32_bf16 v[132:135], v[232:235], a[68:71], v[132:135]
    ds_read_b64_tr_b16 v[218:219], v3 offset:2048
    s_add_u32 s68, s68, s97
    v_mfma_f32_16x16x32_bf16 v[128:131], v[236:239], a[72:75], v[128:131]
    ds_read_b64_tr_b16 v[220:221], v3 offset:8192
    buffer_load_dwordx4 v23, s[20:23], s75 offen offset:3072 sc1 lds
    v_mfma_f32_16x16x32_bf16 v[132:135], v[236:239], a[76:79], v[132:135]
    ds_read_b64_tr_b16 v[222:223], v3 offset:9216
    s_cmp_eq_u32 s3, s35
    s_cselect_b32 s68, s68, 134217728
    v_mfma_f32_16x16x32_bf16 v[128:131], v[240:243], a[80:83], v[128:131]
    ds_read_b64_tr_b16 v[224:225], v3 offset:15360
    s_xor_b32 s69, s35, 3
    v_mfma_f32_16x16x32_bf16 v[132:135], v[240:243], a[84:87], v[132:135]
    ds_read_b64_tr_b16 v[226:227], v3 offset:16384
    s_lshl_b32 s69, s69, 10
    v_mfma_f32_16x16x32_bf16 v[128:131], v[244:247], a[88:91], v[128:131]
    ds_read_b64_tr_b16 v[228:229], v3 offset:22528
    s_add_u32 s69, s69, s97
    v_mfma_f32_16x16x32_bf16 v[132:135], v[244:247], a[92:95], v[132:135]
    ds_read_b64_tr_b16 v[230:231], v3 offset:23552
    s_waitcnt lgkmcnt(8)
    v_mfma_f32_16x16x32_bf16 v[136:139], v[200:203], a[64:67], v[136:139]
    ds_read_b64_tr_b16 v[232:233], v2 offset:3072
    s_add_u32 m0, s88, 45056
    v_mfma_f32_16x16x32_bf16 v[140:143], v[200:203], a[68:71], v[140:143]
    ds_read_b64_tr_b16 v[234:235], v2 offset:4096
    buffer_load_dwordx4 v34, s[20:23], s75 offen offset:0 sc1 lds
    v_mfma_f32_16x16x32_bf16 v[136:139], v[204:207], a[72:75], v[136:139]
    ds_read_b64_tr_b16 v[236:237], v2 offset:10240
    s_cmp_eq_u32 s3, s35
    s_cselect_b32 s69, s69, 134217728
    v_mfma_f32_16x16x32_bf16 v[140:143], v[204:207], a[76:79], v[140:143]
    ds_read_b64_tr_b16 v[238:239], v2 offset:11264
    v_mfma_f32_16x16x32_bf16 v[136:139], v[208:211], a[80:83], v[136:139]
    ds_read_b64_tr_b16 v[240:241], v2 offset:17408
    v_mfma_f32_16x16x32_bf16 v[140:143], v[208:211], a[84:87], v[140:143]
    ds_read_b64_tr_b16 v[242:243], v2 offset:18432
    v_mfma_f32_16x16x32_bf16 v[136:139], v[212:215], a[88:91], v[136:139]
    ds_read_b64_tr_b16 v[244:245], v2 offset:24576
    buffer_load_dwordx4 v34, s[20:23], s75 offen offset:1024 sc1 lds
    v_mfma_f32_16x16x32_bf16 v[140:143], v[212:215], a[92:95], v[140:143]
    ds_read_b64_tr_b16 v[246:247], v2 offset:25600
    s_waitcnt lgkmcnt(8)
    v_mfma_f32_16x16x32_bf16 v[144:147], v[216:219], a[64:67], v[144:147]
    ds_read_b64_tr_b16 v[200:201], v3 offset:3072
    v_mfma_f32_16x16x32_bf16 v[148:151], v[216:219], a[68:71], v[148:151]
    ds_read_b64_tr_b16 v[202:203], v3 offset:4096
    v_mfma_f32_16x16x32_bf16 v[144:147], v[220:223], a[72:75], v[144:147]
    ds_read_b64_tr_b16 v[204:205], v3 offset:10240
    v_mfma_f32_16x16x32_bf16 v[148:151], v[220:223], a[76:79], v[148:151]
    ds_read_b64_tr_b16 v[206:207], v3 offset:11264
    buffer_load_dwordx4 v34, s[20:23], s75 offen offset:2048 sc1 lds
    v_mfma_f32_16x16x32_bf16 v[144:147], v[224:227], a[80:83], v[144:147]
    ds_read_b64_tr_b16 v[208:209], v3 offset:17408
    v_mfma_f32_16x16x32_bf16 v[148:151], v[224:227], a[84:87], v[148:151]
    ds_read_b64_tr_b16 v[210:211], v3 offset:18432
    v_mfma_f32_16x16x32_bf16 v[144:147], v[228:231], a[88:91], v[144:147]
    ds_read_b64_tr_b16 v[212:213], v3 offset:24576
    buffer_load_dwordx4 v[96:99], v23, s[20:23], s87 offen offset:0 sc1
    v_mfma_f32_16x16x32_bf16 v[148:151], v[228:231], a[92:95], v[148:151]
    ds_read_b64_tr_b16 v[214:215], v3 offset:25600
    s_waitcnt lgkmcnt(8)
    v_mfma_f32_16x16x32_bf16 v[152:155], v[232:235], a[64:67], v[152:155]
    ds_read_b64_tr_b16 v[216:217], v2 offset:5120
    v_mfma_f32_16x16x32_bf16 v[156:159], v[232:235], a[68:71], v[156:159]
    ds_read_b64_tr_b16 v[218:219], v2 offset:6144
    v_mfma_f32_16x16x32_bf16 v[152:155], v[236:239], a[72:75], v[152:155]
    ds_read_b64_tr_b16 v[220:221], v2 offset:12288
    buffer_load_dwordx4 v[100:103], v24, s[20:23], s87 offen offset:0 sc1
    v_mfma_f32_16x16x32_bf16 v[156:159], v[236:239], a[76:79], v[156:159]
    ds_read_b64_tr_b16 v[222:223], v2 offset:13312
    v_mfma_f32_16x16x32_bf16 v[152:155], v[240:243], a[80:83], v[152:155]
    ds_read_b64_tr_b16 v[224:225], v2 offset:19456
    v_mfma_f32_16x16x32_bf16 v[156:159], v[240:243], a[84:87], v[156:159]
    ds_read_b64_tr_b16 v[226:227], v2 offset:20480
    v_mfma_f32_16x16x32_bf16 v[152:155], v[244:247], a[88:91], v[152:155]
    ds_read_b64_tr_b16 v[228:229], v2 offset:26624
    buffer_load_dwordx4 v[104:107], v23, s[20:23], s87 offen offset:1024 sc1
    v_mfma_f32_16x16x32_bf16 v[156:159], v[244:247], a[92:95], v[156:159]
    ds_read_b64_tr_b16 v[230:231], v2 offset:27648
    s_waitcnt lgkmcnt(8)
    v_mfma_f32_16x16x32_bf16 v[160:163], v[200:203], a[64:67], v[160:163]
    ds_read_b64_tr_b16 v[232:233], v3 offset:5120
    v_mfma_f32_16x16x32_bf16 v[164:167], v[200:203], a[68:71], v[164:167]
    ds_read_b64_tr_b16 v[234:235], v3 offset:6144
    v_mfma_f32_16x16x32_bf16 v[160:163], v[204:207], a[72:75], v[160:163]
    ds_read_b64_tr_b16 v[236:237], v3 offset:12288
    buffer_load_dwordx4 v[108:111], v24, s[20:23], s87 offen offset:1024 sc1
    v_mfma_f32_16x16x32_bf16 v[164:167], v[204:207], a[76:79], v[164:167]
    ds_read_b64_tr_b16 v[238:239], v3 offset:13312
    v_mfma_f32_16x16x32_bf16 v[160:163], v[208:211], a[80:83], v[160:163]
    ds_read_b64_tr_b16 v[240:241], v3 offset:19456
    v_mfma_f32_16x16x32_bf16 v[164:167], v[208:211], a[84:87], v[164:167]
    ds_read_b64_tr_b16 v[242:243], v3 offset:20480
    v_mfma_f32_16x16x32_bf16 v[160:163], v[212:215], a[88:91], v[160:163]
    ds_read_b64_tr_b16 v[244:245], v3 offset:26624
    v_mfma_f32_16x16x32_bf16 v[164:167], v[212:215], a[92:95], v[164:167]
    ds_read_b64_tr_b16 v[246:247], v3 offset:27648
    s_waitcnt lgkmcnt(8)
    v_mfma_f32_16x16x32_bf16 v[168:171], v[216:219], a[64:67], v[168:171]
    s_waitcnt vmcnt(26)
    s_barrier
    v_mfma_f32_16x16x32_bf16 v[172:175], v[216:219], a[68:71], v[172:175]
    ds_read_b64_tr_b16 v[200:201], v9 offset:28672
    ds_read_b64_tr_b16 v[202:203], v9 offset:29184
    v_mfma_f32_16x16x32_bf16 v[168:171], v[220:223], a[72:75], v[168:171]
    ds_read_b64_tr_b16 v[204:205], v9 offset:35840
    s_add_u32 m0, s88, 69632
    v_mfma_f32_16x16x32_bf16 v[172:175], v[220:223], a[76:79], v[172:175]
    ds_read_b64_tr_b16 v[206:207], v9 offset:36352
    buffer_load_dwordx4 v23, s[20:23], s76 offen offset:0 sc1 lds
    v_mfma_f32_16x16x32_bf16 v[168:171], v[224:227], a[80:83], v[168:171]
    ds_read_b64_tr_b16 v[208:209], v9 offset:43008
    s_mov_b64 exec, 1
    buffer_store_dword v38, off, s[20:23], s6 sc1
    s_mov_b64 exec, -1
    v_mfma_f32_16x16x32_bf16 v[172:175], v[224:227], a[84:87], v[172:175]
    ds_read_b64_tr_b16 v[210:211], v9 offset:43520
    v_mfma_f32_16x16x32_bf16 v[168:171], v[228:231], a[88:91], v[168:171]
    ds_read_b64_tr_b16 v[212:213], v9 offset:50176
    v_mfma_f32_16x16x32_bf16 v[172:175], v[228:231], a[92:95], v[172:175]
    ds_read_b64_tr_b16 v[214:215], v9 offset:50688
    s_waitcnt lgkmcnt(8)
    v_mfma_f32_16x16x32_bf16 v[176:179], v[232:235], a[64:67], v[176:179]
    ds_read_b64_tr_b16 v[216:217], v4 offset:29696
    buffer_load_dwordx4 v23, s[20:23], s76 offen offset:1024 sc1 lds
    v_mfma_f32_16x16x32_bf16 v[180:183], v[232:235], a[68:71], v[180:183]
    ds_read_b64_tr_b16 v[218:219], v4 offset:30720
    v_mfma_f32_16x16x32_bf16 v[176:179], v[236:239], a[72:75], v[176:179]
    ds_read_b64_tr_b16 v[220:221], v4 offset:36864
    v_mfma_f32_16x16x32_bf16 v[180:183], v[236:239], a[76:79], v[180:183]
    ds_read_b64_tr_b16 v[222:223], v4 offset:37888
    v_mfma_f32_16x16x32_bf16 v[176:179], v[240:243], a[80:83], v[176:179]
    ds_read_b64_tr_b16 v[224:225], v4 offset:44032
    v_mfma_f32_16x16x32_bf16 v[180:183], v[240:243], a[84:87], v[180:183]
    ds_read_b64_tr_b16 v[226:227], v4 offset:45056
    buffer_load_dwordx4 v23, s[20:23], s76 offen offset:2048 sc1 lds
    v_mfma_f32_16x16x32_bf16 v[176:179], v[244:247], a[88:91], v[176:179]
    ds_read_b64_tr_b16 v[228:229], v4 offset:51200
    v_mfma_f32_16x16x32_bf16 v[180:183], v[244:247], a[92:95], v[180:183]
    ds_read_b64_tr_b16 v[230:231], v4 offset:52224
    s_waitcnt lgkmcnt(8)
    v_mfma_f32_16x16x32_bf16 v[128:131], v[200:203], a[96:99], v[128:131]
    ds_read_b64_tr_b16 v[232:233], v5 offset:29696
    v_mfma_f32_16x16x32_bf16 v[132:135], v[200:203], a[100:103], v[132:135]
    ds_read_b64_tr_b16 v[234:235], v5 offset:30720
    v_mfma_f32_16x16x32_bf16 v[128:131], v[204:207], a[104:107], v[128:131]
    ds_read_b64_tr_b16 v[236:237], v5 offset:36864
    buffer_load_dwordx4 v23, s[20:23], s76 offen offset:3072 sc1 lds
    v_mfma_f32_16x16x32_bf16 v[132:135], v[204:207], a[108:111], v[132:135]
    ds_read_b64_tr_b16 v[238:239], v5 offset:37888
    v_mfma_f32_16x16x32_bf16 v[128:131], v[208:211], a[112:115], v[128:131]
    ds_read_b64_tr_b16 v[240:241], v5 offset:44032
    v_mfma_f32_16x16x32_bf16 v[132:135], v[208:211], a[116:119], v[132:135]
    ds_read_b64_tr_b16 v[242:243], v5 offset:45056
    v_mfma_f32_16x16x32_bf16 v[128:131], v[212:215], a[120:123], v[128:131]
    ds_read_b64_tr_b16 v[244:245], v5 offset:51200
    v_mfma_f32_16x16x32_bf16 v[132:135], v[212:215], a[124:127], v[132:135]
    ds_read_b64_tr_b16 v[246:247], v5 offset:52224
    s_waitcnt lgkmcnt(8)
    v_mfma_f32_16x16x32_bf16 v[136:139], v[216:219], a[96:99], v[136:139]
    ds_read_b64_tr_b16 v[200:201], v4 offset:31744
    s_add_u32 m0, s88, 73728
    v_mfma_f32_16x16x32_bf16 v[140:143], v[216:219], a[100:103], v[140:143]
    ds_read_b64_tr_b16 v[202:203], v4 offset:32768
    buffer_load_dwordx4 v34, s[20:23], s76 offen offset:0 sc1 lds
    v_mfma_f32_16x16x32_bf16 v[136:139], v[220:223], a[104:107], v[136:139]
    ds_read_b64_tr_b16 v[204:205], v4 offset:38912
    v_mfma_f32_16x16x32_bf16 v[140:143], v[220:223], a[108:111], v[140:143]
    ds_read_b64_tr_b16 v[206:207], v4 offset:39936
    v_mfma_f32_16x16x32_bf16 v[136:139], v[224:227], a[112:115], v[136:139]
    ds_read_b64_tr_b16 v[208:209], v4 offset:46080
    v_mfma_f32_16x16x32_bf16 v[140:143], v[224:227], a[116:119], v[140:143]
    ds_read_b64_tr_b16 v[210:211], v4 offset:47104
    v_mfma_f32_16x16x32_bf16 v[136:139], v[228:231], a[120:123], v[136:139]
    ds_read_b64_tr_b16 v[212:213], v4 offset:53248
    buffer_load_dwordx4 v34, s[20:23], s76 offen offset:1024 sc1 lds
    v_mfma_f32_16x16x32_bf16 v[140:143], v[228:231], a[124:127], v[140:143]
    ds_read_b64_tr_b16 v[214:215], v4 offset:54272
    s_waitcnt lgkmcnt(8)
    v_mfma_f32_16x16x32_bf16 v[144:147], v[232:235], a[96:99], v[144:147]
    ds_read_b64_tr_b16 v[216:217], v5 offset:31744
    v_mfma_f32_16x16x32_bf16 v[148:151], v[232:235], a[100:103], v[148:151]
    ds_read_b64_tr_b16 v[218:219], v5 offset:32768
    v_mfma_f32_16x16x32_bf16 v[144:147], v[236:239], a[104:107], v[144:147]
    ds_read_b64_tr_b16 v[220:221], v5 offset:38912
    v_mfma_f32_16x16x32_bf16 v[148:151], v[236:239], a[108:111], v[148:151]
    ds_read_b64_tr_b16 v[222:223], v5 offset:39936
    buffer_load_dwordx4 v34, s[20:23], s76 offen offset:2048 sc1 lds
    v_mfma_f32_16x16x32_bf16 v[144:147], v[240:243], a[112:115], v[144:147]
    ds_read_b64_tr_b16 v[224:225], v5 offset:46080
    v_mfma_f32_16x16x32_bf16 v[148:151], v[240:243], a[116:119], v[148:151]
    ds_read_b64_tr_b16 v[226:227], v5 offset:47104
    v_mfma_f32_16x16x32_bf16 v[144:147], v[244:247], a[120:123], v[144:147]
    ds_read_b64_tr_b16 v[228:229], v5 offset:53248
    buffer_load_dwordx4 v[112:115], v23, s[20:23], s87 offen offset:2048 sc1
    v_mfma_f32_16x16x32_bf16 v[148:151], v[244:247], a[124:127], v[148:151]
    ds_read_b64_tr_b16 v[230:231], v5 offset:54272
    s_waitcnt lgkmcnt(8)
    v_mfma_f32_16x16x32_bf16 v[152:155], v[200:203], a[96:99], v[152:155]
    ds_read_b64_tr_b16 v[232:233], v4 offset:33792
    v_mfma_f32_16x16x32_bf16 v[156:159], v[200:203], a[100:103], v[156:159]
    ds_read_b64_tr_b16 v[234:235], v4 offset:34816
    v_mfma_f32_16x16x32_bf16 v[152:155], v[204:207], a[104:107], v[152:155]
    ds_read_b64_tr_b16 v[236:237], v4 offset:40960
    buffer_load_dwordx4 v[116:119], v24, s[20:23], s87 offen offset:2048 sc1
    v_mfma_f32_16x16x32_bf16 v[156:159], v[204:207], a[108:111], v[156:159]
    ds_read_b64_tr_b16 v[238:239], v4 offset:41984
    v_mfma_f32_16x16x32_bf16 v[152:155], v[208:211], a[112:115], v[152:155]
    ds_read_b64_tr_b16 v[240:241], v4 offset:48128
    v_mfma_f32_16x16x32_bf16 v[156:159], v[208:211], a[116:119], v[156:159]
    ds_read_b64_tr_b16 v[242:243], v4 offset:49152
    v_mfma_f32_16x16x32_bf16 v[152:155], v[212:215], a[120:123], v[152:155]
    ds_read_b64_tr_b16 v[244:245], v4 offset:55296
    buffer_load_dwordx4 v[120:123], v23, s[20:23], s87 offen offset:3072 sc1
    v_mfma_f32_16x16x32_bf16 v[156:159], v[212:215], a[124:127], v[156:159]
    ds_read_b64_tr_b16 v[246:247], v4 offset:56320
    s_waitcnt lgkmcnt(8)
    v_mfma_f32_16x16x32_bf16 v[160:163], v[216:219], a[96:99], v[160:163]
    ds_read_b64_tr_b16 v[200:201], v5 offset:33792
    v_mfma_f32_16x16x32_bf16 v[164:167], v[216:219], a[100:103], v[164:167]
    ds_read_b64_tr_b16 v[202:203], v5 offset:34816
    v_mfma_f32_16x16x32_bf16 v[160:163], v[220:223], a[104:107], v[160:163]
    ds_read_b64_tr_b16 v[204:205], v5 offset:40960
    buffer_load_dwordx4 v[124:127], v24, s[20:23], s87 offen offset:3072 sc1
    v_mfma_f32_16x16x32_bf16 v[164:167], v[220:223], a[108:111], v[164:167]
    ds_read_b64_tr_b16 v[206:207], v5 offset:41984
    v_mfma_f32_16x16x32_bf16 v[160:163], v[224:227], a[112:115], v[160:163]
    ds_read_b64_tr_b16 v[208:209], v5 offset:48128
    v_mfma_f32_16x16x32_bf16 v[164:167], v[224:227], a[116:119], v[164:167]
    ds_read_b64_tr_b16 v[210:211], v5 offset:49152
    v_mfma_f32_16x16x32_bf16 v[160:163], v[228:231], a[120:123], v[160:163]
    ds_read_b64_tr_b16 v[212:213], v5 offset:55296
    v_mfma_f32_16x16x32_bf16 v[164:167], v[228:231], a[124:127], v[164:167]
    ds_read_b64_tr_b16 v[214:215], v5 offset:56320
    s_waitcnt lgkmcnt(8)
    v_mfma_f32_16x16x32_bf16 v[168:171], v[232:235], a[96:99], v[168:171]
    s_waitcnt vmcnt(27)
    s_barrier
    v_mfma_f32_16x16x32_bf16 v[172:175], v[232:235], a[100:103], v[172:175]
    ds_read_b64_tr_b16 v[216:217], v16 offset:0
    ds_read_b64_tr_b16 v[218:219], v16 offset:512
    v_mfma_f32_16x16x32_bf16 v[168:171], v[236:239], a[104:107], v[168:171]
    ds_read_b64_tr_b16 v[220:221], v16 offset:7168
    s_add_u32 m0, s88, 12288
    v_mfma_f32_16x16x32_bf16 v[172:175], v[236:239], a[108:111], v[172:175]
    ds_read_b64_tr_b16 v[222:223], v16 offset:7680
    buffer_load_dwordx4 v23, s[20:23], s77 offen offset:0 sc1 lds
    v_mfma_f32_16x16x32_bf16 v[168:171], v[240:243], a[112:115], v[168:171]
    ds_read_b64_tr_b16 v[224:225], v16 offset:14336
    v_mfma_f32_16x16x32_bf16 v[172:175], v[240:243], a[116:119], v[172:175]
    ds_read_b64_tr_b16 v[226:227], v16 offset:14848
    v_mfma_f32_16x16x32_bf16 v[168:171], v[244:247], a[120:123], v[168:171]
    ds_read_b64_tr_b16 v[228:229], v16 offset:21504
    v_mfma_f32_16x16x32_bf16 v[172:175], v[244:247], a[124:127], v[172:175]
    ds_read_b64_tr_b16 v[230:231], v16 offset:22016
    s_waitcnt lgkmcnt(8)
    v_mfma_f32_16x16x32_bf16 v[176:179], v[200:203], a[96:99], v[176:179]
    ds_read_b64_tr_b16 v[232:233], v6 offset:1024
    buffer_load_dwordx4 v23, s[20:23], s77 offen offset:1024 sc1 lds
    v_mfma_f32_16x16x32_bf16 v[180:183], v[200:203], a[100:103], v[180:183]
    ds_read_b64_tr_b16 v[234:235], v6 offset:2048
    v_mfma_f32_16x16x32_bf16 v[176:179], v[204:207], a[104:107], v[176:179]
    ds_read_b64_tr_b16 v[236:237], v6 offset:8192
    v_mfma_f32_16x16x32_bf16 v[180:183], v[204:207], a[108:111], v[180:183]
    ds_read_b64_tr_b16 v[238:239], v6 offset:9216
    v_mfma_f32_16x16x32_bf16 v[176:179], v[208:211], a[112:115], v[176:179]
    ds_read_b64_tr_b16 v[240:241], v6 offset:15360
    v_mfma_f32_16x16x32_bf16 v[180:183], v[208:211], a[116:119], v[180:183]
    ds_read_b64_tr_b16 v[242:243], v6 offset:16384
    buffer_load_dwordx4 v23, s[20:23], s77 offen offset:2048 sc1 lds
    v_mfma_f32_16x16x32_bf16 v[176:179], v[212:215], a[120:123], v[176:179]
    ds_read_b64_tr_b16 v[244:245], v6 offset:22528
    v_mfma_f32_16x16x32_bf16 v[180:183], v[212:215], a[124:127], v[180:183]
    ds_read_b64_tr_b16 v[246:247], v6 offset:23552
    s_waitcnt lgkmcnt(8)
    v_mfma_f32_16x16x32_bf16 v[128:131], v[216:219], a[128:131], v[128:131]
    ds_read_b64_tr_b16 v[200:201], v7 offset:1024
    v_mfma_f32_16x16x32_bf16 v[132:135], v[216:219], a[132:135], v[132:135]
    ds_read_b64_tr_b16 v[202:203], v7 offset:2048
    v_mfma_f32_16x16x32_bf16 v[128:131], v[220:223], a[136:139], v[128:131]
    ds_read_b64_tr_b16 v[204:205], v7 offset:8192
    buffer_load_dwordx4 v23, s[20:23], s77 offen offset:3072 sc1 lds
    v_mfma_f32_16x16x32_bf16 v[132:135], v[220:223], a[140:143], v[132:135]
    ds_read_b64_tr_b16 v[206:207], v7 offset:9216
    v_mfma_f32_16x16x32_bf16 v[128:131], v[224:227], a[144:147], v[128:131]
    ds_read_b64_tr_b16 v[208:209], v7 offset:15360
    v_mfma_f32_16x16x32_bf16 v[132:135], v[224:227], a[148:151], v[132:135]
    ds_read_b64_tr_b16 v[210:211], v7 offset:16384
    v_mfma_f32_16x16x32_bf16 v[128:131], v[228:231], a[152:155], v[128:131]
    ds_read_b64_tr_b16 v[212:213], v7 offset:22528
    v_mfma_f32_16x16x32_bf16 v[132:135], v[228:231], a[156:159], v[132:135]
    ds_read_b64_tr_b16 v[214:215], v7 offset:23552
    s_waitcnt lgkmcnt(8)
    v_mfma_f32_16x16x32_bf16 v[136:139], v[232:235], a[128:131], v[136:139]
    ds_read_b64_tr_b16 v[216:217], v6 offset:3072
    s_add_u32 m0, s88, 16384
    v_mfma_f32_16x16x32_bf16 v[140:143], v[232:235], a[132:135], v[140:143]
    ds_read_b64_tr_b16 v[218:219], v6 offset:4096
    buffer_load_dwordx4 v34, s[20:23], s77 offen offset:0 sc1 lds
    v_mfma_f32_16x16x32_bf16 v[136:139], v[236:239], a[136:139], v[136:139]
    ds_read_b64_tr_b16 v[220:221], v6 offset:10240
    v_mfma_f32_16x16x32_bf16 v[140:143], v[236:239], a[140:143], v[140:143]
    ds_read_b64_tr_b16 v[222:223], v6 offset:11264
    v_mfma_f32_16x16x32_bf16 v[136:139], v[240:243], a[144:147], v[136:139]
    ds_read_b64_tr_b16 v[224:225], v6 offset:17408
    v_mfma_f32_16x16x32_bf16 v[140:143], v[240:243], a[148:151], v[140:143]
    ds_read_b64_tr_b16 v[226:227], v6 offset:18432
    v_mfma_f32_16x16x32_bf16 v[136:139], v[244:247], a[152:155], v[136:139]
    ds_read_b64_tr_b16 v[228:229], v6 offset:24576
    buffer_load_dwordx4 v34, s[20:23], s77 offen offset:1024 sc1 lds
    v_mfma_f32_16x16x32_bf16 v[140:143], v[244:247], a[156:159], v[140:143]
    ds_read_b64_tr_b16 v[230:231], v6 offset:25600
    s_waitcnt lgkmcnt(8)
    v_mfma_f32_16x16x32_bf16 v[144:147], v[200:203], a[128:131], v[144:147]
    ds_read_b64_tr_b16 v[232:233], v7 offset:3072
    buffer_load_dwordx4 v[72:75], v17, s[24:27], s60 offen
    v_mfma_f32_16x16x32_bf16 v[148:151], v[200:203], a[132:135], v[148:151]
    ds_read_b64_tr_b16 v[234:235], v7 offset:4096
    v_mfma_f32_16x16x32_bf16 v[144:147], v[204:207], a[136:139], v[144:147]
    ds_read_b64_tr_b16 v[236:237], v7 offset:10240
    v_mfma_f32_16x16x32_bf16 v[148:151], v[204:207], a[140:143], v[148:151]
    ds_read_b64_tr_b16 v[238:239], v7 offset:11264
    buffer_load_dwordx4 v34, s[20:23], s77 offen offset:2048 sc1 lds
    v_mfma_f32_16x16x32_bf16 v[144:147], v[208:211], a[144:147], v[144:147]
    ds_read_b64_tr_b16 v[240:241], v7 offset:17408
    buffer_load_dwordx4 v[76:79], v17, s[24:27], s61 offen
    v_mfma_f32_16x16x32_bf16 v[148:151], v[208:211], a[148:151], v[148:151]
    ds_read_b64_tr_b16 v[242:243], v7 offset:18432
    v_mfma_f32_16x16x32_bf16 v[144:147], v[212:215], a[152:155], v[144:147]
    ds_read_b64_tr_b16 v[244:245], v7 offset:24576
    v_mfma_f32_16x16x32_bf16 v[148:151], v[212:215], a[156:159], v[148:151]
    ds_read_b64_tr_b16 v[246:247], v7 offset:25600
    s_waitcnt lgkmcnt(8)
    v_mfma_f32_16x16x32_bf16 v[152:155], v[216:219], a[128:131], v[152:155]
    ds_read_b64_tr_b16 v[200:201], v6 offset:5120
    buffer_load_dwordx4 v[88:91], v20, s[24:27], s62 offen
    v_mfma_f32_16x16x32_bf16 v[156:159], v[216:219], a[132:135], v[156:159]
    ds_read_b64_tr_b16 v[202:203], v6 offset:6144
    v_mfma_f32_16x16x32_bf16 v[152:155], v[220:223], a[136:139], v[152:155]
    ds_read_b64_tr_b16 v[204:205], v6 offset:12288
    v_mfma_f32_16x16x32_bf16 v[156:159], v[220:223], a[140:143], v[156:159]
    ds_read_b64_tr_b16 v[206:207], v6 offset:13312
    v_mfma_f32_16x16x32_bf16 v[152:155], v[224:227], a[144:147], v[152:155]
    ds_read_b64_tr_b16 v[208:209], v6 offset:19456
    v_mfma_f32_16x16x32_bf16 v[156:159], v[224:227], a[148:151], v[156:159]
    ds_read_b64_tr_b16 v[210:211], v6 offset:20480
    v_mfma_f32_16x16x32_bf16 v[152:155], v[228:231], a[152:155], v[152:155]
    ds_read_b64_tr_b16 v[212:213], v6 offset:26624
    v_mfma_f32_16x16x32_bf16 v[156:159], v[228:231], a[156:159], v[156:159]
    ds_read_b64_tr_b16 v[214:215], v6 offset:27648
    s_waitcnt lgkmcnt(8)
    v_mfma_f32_16x16x32_bf16 v[160:163], v[232:235], a[128:131], v[160:163]
    ds_read_b64_tr_b16 v[216:217], v7 offset:5120
    v_mfma_f32_16x16x32_bf16 v[164:167], v[232:235], a[132:135], v[164:167]
    ds_read_b64_tr_b16 v[218:219], v7 offset:6144
    v_mfma_f32_16x16x32_bf16 v[160:163], v[236:239], a[136:139], v[160:163]
    ds_read_b64_tr_b16 v[220:221], v7 offset:12288
    v_mfma_f32_16x16x32_bf16 v[164:167], v[236:239], a[140:143], v[164:167]
    ds_read_b64_tr_b16 v[222:223], v7 offset:13312
    v_mfma_f32_16x16x32_bf16 v[160:163], v[240:243], a[144:147], v[160:163]
    ds_read_b64_tr_b16 v[224:225], v7 offset:19456
    v_mfma_f32_16x16x32_bf16 v[164:167], v[240:243], a[148:151], v[164:167]
    ds_read_b64_tr_b16 v[226:227], v7 offset:20480
    v_mfma_f32_16x16x32_bf16 v[160:163], v[244:247], a[152:155], v[160:163]
    ds_read_b64_tr_b16 v[228:229], v7 offset:26624
    v_mfma_f32_16x16x32_bf16 v[164:167], v[244:247], a[156:159], v[164:167]
    ds_read_b64_tr_b16 v[230:231], v7 offset:27648
    s_waitcnt lgkmcnt(8)
    v_mfma_f32_16x16x32_bf16 v[168:171], v[200:203], a[128:131], v[168:171]
    s_waitcnt vmcnt(26)
    s_barrier
    v_mfma_f32_16x16x32_bf16 v[172:175], v[200:203], a[132:135], v[172:175]
    ds_read_b64_tr_b16 v[232:233], v8 offset:28672
    ds_read_b64_tr_b16 v[234:235], v8 offset:29184
    v_mfma_f32_16x16x32_bf16 v[168:171], v[204:207], a[136:139], v[168:171]
    ds_read_b64_tr_b16 v[236:237], v8 offset:35840
    s_add_u32 m0, s88, 98304
    v_mfma_f32_16x16x32_bf16 v[172:175], v[204:207], a[140:143], v[172:175]
    ds_read_b64_tr_b16 v[238:239], v8 offset:36352
    buffer_load_dwordx4 v23, s[20:23], s78 offen offset:0 sc1 lds
    v_mfma_f32_16x16x32_bf16 v[168:171], v[208:211], a[144:147], v[168:171]
    ds_read_b64_tr_b16 v[240:241], v8 offset:43008
    v_mfma_f32_16x16x32_bf16 v[172:175], v[208:211], a[148:151], v[172:175]
    ds_read_b64_tr_b16 v[242:243], v8 offset:43520
    v_mfma_f32_16x16x32_bf16 v[168:171], v[212:215], a[152:155], v[168:171]
    ds_read_b64_tr_b16 v[244:245], v8 offset:50176
    v_mfma_f32_16x16x32_bf16 v[172:175], v[212:215], a[156:159], v[172:175]
    ds_read_b64_tr_b16 v[246:247], v8 offset:50688
    s_waitcnt lgkmcnt(8)
    v_mfma_f32_16x16x32_bf16 v[176:179], v[216:219], a[128:131], v[176:179]
    ds_read_b64_tr_b16 v[200:201], v2 offset:29696
    buffer_load_dwordx4 v23, s[20:23], s78 offen offset:1024 sc1 lds
    v_mfma_f32_16x16x32_bf16 v[180:183], v[216:219], a[132:135], v[180:183]
    ds_read_b64_tr_b16 v[202:203], v2 offset:30720
    v_mfma_f32_16x16x32_bf16 v[176:179], v[220:223], a[136:139], v[176:179]
    ds_read_b64_tr_b16 v[204:205], v2 offset:36864
    v_mfma_f32_16x16x32_bf16 v[180:183], v[220:223], a[140:143], v[180:183]
    ds_read_b64_tr_b16 v[206:207], v2 offset:37888
    v_mfma_f32_16x16x32_bf16 v[176:179], v[224:227], a[144:147], v[176:179]
    ds_read_b64_tr_b16 v[208:209], v2 offset:44032
    v_mfma_f32_16x16x32_bf16 v[180:183], v[224:227], a[148:151], v[180:183]
    ds_read_b64_tr_b16 v[210:211], v2 offset:45056
    buffer_load_dwordx4 v23, s[20:23], s78 offen offset:2048 sc1 lds
    v_mfma_f32_16x16x32_bf16 v[176:179], v[228:231], a[152:155], v[176:179]
    ds_read_b64_tr_b16 v[212:213], v2 offset:51200
    v_mfma_f32_16x16x32_bf16 v[180:183], v[228:231], a[156:159], v[180:183]
    ds_read_b64_tr_b16 v[214:215], v2 offset:52224
    s_waitcnt lgkmcnt(8)
    v_mfma_f32_16x16x32_bf16 v[128:131], v[232:235], a[160:163], v[128:131]
    ds_read_b64_tr_b16 v[216:217], v3 offset:29696
    v_mfma_f32_16x16x32_bf16 v[132:135], v[232:235], a[164:167], v[132:135]
    ds_read_b64_tr_b16 v[218:219], v3 offset:30720
    v_mfma_f32_16x16x32_bf16 v[128:131], v[236:239], a[168:171], v[128:131]
    ds_read_b64_tr_b16 v[220:221], v3 offset:36864
    buffer_load_dwordx4 v23, s[20:23], s78 offen offset:3072 sc1 lds
    v_mfma_f32_16x16x32_bf16 v[132:135], v[236:239], a[172:175], v[132:135]
    ds_read_b64_tr_b16 v[222:223], v3 offset:37888
    v_mfma_f32_16x16x32_bf16 v[128:131], v[240:243], a[176:179], v[128:131]
    ds_read_b64_tr_b16 v[224:225], v3 offset:44032
    v_mfma_f32_16x16x32_bf16 v[132:135], v[240:243], a[180:183], v[132:135]
    ds_read_b64_tr_b16 v[226:227], v3 offset:45056
    v_mfma_f32_16x16x32_bf16 v[128:131], v[244:247], a[184:187], v[128:131]
    ds_read_b64_tr_b16 v[228:229], v3 offset:51200
    v_mfma_f32_16x16x32_bf16 v[132:135], v[244:247], a[188:191], v[132:135]
    ds_read_b64_tr_b16 v[230:231], v3 offset:52224
    s_waitcnt lgkmcnt(8)
    v_mfma_f32_16x16x32_bf16 v[136:139], v[200:203], a[160:163], v[136:139]
    ds_read_b64_tr_b16 v[232:233], v2 offset:31744
    s_add_u32 m0, s88, 102400
    v_mfma_f32_16x16x32_bf16 v[140:143], v[200:203], a[164:167], v[140:143]
    ds_read_b64_tr_b16 v[234:235], v2 offset:32768
PG11:
    s_cbranch_execz PG12
    buffer_load_dwordx4 v34, s[20:23], s78 offen offset:0 sc1 lds
    v_mfma_f32_16x16x32_bf16 v[136:139], v[204:207], a[168:171], v[136:139]
    ds_read_b64_tr_b16 v[236:237], v2 offset:38912
    v_mfma_f32_16x16x32_bf16 v[140:143], v[204:207], a[172:175], v[140:143]
    ds_read_b64_tr_b16 v[238:239], v2 offset:39936
    v_mfma_f32_16x16x32_bf16 v[136:139], v[208:211], a[176:179], v[136:139]
    ds_read_b64_tr_b16 v[240:241], v2 offset:46080
    v_mfma_f32_16x16x32_bf16 v[140:143], v[208:211], a[180:183], v[140:143]
    ds_read_b64_tr_b16 v[242:243], v2 offset:47104
    v_mfma_f32_16x16x32_bf16 v[136:139], v[212:215], a[184:187], v[136:139]
    ds_read_b64_tr_b16 v[244:245], v2 offset:53248
    buffer_load_dwordx4 v34, s[20:23], s78 offen offset:1024 sc1 lds
    v_mfma_f32_16x16x32_bf16 v[140:143], v[212:215], a[188:191], v[140:143]
    ds_read_b64_tr_b16 v[246:247], v2 offset:54272
    s_waitcnt lgkmcnt(8)
    v_mfma_f32_16x16x32_bf16 v[144:147], v[216:219], a[160:163], v[144:147]
    ds_read_b64_tr_b16 v[200:201], v3 offset:31744
    v_mfma_f32_16x16x32_bf16 v[148:151], v[216:219], a[164:167], v[148:151]
    ds_read_b64_tr_b16 v[202:203], v3 offset:32768
    v_mfma_f32_16x16x32_bf16 v[144:147], v[220:223], a[168:171], v[144:147]
    ds_read_b64_tr_b16 v[204:205], v3 offset:38912
    v_mfma_f32_16x16x32_bf16 v[148:151], v[220:223], a[172:175], v[148:151]
    ds_read_b64_tr_b16 v[206:207], v3 offset:39936
    buffer_load_dwordx4 v34, s[20:23], s78 offen offset:2048 sc1 lds
    v_mfma_f32_16x16x32_bf16 v[144:147], v[224:227], a[176:179], v[144:147]
    ds_read_b64_tr_b16 v[208:209], v3 offset:46080
    v_mfma_f32_16x16x32_bf16 v[148:151], v[224:227], a[180:183], v[148:151]
    ds_read_b64_tr_b16 v[210:211], v3 offset:47104
    v_mfma_f32_16x16x32_bf16 v[144:147], v[228:231], a[184:187], v[144:147]
    ds_read_b64_tr_b16 v[212:213], v3 offset:53248
    v_mfma_f32_16x16x32_bf16 v[148:151], v[228:231], a[188:191], v[148:151]
    ds_read_b64_tr_b16 v[214:215], v3 offset:54272
    s_waitcnt lgkmcnt(8)
    v_mfma_f32_16x16x32_bf16 v[152:155], v[232:235], a[160:163], v[152:155]
    ds_read_b64_tr_b16 v[216:217], v2 offset:33792
    v_mfma_f32_16x16x32_bf16 v[156:159], v[232:235], a[164:167], v[156:159]
    ds_read_b64_tr_b16 v[218:219], v2 offset:34816
    v_mfma_f32_16x16x32_bf16 v[152:155], v[236:239], a[168:171], v[152:155]
    ds_read_b64_tr_b16 v[220:221], v2 offset:40960
    v_mfma_f32_16x16x32_bf16 v[156:159], v[236:239], a[172:175], v[156:159]
    ds_read_b64_tr_b16 v[222:223], v2 offset:41984
    v_mfma_f32_16x16x32_bf16 v[152:155], v[240:243], a[176:179], v[152:155]
    ds_read_b64_tr_b16 v[224:225], v2 offset:48128
    v_mfma_f32_16x16x32_bf16 v[156:159], v[240:243], a[180:183], v[156:159]
    ds_read_b64_tr_b16 v[226:227], v2 offset:49152
    v_mfma_f32_16x16x32_bf16 v[152:155], v[244:247], a[184:187], v[152:155]
    ds_read_b64_tr_b16 v[228:229], v2 offset:55296
    v_mfma_f32_16x16x32_bf16 v[156:159], v[244:247], a[188:191], v[156:159]
    ds_read_b64_tr_b16 v[230:231], v2 offset:56320
    s_waitcnt lgkmcnt(8)
    v_mfma_f32_16x16x32_bf16 v[160:163], v[200:203], a[160:163], v[160:163]
    ds_read_b64_tr_b16 v[232:233], v3 offset:33792
    v_mfma_f32_16x16x32_bf16 v[164:167], v[200:203], a[164:167], v[164:167]
    ds_read_b64_tr_b16 v[234:235], v3 offset:34816
    v_mfma_f32_16x16x32_bf16 v[160:163], v[204:207], a[168:171], v[160:163]
    ds_read_b64_tr_b16 v[236:237], v3 offset:40960
    v_mfma_f32_16x16x32_bf16 v[164:167], v[204:207], a[172:175], v[164:167]
    ds_read_b64_tr_b16 v[238:239], v3 offset:41984
    v_mfma_f32_16x16x32_bf16 v[160:163], v[208:211], a[176:179], v[160:163]
    ds_read_b64_tr_b16 v[240:241], v3 offset:48128
    v_mfma_f32_16x16x32_bf16 v[164:167], v[208:211], a[180:183], v[164:167]
    ds_read_b64_tr_b16 v[242:243], v3 offset:49152
    v_mfma_f32_16x16x32_bf16 v[160:163], v[212:215], a[184:187], v[160:163]
    ds_read_b64_tr_b16 v[244:245], v3 offset:55296
    v_mfma_f32_16x16x32_bf16 v[164:167], v[212:215], a[188:191], v[164:167]
    ds_read_b64_tr_b16 v[246:247], v3 offset:56320
    s_waitcnt lgkmcnt(8)
    v_mfma_f32_16x16x32_bf16 v[168:171], v[216:219], a[160:163], v[168:171]
    s_waitcnt vmcnt(21)
    s_barrier
    v_mfma_f32_16x16x32_bf16 v[172:175], v[216:219], a[164:167], v[172:175]
    ds_read_b64_tr_b16 v[200:201], v9 offset:0
    ds_read_b64_tr_b16 v[202:203], v9 offset:512
    v_mfma_f32_16x16x32_bf16 v[168:171], v[220:223], a[168:171], v[168:171]
    ds_read_b64_tr_b16 v[204:205], v9 offset:7168
    v_add_u32 v34, 3072, v34
    v_mfma_f32_16x16x32_bf16 v[172:175], v[220:223], a[172:175], v[172:175]
    ds_read_b64_tr_b16 v[206:207], v9 offset:7680
    s_add_u32 m0, s89, 126976
    v_mfma_f32_16x16x32_bf16 v[168:171], v[224:227], a[176:179], v[168:171]
    ds_read_b64_tr_b16 v[208:209], v9 offset:14336
    buffer_load_dwordx4 v34, s[20:23], s70 offen offset:0 sc1 lds
    v_mfma_f32_16x16x32_bf16 v[172:175], v[224:227], a[180:183], v[172:175]
    ds_read_b64_tr_b16 v[210:211], v9 offset:14848
    v_mfma_f32_16x16x32_bf16 v[168:171], v[228:231], a[184:187], v[168:171]
    ds_read_b64_tr_b16 v[212:213], v9 offset:21504
    v_mfma_f32_16x16x32_bf16 v[172:175], v[228:231], a[188:191], v[172:175]
    ds_read_b64_tr_b16 v[214:215], v9 offset:22016
    s_waitcnt lgkmcnt(8)
    v_mfma_f32_16x16x32_bf16 v[176:179], v[232:235], a[160:163], v[176:179]
    ds_read_b64_tr_b16 v[216:217], v4 offset:1024
    v_mfma_f32_16x16x32_bf16 v[180:183], v[232:235], a[164:167], v[180:183]
    ds_read_b64_tr_b16 v[218:219], v4 offset:2048
    buffer_load_dwordx4 v34, s[20:23], s70 offen offset:1024 sc1 lds
    v_mfma_f32_16x16x32_bf16 v[176:179], v[236:239], a[168:171], v[176:179]
    ds_read_b64_tr_b16 v[220:221], v4 offset:8192
    v_mfma_f32_16x16x32_bf16 v[180:183], v[236:239], a[172:175], v[180:183]
    ds_read_b64_tr_b16 v[222:223], v4 offset:9216
    v_mfma_f32_16x16x32_bf16 v[176:179], v[240:243], a[176:179], v[176:179]
    ds_read_b64_tr_b16 v[224:225], v4 offset:15360
    v_mfma_f32_16x16x32_bf16 v[180:183], v[240:243], a[180:183], v[180:183]
    ds_read_b64_tr_b16 v[226:227], v4 offset:16384
    v_mfma_f32_16x16x32_bf16 v[176:179], v[244:247], a[184:187], v[176:179]
    ds_read_b64_tr_b16 v[228:229], v4 offset:22528
    s_add_u32 m0, s89, 135168
    v_mfma_f32_16x16x32_bf16 v[180:183], v[244:247], a[188:191], v[180:183]
    ds_read_b64_tr_b16 v[230:231], v4 offset:23552
    s_waitcnt lgkmcnt(8)
    v_mfma_f32_16x16x32_bf16 v[128:131], v[200:203], a[192:195], v[128:131]
    ds_read_b64_tr_b16 v[232:233], v5 offset:1024
    buffer_load_dwordx4 v34, s[20:23], s71 offen offset:0 sc1 lds
    v_mfma_f32_16x16x32_bf16 v[132:135], v[200:203], a[196:199], v[132:135]
    ds_read_b64_tr_b16 v[234:235], v5 offset:2048
    v_mfma_f32_16x16x32_bf16 v[128:131], v[204:207], a[200:203], v[128:131]
    ds_read_b64_tr_b16 v[236:237], v5 offset:8192
    v_mfma_f32_16x16x32_bf16 v[132:135], v[204:207], a[204:207], v[132:135]
    ds_read_b64_tr_b16 v[238:239], v5 offset:9216
    v_mfma_f32_16x16x32_bf16 v[128:131], v[208:211], a[208:211], v[128:131]
    ds_read_b64_tr_b16 v[240:241], v5 offset:15360
    v_mfma_f32_16x16x32_bf16 v[132:135], v[208:211], a[212:215], v[132:135]
    ds_read_b64_tr_b16 v[242:243], v5 offset:16384
    buffer_load_dwordx4 v34, s[20:23], s71 offen offset:1024 sc1 lds
    v_mfma_f32_16x16x32_bf16 v[128:131], v[212:215], a[216:219], v[128:131]
    ds_read_b64_tr_b16 v[244:245], v5 offset:22528
    v_mfma_f32_16x16x32_bf16 v[132:135], v[212:215], a[220:223], v[132:135]
    ds_read_b64_tr_b16 v[246:247], v5 offset:23552
    s_waitcnt lgkmcnt(8)
    v_mfma_f32_16x16x32_bf16 v[136:139], v[216:219], a[192:195], v[136:139]
    ds_read_b64_tr_b16 v[200:201], v4 offset:3072
    v_mfma_f32_16x16x32_bf16 v[140:143], v[216:219], a[196:199], v[140:143]
    ds_read_b64_tr_b16 v[202:203], v4 offset:4096
    v_mfma_f32_16x16x32_bf16 v[136:139], v[220:223], a[200:203], v[136:139]
    ds_read_b64_tr_b16 v[204:205], v4 offset:10240
    s_add_u32 m0, s89, 143360
    v_mfma_f32_16x16x32_bf16 v[140:143], v[220:223], a[204:207], v[140:143]
    ds_read_b64_tr_b16 v[206:207], v4 offset:11264
    buffer_load_dwordx4 v34, s[20:23], s72 offen offset:0 sc1 lds
    v_mfma_f32_16x16x32_bf16 v[136:139], v[224:227], a[208:211], v[136:139]
    ds_read_b64_tr_b16 v[208:209], v4 offset:17408
    v_mfma_f32_16x16x32_bf16 v[140:143], v[224:227], a[212:215], v[140:143]
    ds_read_b64_tr_b16 v[210:211], v4 offset:18432
    v_mfma_f32_16x16x32_bf16 v[136:139], v[228:231], a[216:219], v[136:139]
    ds_read_b64_tr_b16 v[212:213], v4 offset:24576
    v_mfma_f32_16x16x32_bf16 v[140:143], v[228:231], a[220:223], v[140:143]
    ds_read_b64_tr_b16 v[214:215], v4 offset:25600
    s_waitcnt lgkmcnt(8)
    v_mfma_f32_16x16x32_bf16 v[144:147], v[232:235], a[192:195], v[144:147]
    ds_read_b64_tr_b16 v[216:217], v5 offset:3072
    buffer_load_dwordx4 v34, s[20:23], s72 offen offset:1024 sc1 lds
    v_mfma_f32_16x16x32_bf16 v[148:151], v[232:235], a[196:199], v[148:151]
    ds_read_b64_tr_b16 v[218:219], v5 offset:4096
    v_mfma_f32_16x16x32_bf16 v[144:147], v[236:239], a[200:203], v[144:147]
    ds_read_b64_tr_b16 v[220:221], v5 offset:10240
    v_mfma_f32_16x16x32_bf16 v[148:151], v[236:239], a[204:207], v[148:151]
    ds_read_b64_tr_b16 v[222:223], v5 offset:11264
    v_mfma_f32_16x16x32_bf16 v[144:147], v[240:243], a[208:211], v[144:147]
    ds_read_b64_tr_b16 v[224:225], v5 offset:17408
    v_mfma_f32_16x16x32_bf16 v[148:151], v[240:243], a[212:215], v[148:151]
    ds_read_b64_tr_b16 v[226:227], v5 offset:18432
    v_mfma_f32_16x16x32_bf16 v[144:147], v[244:247], a[216:219], v[144:147]
    ds_read_b64_tr_b16 v[228:229], v5 offset:24576
    v_mfma_f32_16x16x32_bf16 v[148:151], v[244:247], a[220:223], v[148:151]
    ds_read_b64_tr_b16 v[230:231], v5 offset:25600
    s_waitcnt lgkmcnt(8)
    v_mfma_f32_16x16x32_bf16 v[152:155], v[200:203], a[192:195], v[152:155]
    ds_read_b64_tr_b16 v[232:233], v4 offset:5120
    v_mfma_f32_16x16x32_bf16 v[156:159], v[200:203], a[196:199], v[156:159]
    ds_read_b64_tr_b16 v[234:235], v4 offset:6144
    v_mfma_f32_16x16x32_bf16 v[152:155], v[204:207], a[200:203], v[152:155]
    ds_read_b64_tr_b16 v[236:237], v4 offset:12288
    v_mfma_f32_16x16x32_bf16 v[156:159], v[204:207], a[204:207], v[156:159]
    ds_read_b64_tr_b16 v[238:239], v4 offset:13312
    v_mfma_f32_16x16x32_bf16 v[152:155], v[208:211], a[208:211], v[152:155]
    ds_read_b64_tr_b16 v[240:241], v4 offset:19456
    v_mfma_f32_16x16x32_bf16 v[156:159], v[208:211], a[212:215], v[156:159]
    ds_read_b64_tr_b16 v[242:243], v4 offset:20480
    v_mfma_f32_16x16x32_bf16 v[152:155], v[212:215], a[216:219], v[152:155]
    ds_read_b64_tr_b16 v[244:245], v4 offset:26624
    v_mfma_f32_16x16x32_bf16 v[156:159], v[212:215], a[220:223], v[156:159]
    ds_read_b64_tr_b16 v[246:247], v4 offset:27648
    s_waitcnt lgkmcnt(8)
    v_mfma_f32_16x16x32_bf16 v[160:163], v[216:219], a[192:195], v[160:163]
    ds_read_b64_tr_b16 v[200:201], v5 offset:5120
    v_mfma_f32_16x16x32_bf16 v[164:167], v[216:219], a[196:199], v[164:167]
    ds_read_b64_tr_b16 v[202:203], v5 offset:6144
    v_mfma_f32_16x16x32_bf16 v[160:163], v[220:223], a[200:203], v[160:163]
    ds_read_b64_tr_b16 v[204:205], v5 offset:12288
    v_mfma_f32_16x16x32_bf16 v[164:167], v[220:223], a[204:207], v[164:167]
    ds_read_b64_tr_b16 v[206:207], v5 offset:13312
    v_mfma_f32_16x16x32_bf16 v[160:163], v[224:227], a[208:211], v[160:163]
    ds_read_b64_tr_b16 v[208:209], v5 offset:19456
    v_mfma_f32_16x16x32_bf16 v[164:167], v[224:227], a[212:215], v[164:167]
    ds_read_b64_tr_b16 v[210:211], v5 offset:20480
    v_mfma_f32_16x16x32_bf16 v[160:163], v[228:231], a[216:219], v[160:163]
    ds_read_b64_tr_b16 v[212:213], v5 offset:26624
    v_mfma_f32_16x16x32_bf16 v[164:167], v[228:231], a[220:223], v[164:167]
    ds_read_b64_tr_b16 v[214:215], v5 offset:27648
    s_waitcnt lgkmcnt(8)
    v_mfma_f32_16x16x32_bf16 v[168:171], v[232:235], a[192:195], v[168:171]
    s_waitcnt vmcnt(15)
    s_barrier
    v_mfma_f32_16x16x32_bf16 v[172:175], v[232:235], a[196:199], v[172:175]
    ds_read_b64_tr_b16 v[216:217], v8 offset:0
    ds_read_b64_tr_b16 v[218:219], v8 offset:512
    v_mfma_f32_16x16x32_bf16 v[168:171], v[236:239], a[200:203], v[168:171]
    ds_read_b64_tr_b16 v[220:221], v8 offset:7168
    s_add_u32 m0, s89, 40960
    v_mfma_f32_16x16x32_bf16 v[172:175], v[236:239], a[204:207], v[172:175]
    ds_read_b64_tr_b16 v[222:223], v8 offset:7680
    buffer_load_dwordx4 v34, s[20:23], s73 offen offset:0 sc1 lds
    v_mfma_f32_16x16x32_bf16 v[168:171], v[240:243], a[208:211], v[168:171]
    ds_read_b64_tr_b16 v[224:225], v8 offset:14336
    v_mfma_f32_16x16x32_bf16 v[172:175], v[240:243], a[212:215], v[172:175]
    ds_read_b64_tr_b16 v[226:227], v8 offset:14848
    v_mfma_f32_16x16x32_bf16 v[168:171], v[244:247], a[216:219], v[168:171]
    ds_read_b64_tr_b16 v[228:229], v8 offset:21504
    v_mfma_f32_16x16x32_bf16 v[172:175], v[244:247], a[220:223], v[172:175]
    ds_read_b64_tr_b16 v[230:231], v8 offset:22016
    s_waitcnt lgkmcnt(8)
    v_mfma_f32_16x16x32_bf16 v[176:179], v[200:203], a[192:195], v[176:179]
    ds_read_b64_tr_b16 v[232:233], v2 offset:1024
    buffer_load_dwordx4 v34, s[20:23], s73 offen offset:1024 sc1 lds
    v_mfma_f32_16x16x32_bf16 v[180:183], v[200:203], a[196:199], v[180:183]
    ds_read_b64_tr_b16 v[234:235], v2 offset:2048
    v_mfma_f32_16x16x32_bf16 v[176:179], v[204:207], a[200:203], v[176:179]
    ds_read_b64_tr_b16 v[236:237], v2 offset:8192
    v_mfma_f32_16x16x32_bf16 v[180:183], v[204:207], a[204:207], v[180:183]
    ds_read_b64_tr_b16 v[238:239], v2 offset:9216
    v_mfma_f32_16x16x32_bf16 v[176:179], v[208:211], a[208:211], v[176:179]
    ds_read_b64_tr_b16 v[240:241], v2 offset:15360
    v_mfma_f32_16x16x32_bf16 v[180:183], v[208:211], a[212:215], v[180:183]
    ds_read_b64_tr_b16 v[242:243], v2 offset:16384
    s_add_u32 m0, s89, 49152
    v_mfma_f32_16x16x32_bf16 v[176:179], v[212:215], a[216:219], v[176:179]
    ds_read_b64_tr_b16 v[244:245], v2 offset:22528
    buffer_load_dwordx4 v34, s[20:23], s74 offen offset:0 sc1 lds
    v_mfma_f32_16x16x32_bf16 v[180:183], v[212:215], a[220:223], v[180:183]
    ds_read_b64_tr_b16 v[246:247], v2 offset:23552
    s_waitcnt lgkmcnt(8)
    v_mfma_f32_16x16x32_bf16 v[128:131], v[216:219], a[224:227], v[128:131]
    ds_read_b64_tr_b16 v[200:201], v3 offset:1024
    v_mfma_f32_16x16x32_bf16 v[132:135], v[216:219], a[228:231], v[132:135]
    ds_read_b64_tr_b16 v[202:203], v3 offset:2048
    v_mfma_f32_16x16x32_bf16 v[128:131], v[220:223], a[232:235], v[128:131]
    ds_read_b64_tr_b16 v[204:205], v3 offset:8192
    v_mfma_f32_16x16x32_bf16 v[132:135], v[220:223], a[236:239], v[132:135]
    ds_read_b64_tr_b16 v[206:207], v3 offset:9216
    buffer_load_dwordx4 v34, s[20:23], s74 offen offset:1024 sc1 lds
    v_mfma_f32_16x16x32_bf16 v[128:131], v[224:227], a[240:243], v[128:131]
    ds_read_b64_tr_b16 v[208:209], v3 offset:15360
    v_mfma_f32_16x16x32_bf16 v[132:135], v[224:227], a[244:247], v[132:135]
    ds_read_b64_tr_b16 v[210:211], v3 offset:16384
    v_mfma_f32_16x16x32_bf16 v[128:131], v[228:231], a[248:251], v[128:131]
    ds_read_b64_tr_b16 v[212:213], v3 offset:22528
    v_mfma_f32_16x16x32_bf16 v[132:135], v[228:231], a[252:255], v[132:135]
    ds_read_b64_tr_b16 v[214:215], v3 offset:23552
    s_waitcnt lgkmcnt(8)
    v_mfma_f32_16x16x32_bf16 v[136:139], v[232:235], a[224:227], v[136:139]
    ds_read_b64_tr_b16 v[216:217], v2 offset:3072
    s_add_u32 m0, s89, 57344
    v_mfma_f32_16x16x32_bf16 v[140:143], v[232:235], a[228:231], v[140:143]
    ds_read_b64_tr_b16 v[218:219], v2 offset:4096
    buffer_load_dwordx4 v34, s[20:23], s75 offen offset:0 sc1 lds
    v_mfma_f32_16x16x32_bf16 v[136:139], v[236:239], a[232:235], v[136:139]
    ds_read_b64_tr_b16 v[220:221], v2 offset:10240
    v_mfma_f32_16x16x32_bf16 v[140:143], v[236:239], a[236:239], v[140:143]
    ds_read_b64_tr_b16 v[222:223], v2 offset:11264
    v_mfma_f32_16x16x32_bf16 v[136:139], v[240:243], a[240:243], v[136:139]
    ds_read_b64_tr_b16 v[224:225], v2 offset:17408
    v_mfma_f32_16x16x32_bf16 v[140:143], v[240:243], a[244:247], v[140:143]
    ds_read_b64_tr_b16 v[226:227], v2 offset:18432
    v_mfma_f32_16x16x32_bf16 v[136:139], v[244:247], a[248:251], v[136:139]
    ds_read_b64_tr_b16 v[228:229], v2 offset:24576
    buffer_load_dwordx4 v34, s[20:23], s75 offen offset:1024 sc1 lds
    v_mfma_f32_16x16x32_bf16 v[140:143], v[244:247], a[252:255], v[140:143]
    ds_read_b64_tr_b16 v[230:231], v2 offset:25600
    s_waitcnt lgkmcnt(8)
    v_mfma_f32_16x16x32_bf16 v[144:147], v[200:203], a[224:227], v[144:147]
    ds_read_b64_tr_b16 v[232:233], v3 offset:3072
    v_mfma_f32_16x16x32_bf16 v[148:151], v[200:203], a[228:231], v[148:151]
    ds_read_b64_tr_b16 v[234:235], v3 offset:4096
    v_mfma_f32_16x16x32_bf16 v[144:147], v[204:207], a[232:235], v[144:147]
    ds_read_b64_tr_b16 v[236:237], v3 offset:10240
    v_mfma_f32_16x16x32_bf16 v[148:151], v[204:207], a[236:239], v[148:151]
    ds_read_b64_tr_b16 v[238:239], v3 offset:11264
    v_mfma_f32_16x16x32_bf16 v[144:147], v[208:211], a[240:243], v[144:147]
    ds_read_b64_tr_b16 v[240:241], v3 offset:17408
    v_mfma_f32_16x16x32_bf16 v[148:151], v[208:211], a[244:247], v[148:151]
    ds_read_b64_tr_b16 v[242:243], v3 offset:18432
    v_mfma_f32_16x16x32_bf16 v[144:147], v[212:215], a[248:251], v[144:147]
    ds_read_b64_tr_b16 v[244:245], v3 offset:24576
    v_mfma_f32_16x16x32_bf16 v[148:151], v[212:215], a[252:255], v[148:151]
    ds_read_b64_tr_b16 v[246:247], v3 offset:25600
    s_waitcnt lgkmcnt(8)
    v_mfma_f32_16x16x32_bf16 v[152:155], v[216:219], a[224:227], v[152:155]
    ds_read_b64_tr_b16 v[200:201], v2 offset:5120
    v_mfma_f32_16x16x32_bf16 v[156:159], v[216:219], a[228:231], v[156:159]
    ds_read_b64_tr_b16 v[202:203], v2 offset:6144
    v_swap_b32 v98, v100
    v_mfma_f32_16x16x32_bf16 v[152:155], v[220:223], a[232:235], v[152:155]
    ds_read_b64_tr_b16 v[204:205], v2 offset:12288
    v_swap_b32 v99, v101
    v_mfma_f32_16x16x32_bf16 v[156:159], v[220:223], a[236:239], v[156:159]
    ds_read_b64_tr_b16 v[206:207], v2 offset:13312
    v_swap_b32 v106, v108
    v_mfma_f32_16x16x32_bf16 v[152:155], v[224:227], a[240:243], v[152:155]
    ds_read_b64_tr_b16 v[208:209], v2 offset:19456
    v_swap_b32 v107, v109
    v_mfma_f32_16x16x32_bf16 v[156:159], v[224:227], a[244:247], v[156:159]
    ds_read_b64_tr_b16 v[210:211], v2 offset:20480
    v_swap_b32 v114, v116
    v_mfma_f32_16x16x32_bf16 v[152:155], v[228:231], a[248:251], v[152:155]
    ds_read_b64_tr_b16 v[212:213], v2 offset:26624
    v_swap_b32 v115, v117
    v_mfma_f32_16x16x32_bf16 v[156:159], v[228:231], a[252:255], v[156:159]
    ds_read_b64_tr_b16 v[214:215], v2 offset:27648
    s_waitcnt lgkmcnt(8)
    v_mfma_f32_16x16x32_bf16 v[160:163], v[232:235], a[224:227], v[160:163]
    ds_read_b64_tr_b16 v[216:217], v3 offset:5120
    v_swap_b32 v122, v124
    v_mfma_f32_16x16x32_bf16 v[164:167], v[232:235], a[228:231], v[164:167]
    ds_read_b64_tr_b16 v[218:219], v3 offset:6144
    v_swap_b32 v123, v125
    v_mfma_f32_16x16x32_bf16 v[160:163], v[236:239], a[232:235], v[160:163]
    ds_read_b64_tr_b16 v[220:221], v3 offset:12288
    v_mfma_f32_16x16x32_bf16 v[164:167], v[236:239], a[236:239], v[164:167]
    ds_read_b64_tr_b16 v[222:223], v3 offset:13312
    v_mfma_f32_16x16x32_bf16 v[160:163], v[240:243], a[240:243], v[160:163]
    ds_read_b64_tr_b16 v[224:225], v3 offset:19456
    v_mfma_f32_16x16x32_bf16 v[164:167], v[240:243], a[244:247], v[164:167]
    ds_read_b64_tr_b16 v[226:227], v3 offset:20480
    v_mfma_f32_16x16x32_bf16 v[160:163], v[244:247], a[248:251], v[160:163]
    ds_read_b64_tr_b16 v[228:229], v3 offset:26624
    v_mfma_f32_16x16x32_bf16 v[164:167], v[244:247], a[252:255], v[164:167]
    ds_read_b64_tr_b16 v[230:231], v3 offset:27648
    s_waitcnt lgkmcnt(8)
    v_mfma_f32_16x16x32_bf16 v[168:171], v[200:203], a[224:227], v[168:171]
    s_waitcnt vmcnt(12)
    s_barrier
    v_mfma_f32_16x16x32_bf16 v[172:175], v[200:203], a[228:231], v[172:175]
    ds_read_b64_tr_b16 v[232:233], v9 offset:28672
    ds_read_b64_tr_b16 v[234:235], v9 offset:29184
    v_mfma_f32_16x16x32_bf16 v[168:171], v[204:207], a[232:235], v[168:171]
    ds_read_b64_tr_b16 v[236:237], v9 offset:35840
    s_add_u32 m0, s89, 69632
    v_mfma_f32_16x16x32_bf16 v[172:175], v[204:207], a[236:239], v[172:175]
    ds_read_b64_tr_b16 v[238:239], v9 offset:36352
    buffer_load_dwordx4 v34, s[20:23], s76 offen offset:0 sc1 lds
    v_mfma_f32_16x16x32_bf16 v[168:171], v[208:211], a[240:243], v[168:171]
    ds_read_b64_tr_b16 v[240:241], v9 offset:43008
    v_mfma_f32_16x16x32_bf16 v[172:175], v[208:211], a[244:247], v[172:175]
    ds_read_b64_tr_b16 v[242:243], v9 offset:43520
    v_mfma_f32_16x16x32_bf16 v[168:171], v[212:215], a[248:251], v[168:171]
    ds_read_b64_tr_b16 v[244:245], v9 offset:50176
    v_mfma_f32_16x16x32_bf16 v[172:175], v[212:215], a[252:255], v[172:175]
    ds_read_b64_tr_b16 v[246:247], v9 offset:50688
    s_waitcnt lgkmcnt(8)
    v_mfma_f32_16x16x32_bf16 v[176:179], v[216:219], a[224:227], v[176:179]
    ds_read_b64_tr_b16 v[200:201], v4 offset:29696
    buffer_load_dwordx4 v34, s[20:23], s76 offen offset:1024 sc1 lds
    v_mfma_f32_16x16x32_bf16 v[180:183], v[216:219], a[228:231], v[180:183]
    ds_read_b64_tr_b16 v[202:203], v4 offset:30720
    v_mfma_f32_16x16x32_bf16 v[176:179], v[220:223], a[232:235], v[176:179]
    ds_read_b64_tr_b16 v[204:205], v4 offset:36864
    v_mfma_f32_16x16x32_bf16 v[180:183], v[220:223], a[236:239], v[180:183]
    ds_read_b64_tr_b16 v[206:207], v4 offset:37888
    v_mfma_f32_16x16x32_bf16 v[176:179], v[224:227], a[240:243], v[176:179]
    ds_read_b64_tr_b16 v[208:209], v4 offset:44032
    v_mfma_f32_16x16x32_bf16 v[180:183], v[224:227], a[244:247], v[180:183]
    ds_read_b64_tr_b16 v[210:211], v4 offset:45056
    s_add_u32 m0, s89, 77824
    v_mfma_f32_16x16x32_bf16 v[176:179], v[228:231], a[248:251], v[176:179]
    ds_read_b64_tr_b16 v[212:213], v4 offset:51200
    buffer_load_dwordx4 v34, s[20:23], s77 offen offset:0 sc1 lds
    v_mfma_f32_16x16x32_bf16 v[180:183], v[228:231], a[252:255], v[180:183]
    ds_read_b64_tr_b16 v[214:215], v4 offset:52224
    s_waitcnt lgkmcnt(8)
    v_mfma_f32_16x16x32_bf16 v[128:131], v[232:235], v[96:99], v[128:131]
    ds_read_b64_tr_b16 v[216:217], v5 offset:29696
    v_mfma_f32_16x16x32_bf16 v[132:135], v[232:235], v[100:103], v[132:135]
    ds_read_b64_tr_b16 v[218:219], v5 offset:30720
    v_mfma_f32_16x16x32_bf16 v[128:131], v[236:239], v[104:107], v[128:131]
    ds_read_b64_tr_b16 v[220:221], v5 offset:36864
    v_mfma_f32_16x16x32_bf16 v[132:135], v[236:239], v[108:111], v[132:135]
    ds_read_b64_tr_b16 v[222:223], v5 offset:37888
    buffer_load_dwordx4 v34, s[20:23], s77 offen offset:1024 sc1 lds
    v_mfma_f32_16x16x32_bf16 v[128:131], v[240:243], v[112:115], v[128:131]
    ds_read_b64_tr_b16 v[224:225], v5 offset:44032
    v_mfma_f32_16x16x32_bf16 v[132:135], v[240:243], v[116:119], v[132:135]
    ds_read_b64_tr_b16 v[226:227], v5 offset:45056
    v_mfma_f32_16x16x32_bf16 v[128:131], v[244:247], v[120:123], v[128:131]
    ds_read_b64_tr_b16 v[228:229], v5 offset:51200
    v_mfma_f32_16x16x32_bf16 v[132:135], v[244:247], v[124:127], v[132:135]
    ds_read_b64_tr_b16 v[230:231], v5 offset:52224
    s_waitcnt lgkmcnt(8)
    v_mfma_f32_16x16x32_bf16 v[136:139], v[200:203], v[96:99], v[136:139]
    ds_read_b64_tr_b16 v[232:233], v4 offset:31744
    s_add_u32 m0, s89, 86016
    v_mfma_f32_16x16x32_bf16 v[140:143], v[200:203], v[100:103], v[140:143]
    ds_read_b64_tr_b16 v[234:235], v4 offset:32768
    buffer_load_dwordx4 v34, s[20:23], s78 offen offset:0 sc1 lds
    v_mfma_f32_16x16x32_bf16 v[136:139], v[204:207], v[104:107], v[136:139]
    ds_read_b64_tr_b16 v[236:237], v4 offset:38912
    v_mfma_f32_16x16x32_bf16 v[140:143], v[204:207], v[108:111], v[140:143]
    ds_read_b64_tr_b16 v[238:239], v4 offset:39936
    v_cvt_pk_bf16_f32 v40, v128, v129
    v_mfma_f32_16x16x32_bf16 v[136:139], v[208:211], v[112:115], v[136:139]
    ds_read_b64_tr_b16 v[240:241], v4 offset:46080
    v_cvt_pk_bf16_f32 v41, v130, v131
    v_mfma_f32_16x16x32_bf16 v[140:143], v[208:211], v[116:119], v[140:143]
    ds_read_b64_tr_b16 v[242:243], v4 offset:47104
    v_cvt_pk_bf16_f32 v42, v132, v133
    v_mfma_f32_16x16x32_bf16 v[136:139], v[212:215], v[120:123], v[136:139]
    ds_read_b64_tr_b16 v[244:245], v4 offset:53248
    buffer_load_dwordx4 v34, s[20:23], s78 offen offset:1024 sc1 lds
    v_mfma_f32_16x16x32_bf16 v[140:143], v[212:215], v[124:127], v[140:143]
    ds_read_b64_tr_b16 v[246:247], v4 offset:54272
    s_waitcnt lgkmcnt(8)
    v_mfma_f32_16x16x32_bf16 v[144:147], v[216:219], v[96:99], v[144:147]
    ds_read_b64_tr_b16 v[200:201], v5 offset:31744
    v_cvt_pk_bf16_f32 v43, v134, v135
    v_mfma_f32_16x16x32_bf16 v[148:151], v[216:219], v[100:103], v[148:151]
    ds_read_b64_tr_b16 v[202:203], v5 offset:32768
    buffer_store_dwordx4 v[40:43], v23, s[20:23], s15 offen offset:0 sc1
    v_mfma_f32_16x16x32_bf16 v[144:147], v[220:223], v[104:107], v[144:147]
    ds_read_b64_tr_b16 v[204:205], v5 offset:38912
    v_mfma_f32_16x16x32_bf16 v[148:151], v[220:223], v[108:111], v[148:151]
    ds_read_b64_tr_b16 v[206:207], v5 offset:39936
    v_cvt_pk_bf16_f32 v44, v136, v137
    v_mfma_f32_16x16x32_bf16 v[144:147], v[224:227], v[112:115], v[144:147]
    ds_read_b64_tr_b16 v[208:209], v5 offset:46080
    v_cvt_pk_bf16_f32 v45, v138, v139
    v_mfma_f32_16x16x32_bf16 v[148:151], v[224:227], v[116:119], v[148:151]
    ds_read_b64_tr_b16 v[210:211], v5 offset:47104
    v_cvt_pk_bf16_f32 v48, v140, v141
    v_mfma_f32_16x16x32_bf16 v[144:147], v[228:231], v[120:123], v[144:147]
    ds_read_b64_tr_b16 v[212:213], v5 offset:53248
    v_cvt_pk_bf16_f32 v49, v142, v143
    v_mfma_f32_16x16x32_bf16 v[148:151], v[228:231], v[124:127], v[148:151]
    ds_read_b64_tr_b16 v[214:215], v5 offset:54272
    s_waitcnt lgkmcnt(8)
    v_mfma_f32_16x16x32_bf16 v[152:155], v[232:235], v[96:99], v[152:155]
    ds_read_b64_tr_b16 v[216:217], v4 offset:33792
    v_mfma_f32_16x16x32_bf16 v[156:159], v[232:235], v[100:103], v[156:159]
    ds_read_b64_tr_b16 v[218:219], v4 offset:34816
    v_mfma_f32_16x16x32_bf16 v[152:155], v[236:239], v[104:107], v[152:155]
    ds_read_b64_tr_b16 v[220:221], v4 offset:40960
    v_mfma_f32_16x16x32_bf16 v[156:159], v[236:239], v[108:111], v[156:159]
    ds_read_b64_tr_b16 v[222:223], v4 offset:41984
    v_cvt_pk_bf16_f32 v46, v144, v145
    v_mfma_f32_16x16x32_bf16 v[152:155], v[240:243], v[112:115], v[152:155]
    ds_read_b64_tr_b16 v[224:225], v4 offset:48128
    v_cvt_pk_bf16_f32 v47, v146, v147
    v_mfma_f32_16x16x32_bf16 v[156:159], v[240:243], v[116:119], v[156:159]
    ds_read_b64_tr_b16 v[226:227], v4 offset:49152
    buffer_store_dwordx4 v[44:47], v23, s[20:23], s12 offen offset:0 sc1
    v_mfma_f32_16x16x32_bf16 v[152:155], v[244:247], v[120:123], v[152:155]
    ds_read_b64_tr_b16 v[228:229], v4 offset:55296
    v_cvt_pk_bf16_f32 v50, v148, v149
    v_mfma_f32_16x16x32_bf16 v[156:159], v[244:247], v[124:127], v[156:159]
    ds_read_b64_tr_b16 v[230:231], v4 offset:56320
    s_waitcnt lgkmcnt(8)
    v_mfma_f32_16x16x32_bf16 v[160:163], v[200:203], v[96:99], v[160:163]
    ds_read_b64_tr_b16 v[232:233], v5 offset:33792
    buffer_load_dword v36, v39, s[20:23], 0 offen offset:0 sc1
    v_mfma_f32_16x16x32_bf16 v[164:167], v[200:203], v[100:103], v[164:167]
    ds_read_b64_tr_b16 v[234:235], v5 offset:34816
    v_cvt_pk_bf16_f32 v51, v150, v151
    v_mfma_f32_16x16x32_bf16 v[160:163], v[204:207], v[104:107], v[160:163]
    ds_read_b64_tr_b16 v[236:237], v5 offset:40960
    buffer_store_dwordx4 v[48:51], v23, s[20:23], s12 offen offset:1024 sc1
    v_mfma_f32_16x16x32_bf16 v[164:167], v[204:207], v[108:111], v[164:167]
    ds_read_b64_tr_b16 v[238:239], v5 offset:41984
    v_cvt_pk_bf16_f32 v52, v152, v153
    v_mfma_f32_16x16x32_bf16 v[160:163], v[208:211], v[112:115], v[160:163]
    ds_read_b64_tr_b16 v[240:241], v5 offset:48128
    v_cvt_pk_bf16_f32 v53, v154, v155
    v_mfma_f32_16x16x32_bf16 v[164:167], v[208:211], v[116:119], v[164:167]
    ds_read_b64_tr_b16 v[242:243], v5 offset:49152
    v_cvt_pk_bf16_f32 v56, v156, v157
    v_mfma_f32_16x16x32_bf16 v[160:163], v[212:215], v[120:123], v[160:163]
    ds_read_b64_tr_b16 v[244:245], v5 offset:55296
    v_cvt_pk_bf16_f32 v57, v158, v159
    v_mfma_f32_16x16x32_bf16 v[164:167], v[212:215], v[124:127], v[164:167]
    ds_read_b64_tr_b16 v[246:247], v5 offset:56320
    s_waitcnt lgkmcnt(8)
    v_mfma_f32_16x16x32_bf16 v[168:171], v[216:219], v[96:99], v[168:171]
    s_waitcnt vmcnt(16)
    s_barrier
    v_mfma_f32_16x16x32_bf16 v[172:175], v[216:219], v[100:103], v[172:175]
    ds_read_b64_tr_b16 v[200:201], v6 offset:0
    ds_read_b64_tr_b16 v[202:203], v6 offset:1024
    v_mfma_f32_16x16x32_bf16 v[168:171], v[220:223], v[104:107], v[168:171]
    ds_read_b64_tr_b16 v[204:205], v6 offset:2048
    v_mfma_f32_16x16x32_bf16 v[172:175], v[220:223], v[108:111], v[172:175]
    ds_read_b64_tr_b16 v[206:207], v6 offset:3072
    v_cvt_pk_bf16_f32 v54, v160, v161
    v_mfma_f32_16x16x32_bf16 v[168:171], v[224:227], v[112:115], v[168:171]
    ds_read_b64_tr_b16 v[208:209], v6 offset:4096
    v_cvt_pk_bf16_f32 v55, v162, v163
    v_mfma_f32_16x16x32_bf16 v[172:175], v[224:227], v[116:119], v[172:175]
    ds_read_b64_tr_b16 v[210:211], v6 offset:5120
    buffer_store_dwordx4 v[52:55], v23, s[20:23], s13 offen offset:0 sc1
    v_mfma_f32_16x16x32_bf16 v[168:171], v[228:231], v[120:123], v[168:171]
    ds_read_b64_tr_b16 v[212:213], v6 offset:6144
    v_cvt_pk_bf16_f32 v58, v164, v165
    v_mfma_f32_16x16x32_bf16 v[172:175], v[228:231], v[124:127], v[172:175]
    ds_read_b64_tr_b16 v[214:215], v6 offset:7168
    s_waitcnt lgkmcnt(8)
    v_mfma_f32_16x16x32_bf16 v[176:179], v[232:235], v[96:99], v[176:179]
    ds_read_b64_tr_b16 v[216:217], v7 offset:0
    v_cvt_pk_bf16_f32 v59, v166, v167
    v_mfma_f32_16x16x32_bf16 v[180:183], v[232:235], v[100:103], v[180:183]
    ds_read_b64_tr_b16 v[218:219], v7 offset:1024
    buffer_store_dwordx4 v[56:59], v23, s[20:23], s13 offen offset:1024 sc1
    v_mfma_f32_16x16x32_bf16 v[176:179], v[236:239], v[104:107], v[176:179]
    ds_read_b64_tr_b16 v[220:221], v7 offset:2048
    v_mfma_f32_16x16x32_bf16 v[180:183], v[236:239], v[108:111], v[180:183]
    ds_read_b64_tr_b16 v[222:223], v7 offset:3072
    v_cvt_pk_bf16_f32 v60, v168, v169
    v_mfma_f32_16x16x32_bf16 v[176:179], v[240:243], v[112:115], v[176:179]
    ds_read_b64_tr_b16 v[224:225], v7 offset:4096
    v_cvt_pk_bf16_f32 v61, v170, v171
    v_mfma_f32_16x16x32_bf16 v[180:183], v[240:243], v[116:119], v[180:183]
    ds_read_b64_tr_b16 v[226:227], v7 offset:5120
    v_cvt_pk_bf16_f32 v64, v172, v173
    v_mfma_f32_16x16x32_bf16 v[176:179], v[244:247], v[120:123], v[176:179]
    ds_read_b64_tr_b16 v[228:229], v7 offset:6144
    v_cvt_pk_bf16_f32 v65, v174, v175
    v_mfma_f32_16x16x32_bf16 v[180:183], v[244:247], v[124:127], v[180:183]
    ds_read_b64_tr_b16 v[230:231], v7 offset:7168
    v_mfma_f32_16x16x32_bf16 v[184:187], v[248:251], v[72:75], 0
    v_mfma_f32_16x16x32_bf16 v[188:191], v[248:251], v[76:79], 0
PG12:
    s_cbranch_execz RT_C
    v_mfma_f32_16x16x32_bf16 v[192:195], v[252:255], v[72:75], 0
    v_mfma_f32_16x16x32_bf16 v[196:199], v[252:255], v[76:79], 0
    v_cvt_pk_bf16_f32 v62, v176, v177
    s_waitcnt lgkmcnt(8)
    v_mfma_f32_16x16x32_bf16 v[184:187], v[200:203], a[0:3], v[184:187]
    ds_read_b64_tr_b16 v[232:233], v6 offset:8192
    v_cvt_pk_bf16_f32 v63, v178, v179
    v_mfma_f32_16x16x32_bf16 v[188:191], v[200:203], a[4:7], v[188:191]
    ds_read_b64_tr_b16 v[234:235], v6 offset:9216
    buffer_store_dwordx4 v[60:63], v23, s[20:23], s14 offen offset:0 sc1
    v_mfma_f32_16x16x32_bf16 v[184:187], v[204:207], a[8:11], v[184:187]
    ds_read_b64_tr_b16 v[236:237], v6 offset:10240
    v_cvt_pk_bf16_f32 v66, v180, v181
    v_mfma_f32_16x16x32_bf16 v[188:191], v[204:207], a[12:15], v[188:191]
    ds_read_b64_tr_b16 v[238:239], v6 offset:11264
    v_cvt_pk_bf16_f32 v67, v182, v183
    v_mfma_f32_16x16x32_bf16 v[184:187], v[208:211], a[16:19], v[184:187]
    ds_read_b64_tr_b16 v[240:241], v6 offset:12288
    buffer_store_dwordx4 v[64:67], v23, s[20:23], s14 offen offset:1024 sc1
    v_mfma_f32_16x16x32_bf16 v[188:191], v[208:211], a[20:23], v[188:191]
    ds_read_b64_tr_b16 v[242:243], v6 offset:13312
    v_mfma_f32_16x16x32_bf16 v[184:187], v[212:215], a[24:27], v[184:187]
    ds_read_b64_tr_b16 v[244:245], v6 offset:14336
    v_mfma_f32_16x16x32_bf16 v[188:191], v[212:215], a[28:31], v[188:191]
    ds_read_b64_tr_b16 v[246:247], v6 offset:15360
    s_waitcnt lgkmcnt(8)
    v_mfma_f32_16x16x32_bf16 v[192:195], v[216:219], a[0:3], v[192:195]
    ds_read_b64_tr_b16 v[200:201], v7 offset:8192
    v_mfma_f32_16x16x32_bf16 v[196:199], v[216:219], a[4:7], v[196:199]
    ds_read_b64_tr_b16 v[202:203], v7 offset:9216
    v_mfma_f32_16x16x32_bf16 v[192:195], v[220:223], a[8:11], v[192:195]
    ds_read_b64_tr_b16 v[204:205], v7 offset:10240
    v_mfma_f32_16x16x32_bf16 v[196:199], v[220:223], a[12:15], v[196:199]
    ds_read_b64_tr_b16 v[206:207], v7 offset:11264
    v_mfma_f32_16x16x32_bf16 v[192:195], v[224:227], a[16:19], v[192:195]
    ds_read_b64_tr_b16 v[208:209], v7 offset:12288
    v_mfma_f32_16x16x32_bf16 v[196:199], v[224:227], a[20:23], v[196:199]
    ds_read_b64_tr_b16 v[210:211], v7 offset:13312
    v_mfma_f32_16x16x32_bf16 v[192:195], v[228:231], a[24:27], v[192:195]
    ds_read_b64_tr_b16 v[212:213], v7 offset:14336
    v_mfma_f32_16x16x32_bf16 v[196:199], v[228:231], a[28:31], v[196:199]
    ds_read_b64_tr_b16 v[214:215], v7 offset:15360
    s_waitcnt lgkmcnt(8)
    v_mfma_f32_16x16x32_bf16 v[184:187], v[232:235], a[32:35], v[184:187]
    ds_read_b64_tr_b16 v[216:217], v6 offset:16384
    v_mfma_f32_16x16x32_bf16 v[188:191], v[232:235], a[36:39], v[188:191]
    ds_read_b64_tr_b16 v[218:219], v6 offset:17408
    v_mfma_f32_16x16x32_bf16 v[184:187], v[236:239], a[40:43], v[184:187]
    ds_read_b64_tr_b16 v[220:221], v6 offset:18432
    v_mfma_f32_16x16x32_bf16 v[188:191], v[236:239], a[44:47], v[188:191]
    ds_read_b64_tr_b16 v[222:223], v6 offset:19456
    v_mfma_f32_16x16x32_bf16 v[184:187], v[240:243], a[48:51], v[184:187]
    ds_read_b64_tr_b16 v[224:225], v6 offset:20480
    v_mfma_f32_16x16x32_bf16 v[188:191], v[240:243], a[52:55], v[188:191]
    ds_read_b64_tr_b16 v[226:227], v6 offset:21504
    v_mfma_f32_16x16x32_bf16 v[184:187], v[244:247], a[56:59], v[184:187]
    ds_read_b64_tr_b16 v[228:229], v6 offset:22528
    v_mfma_f32_16x16x32_bf16 v[188:191], v[244:247], a[60:63], v[188:191]
    ds_read_b64_tr_b16 v[230:231], v6 offset:23552
    s_waitcnt lgkmcnt(8)
    v_mfma_f32_16x16x32_bf16 v[192:195], v[200:203], a[32:35], v[192:195]
    ds_read_b64_tr_b16 v[232:233], v7 offset:16384
    v_mfma_f32_16x16x32_bf16 v[196:199], v[200:203], a[36:39], v[196:199]
    ds_read_b64_tr_b16 v[234:235], v7 offset:17408
    v_mfma_f32_16x16x32_bf16 v[192:195], v[204:207], a[40:43], v[192:195]
    ds_read_b64_tr_b16 v[236:237], v7 offset:18432
    v_mfma_f32_16x16x32_bf16 v[196:199], v[204:207], a[44:47], v[196:199]
    ds_read_b64_tr_b16 v[238:239], v7 offset:19456
    v_mfma_f32_16x16x32_bf16 v[192:195], v[208:211], a[48:51], v[192:195]
    ds_read_b64_tr_b16 v[240:241], v7 offset:20480
    v_mfma_f32_16x16x32_bf16 v[196:199], v[208:211], a[52:55], v[196:199]
    ds_read_b64_tr_b16 v[242:243], v7 offset:21504
    v_mfma_f32_16x16x32_bf16 v[192:195], v[212:215], a[56:59], v[192:195]
    ds_read_b64_tr_b16 v[244:245], v7 offset:22528
    v_mfma_f32_16x16x32_bf16 v[196:199], v[212:215], a[60:63], v[196:199]
    ds_read_b64_tr_b16 v[246:247], v7 offset:23552
    s_waitcnt lgkmcnt(8)
    v_mfma_f32_16x16x32_bf16 v[184:187], v[216:219], a[64:67], v[184:187]
    s_waitcnt vmcnt(14)
    s_barrier
    v_mfma_f32_16x16x32_bf16 v[188:191], v[216:219], a[68:71], v[188:191]
    ds_read_b64_tr_b16 v[200:201], v2 offset:28672
    ds_read_b64_tr_b16 v[202:203], v2 offset:29696
    v_mfma_f32_16x16x32_bf16 v[184:187], v[220:223], a[72:75], v[184:187]
    ds_read_b64_tr_b16 v[204:205], v2 offset:30720
    v_mfma_f32_16x16x32_bf16 v[188:191], v[220:223], a[76:79], v[188:191]
    ds_read_b64_tr_b16 v[206:207], v2 offset:31744
    v_mfma_f32_16x16x32_bf16 v[184:187], v[224:227], a[80:83], v[184:187]
    ds_read_b64_tr_b16 v[208:209], v2 offset:32768
    v_mfma_f32_16x16x32_bf16 v[188:191], v[224:227], a[84:87], v[188:191]
    ds_read_b64_tr_b16 v[210:211], v2 offset:33792
    v_mfma_f32_16x16x32_bf16 v[184:187], v[228:231], a[88:91], v[184:187]
    ds_read_b64_tr_b16 v[212:213], v2 offset:34816
    v_mfma_f32_16x16x32_bf16 v[188:191], v[228:231], a[92:95], v[188:191]
    ds_read_b64_tr_b16 v[214:215], v2 offset:35840
    s_waitcnt lgkmcnt(8)
    v_mfma_f32_16x16x32_bf16 v[192:195], v[232:235], a[64:67], v[192:195]
    ds_read_b64_tr_b16 v[216:217], v3 offset:28672
    s_waitcnt vmcnt(5)
    v_mfma_f32_16x16x32_bf16 v[196:199], v[232:235], a[68:71], v[196:199]
    ds_read_b64_tr_b16 v[218:219], v3 offset:29696
    v_cmp_ne_u32 vcc, s59, v36
    v_mfma_f32_16x16x32_bf16 v[192:195], v[236:239], a[72:75], v[192:195]
    ds_read_b64_tr_b16 v[220:221], v3 offset:30720
    s_cbranch_vccnz SLOW_fin
RET_fin:
    v_mfma_f32_16x16x32_bf16 v[196:199], v[236:239], a[76:79], v[196:199]
    ds_read_b64_tr_b16 v[222:223], v3 offset:31744
    buffer_load_dwordx4 v[80:83], v22, s[20:23], s63 offen sc1
    v_mfma_f32_16x16x32_bf16 v[192:195], v[240:243], a[80:83], v[192:195]
    ds_read_b64_tr_b16 v[224:225], v3 offset:32768
    buffer_load_dwordx4 v[84:87], v22, s[20:23], s64 offen sc1
    v_mfma_f32_16x16x32_bf16 v[196:199], v[240:243], a[84:87], v[196:199]
    ds_read_b64_tr_b16 v[226:227], v3 offset:33792
    buffer_load_dwordx4 v[92:95], v22, s[20:23], s65 offen sc1
    v_mfma_f32_16x16x32_bf16 v[192:195], v[244:247], a[88:91], v[192:195]
    ds_read_b64_tr_b16 v[228:229], v3 offset:34816
    v_mfma_f32_16x16x32_bf16 v[196:199], v[244:247], a[92:95], v[196:199]
    ds_read_b64_tr_b16 v[230:231], v3 offset:35840
    s_waitcnt lgkmcnt(8)
    v_mfma_f32_16x16x32_bf16 v[184:187], v[200:203], a[96:99], v[184:187]
    ds_read_b64_tr_b16 v[232:233], v2 offset:36864
    v_mfma_f32_16x16x32_bf16 v[188:191], v[200:203], a[100:103], v[188:191]
    ds_read_b64_tr_b16 v[234:235], v2 offset:37888
    v_mfma_f32_16x16x32_bf16 v[184:187], v[204:207], a[104:107], v[184:187]
    ds_read_b64_tr_b16 v[236:237], v2 offset:38912
    v_mfma_f32_16x16x32_bf16 v[188:191], v[204:207], a[108:111], v[188:191]
    ds_read_b64_tr_b16 v[238:239], v2 offset:39936
    v_mfma_f32_16x16x32_bf16 v[184:187], v[208:211], a[112:115], v[184:187]
    ds_read_b64_tr_b16 v[240:241], v2 offset:40960
    v_mfma_f32_16x16x32_bf16 v[188:191], v[208:211], a[116:119], v[188:191]
    ds_read_b64_tr_b16 v[242:243], v2 offset:41984
    v_mfma_f32_16x16x32_bf16 v[184:187], v[212:215], a[120:123], v[184:187]
    ds_read_b64_tr_b16 v[244:245], v2 offset:43008
    v_mfma_f32_16x16x32_bf16 v[188:191], v[212:215], a[124:127], v[188:191]
    ds_read_b64_tr_b16 v[246:247], v2 offset:44032
    s_waitcnt lgkmcnt(8)
    v_mfma_f32_16x16x32_bf16 v[192:195], v[216:219], a[96:99], v[192:195]
    ds_read_b64_tr_b16 v[200:201], v3 offset:36864
    v_mfma_f32_16x16x32_bf16 v[196:199], v[216:219], a[100:103], v[196:199]
    ds_read_b64_tr_b16 v[202:203], v3 offset:37888
    v_mfma_f32_16x16x32_bf16 v[192:195], v[220:223], a[104:107], v[192:195]
    ds_read_b64_tr_b16 v[204:205], v3 offset:38912
    v_mfma_f32_16x16x32_bf16 v[196:199], v[220:223], a[108:111], v[196:199]
    ds_read_b64_tr_b16 v[206:207], v3 offset:39936
    v_mfma_f32_16x16x32_bf16 v[192:195], v[224:227], a[112:115], v[192:195]
    ds_read_b64_tr_b16 v[208:209], v3 offset:40960
    v_mfma_f32_16x16x32_bf16 v[196:199], v[224:227], a[116:119], v[196:199]
    ds_read_b64_tr_b16 v[210:211], v3 offset:41984
    v_mfma_f32_16x16x32_bf16 v[192:195], v[228:231], a[120:123], v[192:195]
    ds_read_b64_tr_b16 v[212:213], v3 offset:43008
    v_mfma_f32_16x16x32_bf16 v[196:199], v[228:231], a[124:127], v[196:199]
    ds_read_b64_tr_b16 v[214:215], v3 offset:44032
    s_waitcnt lgkmcnt(8)
    v_mfma_f32_16x16x32_bf16 v[184:187], v[232:235], a[128:131], v[184:187]
    ds_read_b64_tr_b16 v[216:217], v2 offset:45056
    v_mfma_f32_16x16x32_bf16 v[188:191], v[232:235], a[132:135], v[188:191]
    ds_read_b64_tr_b16 v[218:219], v2 offset:46080
    v_mfma_f32_16x16x32_bf16 v[184:187], v[236:239], a[136:139], v[184:187]
    ds_read_b64_tr_b16 v[220:221], v2 offset:47104
    v_mfma_f32_16x16x32_bf16 v[188:191], v[236:239], a[140:143], v[188:191]
    ds_read_b64_tr_b16 v[222:223], v2 offset:48128
    v_mfma_f32_16x16x32_bf16 v[184:187], v[240:243], a[144:147], v[184:187]
    ds_read_b64_tr_b16 v[224:225], v2 offset:49152
    v_mfma_f32_16x16x32_bf16 v[188:191], v[240:243], a[148:151], v[188:191]
    ds_read_b64_tr_b16 v[226:227], v2 offset:50176
    v_mfma_f32_16x16x32_bf16 v[184:187], v[244:247], a[152:155], v[184:187]
    ds_read_b64_tr_b16 v[228:229], v2 offset:51200
    v_mfma_f32_16x16x32_bf16 v[188:191], v[244:247], a[156:159], v[188:191]
    ds_read_b64_tr_b16 v[230:231], v2 offset:52224
    s_waitcnt lgkmcnt(8)
    v_mfma_f32_16x16x32_bf16 v[192:195], v[200:203], a[128:131], v[192:195]
    ds_read_b64_tr_b16 v[232:233], v3 offset:45056
    v_mfma_f32_16x16x32_bf16 v[196:199], v[200:203], a[132:135], v[196:199]
    ds_read_b64_tr_b16 v[234:235], v3 offset:46080
    v_mfma_f32_16x16x32_bf16 v[192:195], v[204:207], a[136:139], v[192:195]
    ds_read_b64_tr_b16 v[236:237], v3 offset:47104
    v_mfma_f32_16x16x32_bf16 v[196:199], v[204:207], a[140:143], v[196:199]
    ds_read_b64_tr_b16 v[238:239], v3 offset:48128
    v_mfma_f32_16x16x32_bf16 v[192:195], v[208:211], a[144:147], v[192:195]
    ds_read_b64_tr_b16 v[240:241], v3 offset:49152
    v_mfma_f32_16x16x32_bf16 v[196:199], v[208:211], a[148:151], v[196:199]
    ds_read_b64_tr_b16 v[242:243], v3 offset:50176
    v_mfma_f32_16x16x32_bf16 v[192:195], v[212:215], a[152:155], v[192:195]
    ds_read_b64_tr_b16 v[244:245], v3 offset:51200
    v_mfma_f32_16x16x32_bf16 v[196:199], v[212:215], a[156:159], v[196:199]
    ds_read_b64_tr_b16 v[246:247], v3 offset:52224
    s_waitcnt lgkmcnt(8)
    v_mfma_f32_16x16x32_bf16 v[184:187], v[216:219], a[160:163], v[184:187]
    s_barrier
    v_mfma_f32_16x16x32_bf16 v[188:191], v[216:219], a[164:167], v[188:191]
    ds_read_b64_tr_b16 v[200:201], v4 offset:0
    ds_read_b64_tr_b16 v[202:203], v4 offset:1024
    v_mfma_f32_16x16x32_bf16 v[184:187], v[220:223], a[168:171], v[184:187]
    ds_read_b64_tr_b16 v[204:205], v4 offset:2048
    buffer_load_dwordx4 v[136:139], v23, s[20:23], s95 offen offset:0 sc1
    v_mfma_f32_16x16x32_bf16 v[188:191], v[220:223], a[172:175], v[188:191]
    ds_read_b64_tr_b16 v[206:207], v4 offset:3072
    buffer_load_dwordx4 v[140:143], v23, s[20:23], s95 offen offset:1024 sc1
    v_mfma_f32_16x16x32_bf16 v[184:187], v[224:227], a[176:179], v[184:187]
    ds_read_b64_tr_b16 v[208:209], v4 offset:4096
    buffer_load_dwordx4 v[144:147], v23, s[20:23], s95 offen offset:2048 sc1
    v_mfma_f32_16x16x32_bf16 v[188:191], v[224:227], a[180:183], v[188:191]
    ds_read_b64_tr_b16 v[210:211], v4 offset:5120
    buffer_load_dwordx4 v[148:151], v23, s[20:23], s95 offen offset:3072 sc1
    v_mfma_f32_16x16x32_bf16 v[184:187], v[228:231], a[184:187], v[184:187]
    ds_read_b64_tr_b16 v[212:213], v4 offset:6144
    buffer_load_dwordx4 v[152:155], v23, s[20:23], s66 offen offset:0 sc1
    v_mfma_f32_16x16x32_bf16 v[188:191], v[228:231], a[188:191], v[188:191]
    ds_read_b64_tr_b16 v[214:215], v4 offset:7168
    s_waitcnt lgkmcnt(8)
    v_mfma_f32_16x16x32_bf16 v[192:195], v[232:235], a[160:163], v[192:195]
    ds_read_b64_tr_b16 v[216:217], v5 offset:0
    buffer_load_dwordx4 v[156:159], v23, s[20:23], s66 offen offset:1024 sc1
    v_mfma_f32_16x16x32_bf16 v[196:199], v[232:235], a[164:167], v[196:199]
    ds_read_b64_tr_b16 v[218:219], v5 offset:1024
    buffer_load_dwordx4 v[160:163], v23, s[20:23], s67 offen sc1
    v_mfma_f32_16x16x32_bf16 v[192:195], v[236:239], a[168:171], v[192:195]
    ds_read_b64_tr_b16 v[220:221], v5 offset:2048
    buffer_load_dwordx4 v[164:167], v23, s[20:23], s68 offen sc1
    v_mfma_f32_16x16x32_bf16 v[196:199], v[236:239], a[172:175], v[196:199]
    ds_read_b64_tr_b16 v[222:223], v5 offset:3072
    buffer_load_dwordx4 v[168:171], v23, s[20:23], s69 offen sc1
    v_mfma_f32_16x16x32_bf16 v[192:195], v[240:243], a[176:179], v[192:195]
    ds_read_b64_tr_b16 v[224:225], v5 offset:4096
    v_mfma_f32_16x16x32_bf16 v[196:199], v[240:243], a[180:183], v[196:199]
    ds_read_b64_tr_b16 v[226:227], v5 offset:5120
    v_mfma_f32_16x16x32_bf16 v[192:195], v[244:247], a[184:187], v[192:195]
    ds_read_b64_tr_b16 v[228:229], v5 offset:6144
    v_mfma_f32_16x16x32_bf16 v[196:199], v[244:247], a[188:191], v[196:199]
    ds_read_b64_tr_b16 v[230:231], v5 offset:7168
    s_waitcnt lgkmcnt(8)
    v_mfma_f32_16x16x32_bf16 v[184:187], v[200:203], a[192:195], v[184:187]
    ds_read_b64_tr_b16 v[232:233], v4 offset:8192
    v_mfma_f32_16x16x32_bf16 v[188:191], v[200:203], a[196:199], v[188:191]
    ds_read_b64_tr_b16 v[234:235], v4 offset:9216
    v_mfma_f32_16x16x32_bf16 v[184:187], v[204:207], a[200:203], v[184:187]
    ds_read_b64_tr_b16 v[236:237], v4 offset:10240
    v_mfma_f32_16x16x32_bf16 v[188:191], v[204:207], a[204:207], v[188:191]
    ds_read_b64_tr_b16 v[238:239], v4 offset:11264
    v_mfma_f32_16x16x32_bf16 v[184:187], v[208:211], a[208:211], v[184:187]
    ds_read_b64_tr_b16 v[240:241], v4 offset:12288
    v_mfma_f32_16x16x32_bf16 v[188:191], v[208:211], a[212:215], v[188:191]
    ds_read_b64_tr_b16 v[242:243], v4 offset:13312
    v_mfma_f32_16x16x32_bf16 v[184:187], v[212:215], a[216:219], v[184:187]
    ds_read_b64_tr_b16 v[244:245], v4 offset:14336
    v_mfma_f32_16x16x32_bf16 v[188:191], v[212:215], a[220:223], v[188:191]
    ds_read_b64_tr_b16 v[246:247], v4 offset:15360
    s_waitcnt lgkmcnt(8)
    v_mfma_f32_16x16x32_bf16 v[192:195], v[216:219], a[192:195], v[192:195]
    ds_read_b64_tr_b16 v[200:201], v5 offset:8192
    v_mfma_f32_16x16x32_bf16 v[196:199], v[216:219], a[196:199], v[196:199]
    ds_read_b64_tr_b16 v[202:203], v5 offset:9216
    v_mfma_f32_16x16x32_bf16 v[192:195], v[220:223], a[200:203], v[192:195]
    ds_read_b64_tr_b16 v[204:205], v5 offset:10240
    v_mfma_f32_16x16x32_bf16 v[196:199], v[220:223], a[204:207], v[196:199]
    ds_read_b64_tr_b16 v[206:207], v5 offset:11264
    v_mfma_f32_16x16x32_bf16 v[192:195], v[224:227], a[208:211], v[192:195]
    ds_read_b64_tr_b16 v[208:209], v5 offset:12288
    v_mfma_f32_16x16x32_bf16 v[196:199], v[224:227], a[212:215], v[196:199]
    ds_read_b64_tr_b16 v[210:211], v5 offset:13312
    v_mfma_f32_16x16x32_bf16 v[192:195], v[228:231], a[216:219], v[192:195]
    ds_read_b64_tr_b16 v[212:213], v5 offset:14336
    v_mfma_f32_16x16x32_bf16 v[196:199], v[228:231], a[220:223], v[196:199]
    ds_read_b64_tr_b16 v[214:215], v5 offset:15360
    s_waitcnt lgkmcnt(8)
    v_mfma_f32_16x16x32_bf16 v[184:187], v[232:235], a[224:227], v[184:187]
    ds_read_b64_tr_b16 v[216:217], v4 offset:16384
    v_mfma_f32_16x16x32_bf16 v[188:191], v[232:235], a[228:231], v[188:191]
    ds_read_b64_tr_b16 v[218:219], v4 offset:17408
    v_mfma_f32_16x16x32_bf16 v[184:187], v[236:239], a[232:235], v[184:187]
    ds_read_b64_tr_b16 v[220:221], v4 offset:18432
    v_mfma_f32_16x16x32_bf16 v[188:191], v[236:239], a[236:239], v[188:191]
    ds_read_b64_tr_b16 v[222:223], v4 offset:19456
    v_mfma_f32_16x16x32_bf16 v[184:187], v[240:243], a[240:243], v[184:187]
    ds_read_b64_tr_b16 v[224:225], v4 offset:20480
    v_mfma_f32_16x16x32_bf16 v[188:191], v[240:243], a[244:247], v[188:191]
    ds_read_b64_tr_b16 v[226:227], v4 offset:21504
    v_mfma_f32_16x16x32_bf16 v[184:187], v[244:247], a[248:251], v[184:187]
    ds_read_b64_tr_b16 v[228:229], v4 offset:22528
    v_mfma_f32_16x16x32_bf16 v[188:191], v[244:247], a[252:255], v[188:191]
    ds_read_b64_tr_b16 v[230:231], v4 offset:23552
    s_waitcnt lgkmcnt(8)
    v_mfma_f32_16x16x32_bf16 v[192:195], v[200:203], a[224:227], v[192:195]
    ds_read_b64_tr_b16 v[232:233], v5 offset:16384
    v_mfma_f32_16x16x32_bf16 v[196:199], v[200:203], a[228:231], v[196:199]
    ds_read_b64_tr_b16 v[234:235], v5 offset:17408
    v_mfma_f32_16x16x32_bf16 v[192:195], v[204:207], a[232:235], v[192:195]
    ds_read_b64_tr_b16 v[236:237], v5 offset:18432
    v_mfma_f32_16x16x32_bf16 v[196:199], v[204:207], a[236:239], v[196:199]
    ds_read_b64_tr_b16 v[238:239], v5 offset:19456
    v_mfma_f32_16x16x32_bf16 v[192:195], v[208:211], a[240:243], v[192:195]
    ds_read_b64_tr_b16 v[240:241], v5 offset:20480
    v_mfma_f32_16x16x32_bf16 v[196:199], v[208:211], a[244:247], v[196:199]
    ds_read_b64_tr_b16 v[242:243], v5 offset:21504
    v_mfma_f32_16x16x32_bf16 v[192:195], v[212:215], a[248:251], v[192:195]
    ds_read_b64_tr_b16 v[244:245], v5 offset:22528
    v_mfma_f32_16x16x32_bf16 v[196:199], v[212:215], a[252:255], v[196:199]
    ds_read_b64_tr_b16 v[246:247], v5 offset:23552
    s_waitcnt lgkmcnt(8)
    v_mfma_f32_16x16x32_bf16 v[184:187], v[216:219], v[96:99], v[184:187]
    v_mfma_f32_16x16x32_bf16 v[188:191], v[216:219], v[100:103], v[188:191]
    v_mfma_f32_16x16x32_bf16 v[184:187], v[220:223], v[104:107], v[184:187]
    v_mfma_f32_16x16x32_bf16 v[188:191], v[220:223], v[108:111], v[188:191]
    v_mfma_f32_16x16x32_bf16 v[184:187], v[224:227], v[112:115], v[184:187]
    v_mfma_f32_16x16x32_bf16 v[188:191], v[224:227], v[116:119], v[188:191]
    v_mfma_f32_16x16x32_bf16 v[184:187], v[228:231], v[120:123], v[184:187]
    v_mfma_f32_16x16x32_bf16 v[188:191], v[228:231], v[124:127], v[188:191]
    s_waitcnt lgkmcnt(0)
    v_mfma_f32_16x16x32_bf16 v[192:195], v[232:235], v[96:99], v[192:195]
    v_mfma_f32_16x16x32_bf16 v[196:199], v[232:235], v[100:103], v[196:199]
    v_mfma_f32_16x16x32_bf16 v[192:195], v[236:239], v[104:107], v[192:195]
    v_mfma_f32_16x16x32_bf16 v[196:199], v[236:239], v[108:111], v[196:199]
    v_mfma_f32_16x16x32_bf16 v[192:195], v[240:243], v[112:115], v[192:195]
    v_mfma_f32_16x16x32_bf16 v[196:199], v[240:243], v[116:119], v[196:199]
    v_mfma_f32_16x16x32_bf16 v[192:195], v[244:247], v[120:123], v[192:195]
    v_mfma_f32_16x16x32_bf16 v[196:199], v[244:247], v[124:127], v[196:199]
    s_waitcnt vmcnt(0)
    v_max3_u32 v36, v136, v137, v138
    v_max3_u32 v36, v36, v139, v140
    v_max3_u32 v36, v36, v141, v142
    v_max3_u32 v36, v36, v143, v144
    v_max3_u32 v36, v36, v145, v146
    v_max3_u32 v36, v36, v147, v148
    v_max3_u32 v36, v36, v149, v150
    v_max3_u32 v36, v36, v151, v152
    v_max3_u32 v36, v36, v153, v154
    v_max3_u32 v36, v36, v155, v156
    v_max3_u32 v36, v36, v157, v158
    v_max3_u32 v36, v36, v159, v160
    v_max3_u32 v36, v36, v161, v162
    v_max3_u32 v36, v36, v163, v164
    v_max3_u32 v36, v36, v165, v166
    v_max3_u32 v36, v36, v167, v168
    v_max3_u32 v36, v36, v169, v170
    v_max_u32 v36, v36, v171
    v_cmp_eq_u32 vcc, -1, v36
    s_cbranch_vccnz SLOW_in
RET_in:
    v_mfma_f32_16x16x32_bf16 v[184:187], v[80:83], v[248:251], v[184:187]
    v_mfma_f32_16x16x32_bf16 v[192:195], v[84:87], v[248:251], v[192:195]
    v_mfma_f32_16x16x32_bf16 v[184:187], v[12:15], v[136:139], v[184:187]
    v_mfma_f32_16x16x32_bf16 v[192:195], v[10:13], v[136:139], v[192:195]
    v_mfma_f32_16x16x32_bf16 v[184:187], v[12:15], v[144:147], v[184:187]
    v_mfma_f32_16x16x32_bf16 v[192:195], v[10:13], v[144:147], v[192:195]
    v_mfma_f32_16x16x32_bf16 v[184:187], v[12:15], v[152:155], v[184:187]
    v_mfma_f32_16x16x32_bf16 v[192:195], v[10:13], v[152:155], v[192:195]
    v_mfma_f32_16x16x32_bf16 v[188:191], v[80:83], v[252:255], v[188:191]
    v_mfma_f32_16x16x32_bf16 v[196:199], v[84:87], v[252:255], v[196:199]
    v_mfma_f32_16x16x32_bf16 v[188:191], v[12:15], v[140:143], v[188:191]
    v_mfma_f32_16x16x32_bf16 v[196:199], v[10:13], v[140:143], v[196:199]
    v_mfma_f32_16x16x32_bf16 v[188:191], v[12:15], v[148:151], v[188:191]
    v_mfma_f32_16x16x32_bf16 v[196:199], v[10:13], v[148:151], v[196:199]
    v_mfma_f32_16x16x32_bf16 v[188:191], v[12:15], v[156:159], v[188:191]
    v_mfma_f32_16x16x32_bf16 v[196:199], v[10:13], v[156:159], v[196:199]
    s_cmp_eq_u32 s3, s35
    s_nop 0
    v_cvt_pk_bf16_f32 v200, v184, v185
    v_cvt_pk_bf16_f32 v201, v186, v187
    v_cvt_pk_bf16_f32 v202, v192, v193
    v_cvt_pk_bf16_f32 v203, v194, v195
    s_nop 0
    v_permlane16_swap_b32 v200, v202
    v_permlane16_swap_b32 v201, v203
    buffer_store_dwordx4 v[200:203], v18, s[28:31], s60 offen
    v_cvt_pk_bf16_f32 v204, v188, v189
    v_cvt_pk_bf16_f32 v205, v190, v191
    v_cvt_pk_bf16_f32 v206, v196, v197
    v_cvt_pk_bf16_f32 v207, v198, v199
    s_nop 0
    v_permlane16_swap_b32 v204, v206
    v_permlane16_swap_b32 v205, v207
    buffer_store_dwordx4 v[204:207], v18, s[28:31], s61 offen
    s_cbranch_scc0 NO8
    v_mfma_f32_16x16x32_bf16 v[128:131], v[248:251], v[88:91], v[128:131]
    v_mfma_f32_16x16x32_bf16 v[128:131], v[92:95], v[248:251], v[128:131]
    v_mfma_f32_16x16x32_bf16 v[132:135], v[252:255], v[88:91], v[132:135]
    v_mfma_f32_16x16x32_bf16 v[132:135], v[92:95], v[252:255], v[132:135]
    v_mfma_f32_16x16x32_bf16 v[128:131], v[12:15], v[160:163], v[128:131]
    v_mfma_f32_16x16x32_bf16 v[132:135], v[10:13], v[160:163], v[132:135]
    v_mfma_f32_16x16x32_bf16 v[128:131], v[12:15], v[164:167], v[128:131]
    v_mfma_f32_16x16x32_bf16 v[132:135], v[10:13], v[164:167], v[132:135]
    v_mfma_f32_16x16x32_bf16 v[128:131], v[12:15], v[168:171], v[128:131]
    v_mfma_f32_16x16x32_bf16 v[132:135], v[10:13], v[168:171], v[132:135]
    s_nop 7
    v_cvt_pk_bf16_f32 v208, v128, v129
    v_cvt_pk_bf16_f32 v209, v130, v131
    v_cvt_pk_bf16_f32 v210, v132, v133
    v_cvt_pk_bf16_f32 v211, v134, v135
    s_nop 0
    v_permlane16_swap_b32 v208, v210
    v_permlane16_swap_b32 v209, v211
    buffer_store_dwordx4 v[208:211], v21, s[28:31], s62 offen
NO8:
    s_waitcnt vmcnt(0)
END:
    s_endpgm
SLOW_xn:
    s_mov_b32 s94, 0
SPIN_xn:
    buffer_load_dword v36, v37, s[20:23], s1 offen offset:0 sc1
    s_add_u32 s94, s94, 1
    s_cmp_ge_u32 s94, 20000
    s_cbranch_scc1 RET_xn
    s_waitcnt vmcnt(0)
    v_cmp_ne_u32 vcc, s59, v36
    s_cbranch_vccnz SPIN_xn
    s_branch RET_xn
SLOW_h0:
    s_mov_b32 s94, 0
SPIN_h0:
    buffer_load_dword v36, v35, s[20:23], 0 offen offset:0 sc1
    s_add_u32 s94, s94, 1
    s_cmp_ge_u32 s94, 20000
    s_cbranch_scc1 RET_h0
    s_waitcnt vmcnt(0)
    v_cmp_ne_u32 vcc, s59, v36
    s_cbranch_vccnz SPIN_h0
    s_branch RET_h0
SLOW_xt:
    s_mov_b32 s94, 0
SPIN_xt:
    buffer_load_dwordx4 v[30:33], v23, s[20:23], s67 offen sc1
    s_add_u32 s94, s94, 1
    s_cmp_ge_u32 s94, 20000
    s_waitcnt vmcnt(0)
    s_cbranch_scc1 RET_xt
    v_xor_b32 v30, s59, v30
    v_xor_b32 v31, s59, v31
    v_xor_b32 v32, s59, v32
    v_xor_b32 v33, s59, v33
    v_or3_b32 v30, v30, v31, v32
    v_or_b32 v30, v30, v33
    v_cmp_ne_u32 vcc, 0, v30
    s_cbranch_vccnz SPIN_xt
    s_branch RET_xt
SLOW_h1a:
    s_mov_b32 s94, 0
SPIN_h1a:
    buffer_load_dword v36, v37, s[20:23], s91 offen offset:128 sc1
    s_add_u32 s94, s94, 1
    s_cmp_ge_u32 s94, 20000
    s_cbranch_scc1 RET_h1a
    s_waitcnt vmcnt(0)
    v_cmp_ne_u32 vcc, s59, v36
    s_cbranch_vccnz SPIN_h1a
    s_branch RET_h1a
SLOW_h1b:
    s_mov_b32 s94, 0
SPIN_h1b:
    buffer_load_dword v36, v37, s[20:23], s91 offen offset:128 sc1
    s_add_u32 s94, s94, 1
    s_cmp_ge_u32 s94, 20000
    s_cbranch_scc1 RET_h1b
    s_waitcnt vmcnt(0)
    v_cmp_ne_u32 vcc, s59, v36
    s_cbranch_vccnz SPIN_h1b
    s_branch RET_h1b
SLOW_h2:
    s_mov_b32 s94, 0
SPIN_h2:
    buffer_load_dword v36, v35, s[20:23], 0 offen offset:0 sc1
    s_add_u32 s94, s94, 1
    s_cmp_ge_u32 s94, 20000
    s_cbranch_scc1 RET_h2
    s_waitcnt vmcnt(0)
    v_cmp_ne_u32 vcc, s59, v36
    s_cbranch_vccnz SPIN_h2
    s_branch RET_h2
SLOW_fin:
    s_mov_b32 s94, 0
SPIN_fin:
    buffer_load_dword v36, v39, s[20:23], 0 offen offset:0 sc1
    s_add_u32 s94, s94, 1
    s_cmp_ge_u32 s94, 20000
    s_cbranch_scc1 RET_fin
    s_waitcnt vmcnt(0)
    v_cmp_ne_u32 vcc, s59, v36
    s_cbranch_vccnz SPIN_fin
    s_branch RET_fin
SLOW_in:
    s_mov_b32 s94, 0
SPIN_in:
    buffer_load_dwordx4 v[136:139], v23, s[20:23], s95 offen offset:0 sc1
    buffer_load_dwordx4 v[140:143], v23, s[20:23], s95 offen offset:1024 sc1
    buffer_load_dwordx4 v[144:147], v23, s[20:23], s95 offen offset:2048 sc1
    buffer_load_dwordx4 v[148:151], v23, s[20:23], s95 offen offset:3072 sc1
    buffer_load_dwordx4 v[152:155], v23, s[20:23], s66 offen offset:0 sc1
    buffer_load_dwordx4 v[156:159], v23, s[20:23], s66 offen offset:1024 sc1
    buffer_load_dwordx4 v[160:163], v23, s[20:23], s67 offen sc1
    buffer_load_dwordx4 v[164:167], v23, s[20:23], s68 offen sc1
    buffer_load_dwordx4 v[168:171], v23, s[20:23], s69 offen sc1
    s_add_u32 s94, s94, 1
    s_cmp_ge_u32 s94, 20000
    s_waitcnt vmcnt(0)
    s_cbranch_scc1 RET_in
    v_max3_u32 v36, v136, v137, v138
    v_max3_u32 v36, v36, v139, v140
    v_max3_u32 v36, v36, v141, v142
    v_max3_u32 v36, v36, v143, v144
    v_max3_u32 v36, v36, v145, v146
    v_max3_u32 v36, v36, v147, v148
    v_max3_u32 v36, v36, v149, v150
    v_max3_u32 v36, v36, v151, v152
    v_max3_u32 v36, v36, v153, v154
    v_max3_u32 v36, v36, v155, v156
    v_max3_u32 v36, v36, v157, v158
    v_max3_u32 v36, v36, v159, v160
    v_max3_u32 v36, v36, v161, v162
    v_max3_u32 v36, v36, v163, v164
    v_max3_u32 v36, v36, v165, v166
    v_max3_u32 v36, v36, v167, v168
    v_max3_u32 v36, v36, v169, v170
    v_max_u32 v36, v36, v171
    v_cmp_eq_u32 vcc, -1, v36
    s_cbranch_vccnz SPIN_in
    s_branch RET_in
.p2align 12
.section .rodata,"a"
.p2align 6
.amdhsa_kernel parallel_sum__ssm_conv_s4d__glu_gated_bilinear__prompt_kernel
  .amdhsa_next_free_vgpr 512
  .amdhsa_next_free_sgpr 102
  .amdhsa_accum_offset 256
  .amdhsa_group_segment_fixed_size 0
  .amdhsa_kernarg_size 112
  .amdhsa_user_sgpr_count 2
  .amdhsa_user_sgpr_kernarg_segment_ptr 1
  .amdhsa_system_sgpr_workgroup_id_x 1
  .amdhsa_float_denorm_mode_32 3
.end_amdhsa_kernel
```
